```python
import torch

def _softmax(x, axis=-1):
    return torch.softmax(x, dim=axis)

def _gelu(x):
    return torch.nn.functional.gelu(x, approximate='tanh')

def _silu(x):
    return torch.nn.functional.silu(x)

def _sigmoid(x):
    return torch.sigmoid(x)

def _layernorm(x, axis=-1, eps=1e-05):
    m = x.mean(dim=axis, keepdim=True)
    v = x.var(dim=axis, keepdim=True, unbiased=False)
    return (x - m) / torch.sqrt(v + eps)

def _scatter_add(tgt, idx, src, axis=0):
    return tgt.clone().index_add_(axis, idx, src)

def _segment_sum(src, seg, n):
    out = torch.zeros((n,) + src.shape[1:], dtype=src.dtype)
    return out.index_add_(0, seg, src)

def _pad(x, pw):
    flat = tuple((v for pair in reversed(pw) for v in pair))
    return torch.nn.functional.pad(x, flat)
kernel_name = 'adaLN_cond__ssm_conv_s4__glu_gated_glu__prompt'

def setup_inputs():

    _w = lambda a: (lambda t: t.to(torch.bfloat16) if t.is_floating_point() else t)(torch.as_tensor(a))

    def _A_setup():
        B, L, D, N = (1, 2048, 448, 256)
        A_re = -(lambda _x: torch.exp(torch.as_tensor(_x)))((lambda *s: torch.randn(*s, dtype=torch.bfloat16) * 3.2)(D, N))
        A_im = torch.pi * (lambda *s: torch.randn(*s, dtype=torch.bfloat16) * 0.2)(D, N)
        B_re = (lambda *s: torch.randn(*s, dtype=torch.bfloat16) * 0.2)(D, N)
        B_im = (lambda *s: torch.randn(*s, dtype=torch.bfloat16) * 0.2)(D, N)
        C_re = (lambda *s: torch.randn(*s, dtype=torch.bfloat16) * 0.2)(D, N)
        C_im = (lambda *s: torch.randn(*s, dtype=torch.bfloat16) * 0.2)(D, N)
        log_dt = (lambda *s: torch.randn(*s, dtype=torch.bfloat16) * 0.2)(D) * 0.5 - 4.0
        Dskip = (lambda *s: torch.randn(*s, dtype=torch.bfloat16) * 0.2)(D)
        return {'u': _w((lambda *s: torch.randn(*s, dtype=torch.bfloat16) * 0.05)(B, L, D)), 'A_re': _w(A_re), 'A_im': _w(A_im), 'B_re': _w(B_re), 'B_im': _w(B_im), 'C_re': _w(C_re), 'C_im': _w(C_im), 'log_dt': _w(log_dt), 'Dskip': _w(Dskip)}
    _A_in = _A_setup()

    def _B_setup():
        B, S, D, F = (1, 2048, 448, 1792)
        return {'x': _w((lambda *s: torch.randn(*s, dtype=torch.bfloat16) * 0.05)(B, S, D)), 'w_gate': _w((lambda *s: torch.randn(*s, dtype=torch.bfloat16) * 0.4)(D, F)), 'w_up': _w((lambda *s: torch.randn(*s, dtype=torch.bfloat16) * 0.2)(D, F)), 'w_down': _w((lambda *s: torch.randn(*s, dtype=torch.bfloat16) * 0.2)(F, D))}
    _B_in = _B_setup()
    return {'A_u': _A_in['u'], 'A_A_re': _A_in['A_re'], 'A_A_im': _A_in['A_im'], 'A_B_re': _A_in['B_re'], 'A_B_im': _A_in['B_im'], 'A_C_re': _A_in['C_re'], 'A_C_im': _A_in['C_im'], 'A_log_dt': _A_in['log_dt'], 'A_Dskip': _A_in['Dskip'], 'B_x': _B_in['x'], 'B_w_gate': _B_in['w_gate'], 'B_w_up': _B_in['w_up'], 'B_w_down': _B_in['w_down'], 'c': _w((lambda *s: torch.randn(*s, dtype=torch.bfloat16) * 0.4)(1, 448) * 8.0), 'w_mod': _w((lambda *s: torch.randn(*s, dtype=torch.bfloat16) * 0.4)(448, 6 * 448) * 448 ** (-0.5) * 8.0)}

def reference(A_u, A_A_re, A_A_im, A_B_re, A_B_im, A_C_re, A_C_im, A_log_dt, A_Dskip, B_x, B_w_gate, B_w_up, B_w_down, c, w_mod):

    def _A_ref(u, A_re, A_im, B_re, B_im, C_re, C_im, log_dt, Dskip):
        Bsz, L, D = u.shape
        dt = torch.exp(log_dt)[:, None]
        A = A_re + 1j * A_im
        Bc = B_re + 1j * B_im
        Cc = C_re + 1j * C_im
        logdA = dt * A
        dB = dt * Bc
        l = (lambda x, dt: x.to(dt))(torch.arange(L), A_re.dtype)
        P = torch.exp(logdA[:, :, None] * l[None, None, :])
        K = torch.einsum('dn,dnl,dn->dl', Cc, P, dB).real
        L2 = 2 * L
        Kp = _pad(K, ((0, 0), (0, L)))
        up = (lambda x, *d: x.permute(*d))(u, 0, 2, 1)
        up = _pad(up, ((0, 0), (0, 0), (0, L)))
        Kf = (lambda x, axes=(-2, -1): torch.fft.rfft2(x.float(), dim=axes))(Kp[:, None, :], axes=(-2, -1))
        Uf = (lambda x, axes=(-2, -1): torch.fft.rfft2(x.float(), dim=axes))(up[:, :, None, :], axes=(-2, -1))
        Yf = Uf * Kf[None, :, :, :]
        y = (lambda x, s, axes=(-2, -1): torch.fft.irfft2(x, s=s, dim=axes).to(torch.bfloat16))(Yf, (1, L2), axes=(-2, -1))[:, :, 0, :L]
        y = (lambda x, *d: x.permute(*d))(y, 0, 2, 1) + u * Dskip[None, None, :]
        return y

    def _B_ref(x, w_gate, w_up, w_down):
        g = torch.einsum('bsd,df->bsf', x, w_gate)
        u = torch.einsum('bsd,df->bsf', x, w_up)
        h = _sigmoid(g) * u
        return torch.einsum('bsf,fd->bsd', h, w_down)
    x = A_u
    mod = (_silu(c) @ w_mod).reshape(c.shape[0], 6, 1, -1)
    sa, ca, ga, sb, cb, gb = (mod[:, 0].clone(), mod[:, 1].clone(), mod[:, 2].clone(), mod[:, 3].clone(), mod[:, 4].clone(), mod[:, 5].clone())
    h = _layernorm(x, axis=-1) * (1 + ca) + sa
    x = x + ga * _A_ref(h, A_A_re, A_A_im, A_B_re, A_B_im, A_C_re, A_C_im, A_log_dt, A_Dskip)
    h = _layernorm(x, axis=-1) * (1 + cb) + sb
    x = x + gb * _B_ref(h, B_w_gate, B_w_up, B_w_down)
    return x
```

```asm
; @launch grid=(256,1,1) block=(512,1,1) lds=163840
.amdgcn_target "amdgcn-amd-amdhsa--gfx950"
.text
.globl adaLN_cond__ssm_conv_s4__glu_gated_glu__prompt_kernel
.p2align 8
.type adaLN_cond__ssm_conv_s4__glu_gated_glu__prompt_kernel,@function
adaLN_cond__ssm_conv_s4__glu_gated_glu__prompt_kernel:
  s_cmp_ge_u32 s2, 256
  s_cbranch_scc1 END
  s_memrealtime s[68:69]
  v_lshrrev_b32 v1, 6, v0
  s_load_dwordx4 s[64:67], s[0:1], 128
  s_load_dwordx16 s[32:47], s[0:1], 0
  v_readfirstlane_b32 s4, v1
  s_load_dwordx16 s[48:63], s[0:1], 64
  v_and_b32 v2, 63, v0
  s_getpc_b64 s[20:21]
CPF0:
  s_lshr_b32 s22, s2, 3
  s_mul_i32 s22, s22, 2560
  v_mul_u32_u24 v8, 5, v0
  v_and_b32 v8, 0xffc, v8
  v_add_u32 v8, s22, v8
  v_min_u32 v8, GTAB-CPF0, v8
  global_load_dword v50, v8, s[20:21]
  s_cmp_lt_u32 s2, 32
  s_cbranch_scc1 AUX
  s_lshr_b32 s27, s4, 1
  s_lshl_b32 s25, s27, 6
  v_add_u32 v1, s25, v2
  s_add_u32 s20, s20, GTAB-CPF0
  v_lshlrev_b32 v32, 4, v1
  s_addc_u32 s21, s21, 0
  s_sub_u32 s3, s2, 32
  s_and_b32 s28, s4, 1
  global_load_dwordx4 v[122:125], v32, s[20:21]
  global_load_dwordx2 v[126:127], v32, s[20:21] offset:16
  s_lshl2_add_u32 s7, s28, s27
  s_lshl3_add_u32 s25, s3, s7
  s_lshl_b32 s25, s25, 7
  v_lshl_add_u32 v7, v2, 1, s25
  s_lshl1_add_u32 s23, s3, s28
  s_lshl_b32 s23, s23, 1
  v_mov_b32 v28, s23
  s_and_b32 s15, s4, 3
  s_and_b32 s12, s3, 7
  s_lshr_b32 s6, s3, 3
  s_mul_i32 s13, s6, 37
  s_lshr_b32 s13, s13, 8
  s_mul_i32 s5, s13, 7
  s_sub_u32 s14, s6, s5
  v_lshrrev_b32 v3, 5, v2
  s_cmp_ge_u32 s4, 4
  s_cbranch_scc1 HELPER
  s_mul_i32 s26, s2, 7168
  s_mul_i32 s24, s15, 1792
  s_add_u32 s24, s24, s26
  v_and_b32 v4, 31, v2
  v_mul_u32_u24 v21, 896, v3
  v_mad_u32_u24 v5, v4, 12, v21
  v_lshl_add_u32 v4, v4, 4, v21
  v_lshlrev_b32 v6, 4, v2
  s_mov_b32 s31, 20000
  s_and_b32 s5, s12, 1
  s_lshl2_add_u32 s5, s5, s13
  s_lshr_b32 s6, s12, 1
  s_mul_i32 s6, s6, 7
  s_add_u32 s6, s6, s14
  s_mul_i32 s29, s28, 34816
  s_mul_i32 s7, s7, 8704
  v_add_u32 v49, s29, v32
  v_and_b32 v21, 31, v2
  v_mul_u32_u24 v44, 272, v21
  v_add_u32 v44, s7, v44
  v_lshl_add_u32 v44, v3, 4, v44
  v_lshlrev_b32 v45, 3, v21
  v_lshl_add_u32 v45, v3, 2, v45
  v_cmp_eq_u32 s[16:17], 0, v3
  v_lshlrev_b32 v22, 2, v21
  v_lshlrev_b32 v23, 1, v21
  v_add_u32 v22, 256, v22
  v_add_u32 v23, 384, v23
  v_cndmask_b32_e64 v46, v23, v22, s[16:17]
  v_cndmask_b32_e64 v22, 64, 2, s[16:17]
  v_add_u32 v47, v46, v22
  s_waitcnt lgkmcnt(0)
  global_load_ushort v31, v28, s[46:47]
  global_load_ushort v59, v7, s[36:37] nt
  global_load_ushort v58, v7, s[34:35] nt
  global_load_ushort v60, v7, s[38:39] nt
  global_load_ushort v62, v7, s[42:43] nt
  global_load_ushort v61, v7, s[40:41] nt
  global_load_ushort v63, v7, s[44:45] nt
  global_load_ushort v43, v28, s[48:49]
  s_mov_b32 s8, s32
  s_and_b32 s9, s33, 0xffff
  s_mov_b32 s10, 0x1c0000
  s_mov_b32 s11, 0x20000
  buffer_load_dwordx4 v[50:53], v4, s[8:11], s24 offen nt
  buffer_load_dwordx3 v[54:56], v5, s[8:11], s24 offen offset:512 nt
  s_branch MC_CONT
HELPER:
  s_setprio 1
  s_lshl2_add_u32 s22, s12, s13
  s_lshl_b32 s18, s15, 1
  s_add_u32 s19, s18, 1
  s_cmp_eq_u32 s15, 3
  s_cselect_b32 s19, s14, s19
  s_cselect_b32 s22, s22, s2
  s_mul_i32 s16, s2, 56
  s_mul_i32 s17, s22, 56
  s_add_u32 s16, s16, s18
  s_add_u32 s17, s17, s19
  s_lshl_b32 s16, s16, 7
  s_lshl_b32 s17, s17, 7
  s_lshl_b32 s24, s15, 11
  s_add_u32 s24, s24, 87040
  v_lshrrev_b32 v21, 3, v2
  v_and_b32 v22, 7, v2
  v_and_b32 v23, 6, v21
  v_xor_b32 v23, v22, v23
  v_mul_u32_u24 v4, 896, v21
  v_lshl_add_u32 v4, v23, 4, v4
  s_waitcnt lgkmcnt(0)
  global_load_ushort v31, v28, s[46:47]
  global_load_ushort v59, v7, s[36:37] nt
  global_load_ushort v58, v7, s[34:35] nt
  global_load_ushort v60, v7, s[38:39] nt
  global_load_ushort v62, v7, s[42:43] nt
  global_load_ushort v61, v7, s[40:41] nt
  global_load_ushort v63, v7, s[44:45] nt
  s_mov_b32 s8, s32
  s_and_b32 s9, s33, 0xffff
  s_mov_b32 s10, 0x1c0000
  s_mov_b32 s11, 0x20000
  s_add_u32 m0, s24, 0
  s_nop 0
  buffer_load_dwordx4 v4, s[8:11], s16 offen nt lds
  s_add_u32 m0, s24, 1024
  s_nop 0
  buffer_load_dwordx4 v4, s[8:11], s17 offen nt lds
  s_branch MH_CONT
AUX:
  s_add_u32 s6, s2, 7
  s_and_b32 s6, s6, 7
  s_lshr_b32 s7, s2, 3
  s_lshl2_add_u32 s6, s6, s7
  s_lshr_b32 s3, s6, 1
  s_lshl_b32 s7, s3, 7
  s_lshl1_add_u32 s25, s7, 0xfffffc80
  s_cmp_ge_u32 s3, 14
  s_cselect_b32 s7, s25, s7
  s_and_b32 s23, s6, 1
  s_mul_i32 s26, s23, 224
  s_min_u32 s25, s4, 6
  s_lshl_b32 s25, s25, 5
  s_add_u32 s25, s25, s26
  v_lshrrev_b32 v16, 3, v2
  v_lshl_add_u32 v16, v16, 2, s25
  v_and_b32 v17, 7, v2
  v_mul_u32_u24 v18, 5376, v16
  v_lshl_add_u32 v18, v17, 4, v18
  v_lshlrev_b32 v19, 1, v16
  v_lshrrev_b32 v3, 5, v2
  s_and_b32 s15, s4, 3
  s_mul_i32 s26, s2, 7168
  s_mul_i32 s24, s15, 1792
  s_add_u32 s24, s24, s26
  v_and_b32 v4, 31, v2
  v_mul_u32_u24 v21, 896, v3
  v_mad_u32_u24 v5, v4, 12, v21
  v_lshl_add_u32 v4, v4, 4, v21
  s_cmp_eq_u32 s4, 7
  s_waitcnt lgkmcnt(0)
  s_cbranch_scc1 AX_W7
  s_cmp_ge_u32 s4, 4
  s_cbranch_scc1 AX_NOPX
  s_mov_b32 s8, s32
  s_and_b32 s9, s33, 0xffff
  s_mov_b32 s10, 0x1c0000
  s_mov_b32 s11, 0x20000
  buffer_load_dwordx4 v[50:53], v4, s[8:11], s24 offen nt
  buffer_load_dwordx3 v[54:56], v5, s[8:11], s24 offen offset:512 nt
AX_NOPX:
  s_mov_b32 s12, s60
  s_and_b32 s13, s61, 0xffff
  s_mov_b32 s14, 0x24c000
  s_mov_b32 s15, 0x20000
  global_load_dwordx2 v[40:41], v19, s[58:59]
  buffer_load_dwordx4 v[96:99], v18, s[12:15], s7 offen nt
  s_add_u32 s25, s7, 5376
  buffer_load_dwordx4 v[100:103], v18, s[12:15], s25 offen nt
  s_add_u32 s25, s7, 10752
  buffer_load_dwordx4 v[104:107], v18, s[12:15], s25 offen nt
  s_add_u32 s25, s7, 16128
  buffer_load_dwordx4 v[108:111], v18, s[12:15], s25 offen nt
  s_cmp_ge_u32 s4, 4
  s_cbranch_scc1 AUXH
  s_branch AX_CONT
EARLY_END:
MC_CONT:
  v_lshl_add_u32 v48, v3, 7, v21
  v_add_u32 v48, 512, v48
  v_lshrrev_b32 v22, 4, v45
  v_add_u32 v45, v45, v22
  v_lshl_add_u32 v45, v45, 2, s7
  v_lshrrev_b32 v22, 4, v46
  v_add_u32 v46, v46, v22
  v_lshl_add_u32 v46, v46, 2, s7
  v_lshrrev_b32 v22, 4, v47
  v_add_u32 v47, v47, v22
  v_lshl_add_u32 v47, v47, 2, s7
  v_lshrrev_b32 v22, 4, v48
  v_add_u32 v48, v48, v22
  v_lshl_add_u32 v48, v48, 2, s7
  s_mov_b32 s32, s15
  s_mov_b32 s51, s13
  s_and_b32 s33, s14, 3
  s_cmp_lt_u32 s15, 2
  s_cselect_b32 s52, s52, s54
  s_cselect_b32 s53, s53, s55
  s_mov_b32 s12, s52
  s_and_b32 s13, s53, 0xffff
  s_mov_b32 s14, 0x188000
  s_mov_b32 s15, 0x20000
  s_mov_b32 s20, s64
  s_and_b32 s21, s65, 0xffff
  s_mov_b32 s22, 0x100
  s_mov_b32 s23, 0x20000
  s_mov_b32 s16, s66
  s_and_b32 s17, s67, 0xffff
  s_mov_b32 s18, 0x1400000
  s_mov_b32 s19, 0x20000
  s_lshr_b64 s[70:71], s[68:69], 8
  s_sub_u32 s69, s70, 3
  v_lshrrev_b32 v21, 3, v2
  v_and_b32 v22, 7, v2
  v_mul_u32_u24 v20, 28928, v21
  v_lshl_add_u32 v20, v22, 4, v20
  v_mov_b32 v24, -1
  v_mov_b32 v25, -1
  v_mov_b32 v26, -1
  v_mov_b32 v27, -1
  s_mul_i32 s35, s4, 231424
  s_lshl_b32 s25, s3, 7
  s_add_u32 s35, s35, s25
  s_add_u32 s35, s35, 147456
  s_lshl_b32 s39, s3, 5
  v_lshrrev_b32 v21, 1, v2
  v_cmp_eq_u32 vcc, 3, v21
  s_nop 1
  v_addc_co_u32 v21, vcc, 0, v21, vcc
  v_mul_u32_u24 v7, 7168, v21
  v_and_b32 v21, 1, v2
  v_lshl_add_u32 v7, v21, 4, v7
  s_add_u32 s39, s39, 90112
  s_lshr_b32 s25, s3, 3
  s_lshl1_add_u32 s25, s25, s28
  s_mul_i32 s25, s25, 36
  s_add_u32 s25, s25, 0
  v_min_u32 v21, 35, v2
  v_add_u32 v21, s25, v21
  v_mul_u32_u24 v5, 9363, v21
  v_lshrrev_b32 v5, 16, v5
  v_mul_u32_u24 v5, 2688, v5
  v_lshl_add_u32 v5, v21, 7, v5
  v_cmp_gt_u32 vcc, 2016, v21
  s_nop 1
  v_cndmask_b32 v22, 0, v24, vcc
  v_cmp_gt_u32 vcc, 224, v21
  v_and_b32 v22, 0xfffe4000, v22
  v_mov_b32 v21, 917504
  v_cndmask_b32 v22, v22, v21, vcc
  v_add_u32 v5, v5, v22
  s_bfe_u32 s36, s3, 0x20001
  s_mul_i32 s36, s36, 896
  v_and_b32 v22, 3, v2
  v_bfe_u32 v21, v2, 2, 2
  v_mul_u32_u24 v21, 8768, v21
  v_lshl_add_u32 v21, v22, 4, v21
  v_add_u32 v29, s29, v21
  v_accvgpr_write_b32 a0, 0
  v_accvgpr_write_b32 a1, 0
  v_accvgpr_write_b32 a2, 0
  v_accvgpr_write_b32 a3, 0
  v_cmp_eq_u32 s[54:55], 0, v1
  s_lshr_b32 s27, s4, 1
  v_and_b32 v21, 15, v2
  v_lshrrev_b32 v22, 4, v2
  v_and_b32 v23, 3, v21
  v_sub_u32 v23, 3, v23
  v_mul_u32_u24 v8, 8768, v23
  v_lshrrev_b32 v23, 2, v21
  v_lshlrev_b32 v23, 3, v23
  v_sub_u32 v8, v8, v23
  v_lshl_add_u32 v8, v22, 4, v8
  s_lshl_b32 s50, s27, 6
  s_sub_u32 s26, s29, s50
  s_add_u32 s26, s26, 3544
  v_add_u32 v8, s26, v8
  v_lshlrev_b32 v9, 5, v21
  v_lshl_add_u32 v9, v22, 4, v9
  s_mul_i32 s26, s28, 4608
  s_sub_u32 s26, s26, s50
  s_add_u32 s26, s26, 69856
  v_add_u32 v9, s26, v9
  v_lshl_add_u32 v22, v21, 1, v3
  v_bfe_u32 v23, v22, 3, 1
  v_xor_b32 v22, v22, v23
  v_bfe_u32 v23, v2, 4, 1
  v_lshl_add_u32 v22, v23, 5, v22
  v_lshl_add_u32 v11, v22, 4, s7
  s_lshl_b32 s47, s4, 11
  s_mul_i32 s34, s3, 16512
  s_add_u32 s34, s34, s47
  s_add_u32 s34, s34, 2097152
  s_mov_b32 s46, 0x3e22f983
  s_waitcnt vmcnt(10)
  v_add_u32_sdwa v32, s29, v122 dst_sel:DWORD dst_unused:UNUSED_PAD src0_sel:DWORD src1_sel:WORD_0
  v_add_u32_sdwa v33, s29, v122 dst_sel:DWORD dst_unused:UNUSED_PAD src0_sel:DWORD src1_sel:WORD_1
  v_add_u32_sdwa v34, s29, v123 dst_sel:DWORD dst_unused:UNUSED_PAD src0_sel:DWORD src1_sel:WORD_0
  v_add_u32_sdwa v35, s29, v123 dst_sel:DWORD dst_unused:UNUSED_PAD src0_sel:DWORD src1_sel:WORD_1
  v_add_u32_sdwa v36, s29, v124 dst_sel:DWORD dst_unused:UNUSED_PAD src0_sel:DWORD src1_sel:WORD_0
  v_add_u32_sdwa v37, s29, v124 dst_sel:DWORD dst_unused:UNUSED_PAD src0_sel:DWORD src1_sel:WORD_1
  v_add_u32_sdwa v38, s29, v125 dst_sel:DWORD dst_unused:UNUSED_PAD src0_sel:DWORD src1_sel:WORD_0
  v_add_u32_sdwa v39, s29, v125 dst_sel:DWORD dst_unused:UNUSED_PAD src0_sel:DWORD src1_sel:WORD_1
  v_add_u32_sdwa v40, s29, v126 dst_sel:DWORD dst_unused:UNUSED_PAD src0_sel:DWORD src1_sel:WORD_0
  v_add_u32_sdwa v41, s29, v126 dst_sel:DWORD dst_unused:UNUSED_PAD src0_sel:DWORD src1_sel:WORD_1
  v_add_u32_sdwa v42, s29, v127 dst_sel:DWORD dst_unused:UNUSED_PAD src0_sel:DWORD src1_sel:WORD_0
  s_waitcnt vmcnt(2)
  v_lshlrev_b32 v31, 16, v31
  v_mul_f32 v31, 0x3fb8aa3b, v31
  v_exp_f32 v31, v31
  v_lshlrev_b32 v58, 16, v58
  v_lshlrev_b32 v59, 16, v59
  v_lshlrev_b32 v60, 16, v60
  v_lshlrev_b32 v61, 16, v61
  v_lshlrev_b32 v62, 16, v62
  v_lshlrev_b32 v63, 16, v63
  v_cvt_pk_bf16_f32 v31, 0, v31
  v_mul_f32 v121, 0x3fb8aa3b, v31
  v_mul_f32 v59, v59, v31
  v_mul_f32 v58, v58, v121
  v_mul_f32 v96, s46, v59
  v_mul_f32 v100, v62, v60
  v_mul_f32 v101, v62, v61
  v_fma_f32 v97, v59, s46, -v96
  v_fma_f32 v100, -v63, v61, v100
  v_fma_f32 v101, v63, v60, v101
  v_fmac_f32 v97, 0x31dc9c88, v59
  v_exp_f32 v98, v58
  v_fract_f32 v99, v96
  v_add_f32 v99, v99, v97
  v_cos_f32 v104, v99
  v_sin_f32 v105, v99
  v_mul_f32 v104, v104, v98
  v_mul_f32 v105, v105, v98
  v_mul_f32 v98, 0x43800000, v58
  v_mul_f32 v99, 0x43800000, v96
  v_exp_f32 v98, v98
  v_fract_f32 v99, v99
  v_fmac_f32 v99, 0x43800000, v97
  v_cos_f32 v106, v99
  v_sin_f32 v107, v99
  v_mul_f32 v106, v106, v98
  v_mul_f32 v107, v107, v98
  v_mul_f32 v98, 0x41000000, v58
  v_mul_f32 v99, 0x41000000, v96
  v_exp_f32 v98, v98
  v_fract_f32 v99, v99
  v_fmac_f32 v99, 0x41000000, v97
  v_cos_f32 v112, v99
  v_sin_f32 v113, v99
  v_pk_mul_f32 v[108:109], v[106:107], v[106:107] op_sel:[0,0] op_sel_hi:[1,0]
  v_pk_fma_f32 v[108:109], v[106:107], v[106:107], v[108:109] op_sel:[1,1,0] op_sel_hi:[0,1,1] neg_lo:[1,0,0]
  v_mul_f32 v112, v112, v98
  v_mul_f32 v113, -v113, v98
  v_pk_mul_f32 v[110:111], v[108:109], v[108:109] op_sel:[0,0] op_sel_hi:[1,0]
  v_pk_fma_f32 v[110:111], v[108:109], v[108:109], v[110:111] op_sel:[1,1,0] op_sel_hi:[0,1,1] neg_lo:[1,0,0]
  v_pk_mul_f32 v[114:115], v[112:113], v[112:113] op_sel:[0,0] op_sel_hi:[1,0]
  v_pk_fma_f32 v[114:115], v[112:113], v[112:113], v[114:115] op_sel:[1,1,0] op_sel_hi:[0,1,1] neg_lo:[1,0,0]
  s_mov_b32 m0, s7
  v_cvt_pk_f16_f32 v58, v106, v107
  v_cvt_pk_f16_f32 v59, v108, v109
  v_cvt_pk_f16_f32 v60, v110, v111
  s_waitcnt vmcnt(0)
  v_lshlrev_b32 v68, 16, v50
  v_and_b32 v69, 0xffff0000, v50
  v_lshlrev_b32 v70, 16, v51
  v_and_b32 v71, 0xffff0000, v51
  v_lshlrev_b32 v72, 16, v52
  v_and_b32 v73, 0xffff0000, v52
  v_lshlrev_b32 v74, 16, v53
  v_and_b32 v75, 0xffff0000, v53
  v_lshlrev_b32 v76, 16, v54
  v_and_b32 v77, 0xffff0000, v54
  v_lshlrev_b32 v78, 16, v55
  v_and_b32 v79, 0xffff0000, v55
  v_lshlrev_b32 v80, 16, v56
  v_and_b32 v81, 0xffff0000, v56
  v_pk_add_f32 v[82:83], v[68:69], v[70:71]
  v_pk_mul_f32 v[84:85], v[68:69], v[68:69]
  v_pk_mul_f32 v[86:87], v[70:71], v[70:71]
  v_pk_add_f32 v[82:83], v[82:83], v[72:73]
  v_pk_fma_f32 v[84:85], v[72:73], v[72:73], v[84:85]
  v_pk_add_f32 v[82:83], v[82:83], v[74:75]
  v_pk_fma_f32 v[86:87], v[74:75], v[74:75], v[86:87]
  v_pk_add_f32 v[82:83], v[82:83], v[76:77]
  v_pk_fma_f32 v[84:85], v[76:77], v[76:77], v[84:85]
  v_pk_add_f32 v[82:83], v[82:83], v[78:79]
  v_pk_fma_f32 v[86:87], v[78:79], v[78:79], v[86:87]
  v_pk_add_f32 v[82:83], v[82:83], v[80:81]
  v_pk_fma_f32 v[84:85], v[80:81], v[80:81], v[84:85]
  v_pk_add_f32 v[84:85], v[84:85], v[86:87]
  v_add_f32 v82, v82, v83
  v_add_f32 v84, v84, v85
  s_lshl_b32 s25, s4, 4
  v_add_f32_dpp v82, v82, v82 quad_perm:[1,0,3,2] row_mask:0xf bank_mask:0xf
  v_add_f32_dpp v84, v84, v84 quad_perm:[1,0,3,2] row_mask:0xf bank_mask:0xf
  s_add_u32 s25, s25, 162592
  v_add_f32_dpp v82, v82, v82 quad_perm:[2,3,0,1] row_mask:0xf bank_mask:0xf
  v_add_f32_dpp v84, v84, v84 quad_perm:[2,3,0,1] row_mask:0xf bank_mask:0xf
  v_lshl_add_u32 v68, v3, 3, s25
  v_add_f32_dpp v82, v82, v82 row_half_mirror row_mask:0xf bank_mask:0xf
  v_add_f32_dpp v84, v84, v84 row_half_mirror row_mask:0xf bank_mask:0xf
  v_add_u32 v69, 162592, v6
  v_add_f32_dpp v82, v82, v82 row_mirror row_mask:0xf bank_mask:0xf
  v_add_f32_dpp v84, v84, v84 row_mirror row_mask:0xf bank_mask:0xf
  s_lshl_b32 s24, s2, 6
  v_add_f32_dpp v82, v82, v82 row_bcast:15 row_mask:0xa bank_mask:0xf
  v_add_f32_dpp v84, v84, v84 row_bcast:15 row_mask:0xa bank_mask:0xf
  v_mul_f32 v82, 0x3b124925, v82
  v_mul_f32 v84, 0x3b124925, v84
  v_fma_f32 v84, -v82, v82, v84
  v_max_f32 v84, 0, v84
  v_cvt_pk_bf16_f32 v84, 0, v84
  v_add_f32 v84, 0x3727c5ac, v84
  v_cvt_pk_bf16_f32 v84, 0, v84
  v_sqrt_f32 v84, v84
  s_nop 0
  v_cvt_pk_bf16_f32 v84, v84, v82
  v_add_u32_e64 v30, s69, 3
  v_mov_b32 v85, v30
  s_mov_b32 exec_lo, 0x10000
  s_mov_b32 exec_hi, 0x10000
  ds_write_b64 v68, v[84:85]
  s_mov_b64 exec, 15
  ds_read_b128 v[72:75], v69
  s_waitcnt lgkmcnt(0)
  v_subrev_u32 v70, s69, v73
  v_subrev_u32 v71, s69, v75
  v_max_u32 v70, v70, v71
  v_cmp_lt_u32 vcc, 16, v70
  s_cbranch_vccnz MC_NOST
  buffer_store_dwordx4 v[72:75], v6, s[16:19], s24 offen offset:0 sc1
MC_NOST:
  s_mov_b64 exec, -1
  v_cvt_pk_f16_f32 v64, v100, v101
  v_pk_mul_f32 v[118:119], v[114:115], v[114:115] op_sel:[0,0] op_sel_hi:[1,0]
  v_pk_mul_f32 v[102:103], v[100:101], v[104:105] op_sel:[0,0] op_sel_hi:[1,0]
  v_pk_fma_f32 v[118:119], v[114:115], v[114:115], v[118:119] op_sel:[1,1,0] op_sel_hi:[0,1,1] neg_lo:[1,0,0]
  v_pk_fma_f32 v[102:103], v[100:101], v[104:105], v[102:103] op_sel:[1,1,0] op_sel_hi:[0,1,1] neg_lo:[1,0,0]
  v_pk_mul_f16 v72, v64, v58 op_sel:[0,0] op_sel_hi:[1,0]
  ds_write_addtid_b32 v64 offset:0
  v_pk_fma_f16 v72, v64, v58, v72 op_sel:[1,1,0] op_sel_hi:[0,1,1] neg_lo:[1,0,0]
  v_cvt_pk_f16_f32 v65, v102, v103
  ds_write_addtid_b32 v72 offset:2176
  v_pk_mul_f32 v[100:101], v[102:103], v[104:105] op_sel:[0,0] op_sel_hi:[1,0]
  v_pk_mul_f16 v76, v64, v59 op_sel:[0,0] op_sel_hi:[1,0]
  v_pk_fma_f32 v[100:101], v[102:103], v[104:105], v[100:101] op_sel:[1,1,0] op_sel_hi:[0,1,1] neg_lo:[1,0,0]
  v_pk_fma_f16 v76, v64, v59, v76 op_sel:[1,1,0] op_sel_hi:[0,1,1] neg_lo:[1,0,0]
  ds_write_addtid_b32 v65 offset:272
  ds_write_addtid_b32 v76 offset:3264
  v_cvt_pk_f16_f32 v66, v100, v101
  v_pk_mul_f16 v80, v64, v60 op_sel:[0,0] op_sel_hi:[1,0]
  v_pk_mul_f32 v[102:103], v[100:101], v[104:105] op_sel:[0,0] op_sel_hi:[1,0]
  v_pk_fma_f16 v80, v64, v60, v80 op_sel:[1,1,0] op_sel_hi:[0,1,1] neg_lo:[1,0,0]
  v_pk_fma_f32 v[102:103], v[100:101], v[104:105], v[102:103] op_sel:[1,1,0] op_sel_hi:[0,1,1] neg_lo:[1,0,0]
  ds_write_addtid_b32 v80 offset:4352
  ds_write_addtid_b32 v66 offset:544
  v_pk_mul_f16 v78, v72, v59 op_sel:[0,0] op_sel_hi:[1,0]
  v_cvt_pk_f16_f32 v67, v102, v103
  v_pk_fma_f16 v78, v72, v59, v78 op_sel:[1,1,0] op_sel_hi:[0,1,1] neg_lo:[1,0,0]
  v_pk_mul_f32 v[100:101], v[102:103], v[104:105] op_sel:[0,0] op_sel_hi:[1,0]
  ds_write_addtid_b32 v78 offset:3808
  v_pk_fma_f32 v[100:101], v[102:103], v[104:105], v[100:101] op_sel:[1,1,0] op_sel_hi:[0,1,1] neg_lo:[1,0,0]
  v_pk_mul_f16 v73, v66, v58 op_sel:[0,0] op_sel_hi:[1,0]
  ds_write_addtid_b32 v67 offset:816
  v_pk_fma_f16 v73, v66, v58, v73 op_sel:[1,1,0] op_sel_hi:[0,1,1] neg_lo:[1,0,0]
  v_cvt_pk_f16_f32 v68, v100, v101
  ds_write_addtid_b32 v73 offset:2448
  v_pk_mul_f32 v[102:103], v[100:101], v[104:105] op_sel:[0,0] op_sel_hi:[1,0]
  v_pk_mul_f16 v81, v72, v60 op_sel:[0,0] op_sel_hi:[1,0]
  v_pk_fma_f32 v[102:103], v[100:101], v[104:105], v[102:103] op_sel:[1,1,0] op_sel_hi:[0,1,1] neg_lo:[1,0,0]
  v_pk_fma_f16 v81, v72, v60, v81 op_sel:[1,1,0] op_sel_hi:[0,1,1] neg_lo:[1,0,0]
  ds_write_addtid_b32 v68 offset:1088
  ds_write_addtid_b32 v81 offset:4624
  v_cvt_pk_f16_f32 v69, v102, v103
  v_pk_mul_f16 v82, v76, v60 op_sel:[0,0] op_sel_hi:[1,0]
  v_pk_mul_f32 v[100:101], v[102:103], v[104:105] op_sel:[0,0] op_sel_hi:[1,0]
  v_pk_fma_f16 v82, v76, v60, v82 op_sel:[1,1,0] op_sel_hi:[0,1,1] neg_lo:[1,0,0]
  v_pk_fma_f32 v[100:101], v[102:103], v[104:105], v[100:101] op_sel:[1,1,0] op_sel_hi:[0,1,1] neg_lo:[1,0,0]
  ds_write_addtid_b32 v82 offset:4896
  ds_write_addtid_b32 v69 offset:1360
  v_pk_mul_f16 v74, v68, v58 op_sel:[0,0] op_sel_hi:[1,0]
  v_cvt_pk_f16_f32 v70, v100, v101
  v_pk_fma_f16 v74, v68, v58, v74 op_sel:[1,1,0] op_sel_hi:[0,1,1] neg_lo:[1,0,0]
  v_pk_mul_f32 v[102:103], v[100:101], v[104:105] op_sel:[0,0] op_sel_hi:[1,0]
  ds_write_addtid_b32 v74 offset:2720
  v_pk_fma_f32 v[102:103], v[100:101], v[104:105], v[102:103] op_sel:[1,1,0] op_sel_hi:[0,1,1] neg_lo:[1,0,0]
  v_pk_mul_f16 v84, v80, v60 op_sel:[0,0] op_sel_hi:[1,0]
  ds_write_addtid_b32 v70 offset:1632
  v_pk_fma_f16 v84, v80, v60, v84 op_sel:[1,1,0] op_sel_hi:[0,1,1] neg_lo:[1,0,0]
  v_cvt_pk_f16_f32 v71, v102, v103
  ds_write_addtid_b32 v84 offset:5440
  ds_write_addtid_b32 v71 offset:1904
  v_pk_mul_f16 v77, v68, v59 op_sel:[0,0] op_sel_hi:[1,0]
  v_pk_mul_f16 v83, v78, v60 op_sel:[0,0] op_sel_hi:[1,0]
  v_pk_mul_f32 v[116:117], v[114:115], v[112:113] op_sel:[0,0] op_sel_hi:[1,0]
  v_pk_fma_f16 v77, v68, v59, v77 op_sel:[1,1,0] op_sel_hi:[0,1,1] neg_lo:[1,0,0]
  v_pk_fma_f16 v83, v78, v60, v83 op_sel:[1,1,0] op_sel_hi:[0,1,1] neg_lo:[1,0,0]
  v_pk_fma_f32 v[116:117], v[114:115], v[112:113], v[116:117] op_sel:[1,1,0] op_sel_hi:[0,1,1] neg_lo:[1,0,0]
  ds_write_addtid_b32 v77 offset:3536
  ds_write_addtid_b32 v83 offset:5168
  v_mov_b32 v61, 0x3c00
  v_pk_mul_f16 v79, v74, v59 op_sel:[0,0] op_sel_hi:[1,0]
  v_pk_mul_f16 v75, v70, v58 op_sel:[0,0] op_sel_hi:[1,0]
  buffer_load_dword v5, v5, s[12:15], s36 offen
  v_pk_fma_f16 v79, v74, v59, v79 op_sel:[1,1,0] op_sel_hi:[0,1,1] neg_lo:[1,0,0]
  v_pk_fma_f16 v75, v70, v58, v75 op_sel:[1,1,0] op_sel_hi:[0,1,1] neg_lo:[1,0,0]
  ds_write_addtid_b32 v79 offset:4080
  ds_write_addtid_b32 v75 offset:2992
  ds_read_b128 a[64:67], v44 offset:0
  v_cvt_pk_f16_f32 v58, v112, v113
  ds_read_b128 a[68:71], v44 offset:32
  v_cvt_pk_f16_f32 v59, v114, v115
  ds_read_b128 a[72:75], v44 offset:64
  v_cvt_pk_f16_f32 v60, v116, v117
  ds_read_b128 a[76:79], v44 offset:96
  v_cvt_pk_f16_f32 v65, v118, v119
  ds_read_b128 a[80:83], v44 offset:128
  v_pk_mul_f32 v[100:101], v[118:119], v[118:119] op_sel:[0,0] op_sel_hi:[1,0]
  ds_read_b128 a[84:87], v44 offset:160
  v_pk_fma_f32 v[100:101], v[118:119], v[118:119], v[100:101] op_sel:[1,1,0] op_sel_hi:[0,1,1] neg_lo:[1,0,0]
  ds_read_b128 a[88:91], v44 offset:192
  ds_read_b128 a[92:95], v44 offset:224
  ds_write_addtid_b32 v61 offset:0
  ds_write_addtid_b32 v58 offset:272
  ds_write_addtid_b32 v59 offset:544
  ds_write_addtid_b32 v60 offset:816
  ds_write_addtid_b32 v65 offset:1088
  v_pk_mul_f16 v72, v65, v58 op_sel:[0,0] op_sel_hi:[1,0]
  v_pk_mul_f16 v73, v65, v59 op_sel:[0,0] op_sel_hi:[1,0]
  v_pk_mul_f16 v74, v65, v60 op_sel:[0,0] op_sel_hi:[1,0]
  v_cvt_pk_f16_f32 v66, v100, v101
  v_pk_fma_f16 v72, v65, v58, v72 op_sel:[1,1,0] op_sel_hi:[0,1,1] neg_lo:[1,0,0]
  v_pk_fma_f16 v73, v65, v59, v73 op_sel:[1,1,0] op_sel_hi:[0,1,1] neg_lo:[1,0,0]
  v_pk_fma_f16 v74, v65, v60, v74 op_sel:[1,1,0] op_sel_hi:[0,1,1] neg_lo:[1,0,0]
  buffer_store_dwordx4 v[24:27], v20, s[16:19], s35 offen sc1
  v_pk_mul_f32 v[102:103], v[100:101], v[118:119] op_sel:[0,0] op_sel_hi:[1,0]
  ds_write_addtid_b32 v72 offset:1360
  ds_write_addtid_b32 v73 offset:1632
  ds_write_addtid_b32 v74 offset:1904
  v_pk_fma_f32 v[102:103], v[100:101], v[118:119], v[102:103] op_sel:[1,1,0] op_sel_hi:[0,1,1] neg_lo:[1,0,0]
  ds_write_addtid_b32 v66 offset:2176
  v_pk_mul_f16 v75, v66, v58 op_sel:[0,0] op_sel_hi:[1,0]
  v_pk_mul_f16 v76, v66, v59 op_sel:[0,0] op_sel_hi:[1,0]
  v_pk_mul_f16 v77, v66, v60 op_sel:[0,0] op_sel_hi:[1,0]
  v_cvt_pk_f16_f32 v67, v102, v103
  v_pk_fma_f16 v75, v66, v58, v75 op_sel:[1,1,0] op_sel_hi:[0,1,1] neg_lo:[1,0,0]
  v_pk_fma_f16 v76, v66, v59, v76 op_sel:[1,1,0] op_sel_hi:[0,1,1] neg_lo:[1,0,0]
  v_pk_fma_f16 v77, v66, v60, v77 op_sel:[1,1,0] op_sel_hi:[0,1,1] neg_lo:[1,0,0]
  v_pk_mul_f32 v[100:101], v[102:103], v[118:119] op_sel:[0,0] op_sel_hi:[1,0]
  ds_write_addtid_b32 v75 offset:2448
  ds_write_addtid_b32 v76 offset:2720
  ds_write_addtid_b32 v77 offset:2992
  v_pk_fma_f32 v[100:101], v[102:103], v[118:119], v[100:101] op_sel:[1,1,0] op_sel_hi:[0,1,1] neg_lo:[1,0,0]
  ds_write_addtid_b32 v67 offset:3264
  s_load_dwordx4 s[8:11], s[64:65], 128
  s_load_dwordx4 s[24:27], s[64:65], 144
  v_pk_mul_f16 v72, v67, v58 op_sel:[0,0] op_sel_hi:[1,0]
  v_pk_mul_f16 v73, v67, v59 op_sel:[0,0] op_sel_hi:[1,0]
  v_pk_mul_f16 v74, v67, v60 op_sel:[0,0] op_sel_hi:[1,0]
  v_cvt_pk_f16_f32 v68, v100, v101
  v_pk_fma_f16 v72, v67, v58, v72 op_sel:[1,1,0] op_sel_hi:[0,1,1] neg_lo:[1,0,0]
  v_pk_fma_f16 v73, v67, v59, v73 op_sel:[1,1,0] op_sel_hi:[0,1,1] neg_lo:[1,0,0]
  v_pk_fma_f16 v74, v67, v60, v74 op_sel:[1,1,0] op_sel_hi:[0,1,1] neg_lo:[1,0,0]
  v_pk_mul_f32 v[102:103], v[100:101], v[118:119] op_sel:[0,0] op_sel_hi:[1,0]
  ds_write_addtid_b32 v72 offset:3536
  ds_write_addtid_b32 v73 offset:3808
  ds_write_addtid_b32 v74 offset:4080
  v_pk_fma_f32 v[102:103], v[100:101], v[118:119], v[102:103] op_sel:[1,1,0] op_sel_hi:[0,1,1] neg_lo:[1,0,0]
  ds_write_addtid_b32 v68 offset:4352
  v_pk_mul_f16 v75, v68, v58 op_sel:[0,0] op_sel_hi:[1,0]
  v_pk_mul_f16 v76, v68, v59 op_sel:[0,0] op_sel_hi:[1,0]
  v_pk_mul_f16 v77, v68, v60 op_sel:[0,0] op_sel_hi:[1,0]
  v_cvt_pk_f16_f32 v69, v102, v103
  v_pk_fma_f16 v75, v68, v58, v75 op_sel:[1,1,0] op_sel_hi:[0,1,1] neg_lo:[1,0,0]
  v_pk_fma_f16 v76, v68, v59, v76 op_sel:[1,1,0] op_sel_hi:[0,1,1] neg_lo:[1,0,0]
  v_pk_fma_f16 v77, v68, v60, v77 op_sel:[1,1,0] op_sel_hi:[0,1,1] neg_lo:[1,0,0]
  v_pk_mul_f32 v[100:101], v[102:103], v[118:119] op_sel:[0,0] op_sel_hi:[1,0]
  ds_write_addtid_b32 v75 offset:4624
  ds_write_addtid_b32 v76 offset:4896
  ds_write_addtid_b32 v77 offset:5168
  v_pk_fma_f32 v[100:101], v[102:103], v[118:119], v[100:101] op_sel:[1,1,0] op_sel_hi:[0,1,1] neg_lo:[1,0,0]
  ds_write_addtid_b32 v69 offset:5440
  v_pk_mul_f16 v72, v69, v58 op_sel:[0,0] op_sel_hi:[1,0]
  v_pk_mul_f16 v73, v69, v59 op_sel:[0,0] op_sel_hi:[1,0]
  v_pk_mul_f16 v74, v69, v60 op_sel:[0,0] op_sel_hi:[1,0]
  v_cvt_pk_f16_f32 v70, v100, v101
  v_pk_fma_f16 v72, v69, v58, v72 op_sel:[1,1,0] op_sel_hi:[0,1,1] neg_lo:[1,0,0]
  v_pk_fma_f16 v73, v69, v59, v73 op_sel:[1,1,0] op_sel_hi:[0,1,1] neg_lo:[1,0,0]
  v_pk_fma_f16 v74, v69, v60, v74 op_sel:[1,1,0] op_sel_hi:[0,1,1] neg_lo:[1,0,0]
  v_pk_mul_f32 v[102:103], v[100:101], v[118:119] op_sel:[0,0] op_sel_hi:[1,0]
  ds_write_addtid_b32 v72 offset:5712
  ds_write_addtid_b32 v73 offset:5984
  ds_write_addtid_b32 v74 offset:6256
  v_pk_fma_f32 v[102:103], v[100:101], v[118:119], v[102:103] op_sel:[1,1,0] op_sel_hi:[0,1,1] neg_lo:[1,0,0]
  ds_write_addtid_b32 v70 offset:6528
  v_pk_mul_f16 v75, v70, v58 op_sel:[0,0] op_sel_hi:[1,0]
  v_pk_mul_f16 v76, v70, v59 op_sel:[0,0] op_sel_hi:[1,0]
  v_pk_mul_f16 v77, v70, v60 op_sel:[0,0] op_sel_hi:[1,0]
  v_cvt_pk_f16_f32 v71, v102, v103
  v_pk_fma_f16 v75, v70, v58, v75 op_sel:[1,1,0] op_sel_hi:[0,1,1] neg_lo:[1,0,0]
  v_pk_fma_f16 v76, v70, v59, v76 op_sel:[1,1,0] op_sel_hi:[0,1,1] neg_lo:[1,0,0]
  v_pk_fma_f16 v77, v70, v60, v77 op_sel:[1,1,0] op_sel_hi:[0,1,1] neg_lo:[1,0,0]
  ds_write_addtid_b32 v71 offset:7616
  ds_write_addtid_b32 v75 offset:6800
  ds_write_addtid_b32 v76 offset:7072
  ds_write_addtid_b32 v77 offset:7344
  v_pk_mul_f16 v72, v71, v58 op_sel:[0,0] op_sel_hi:[1,0]
  v_pk_mul_f16 v73, v71, v59 op_sel:[0,0] op_sel_hi:[1,0]
  v_pk_mul_f16 v74, v71, v60 op_sel:[0,0] op_sel_hi:[1,0]
  v_pk_fma_f16 v72, v71, v58, v72 op_sel:[1,1,0] op_sel_hi:[0,1,1] neg_lo:[1,0,0]
  v_pk_fma_f16 v73, v71, v59, v73 op_sel:[1,1,0] op_sel_hi:[0,1,1] neg_lo:[1,0,0]
  v_pk_fma_f16 v74, v71, v60, v74 op_sel:[1,1,0] op_sel_hi:[0,1,1] neg_lo:[1,0,0]
  ds_write_addtid_b32 v72 offset:7888
  ds_write_addtid_b32 v73 offset:8160
  ds_write_addtid_b32 v74 offset:8432
  ds_read_b128 a[96:99], v44 offset:0
  ds_read_b128 a[100:103], v44 offset:32
  ds_read_b128 a[104:107], v44 offset:64
  ds_read_b128 a[108:111], v44 offset:96
  ds_read_b128 a[112:115], v44 offset:128
  ds_read_b128 a[116:119], v44 offset:160
  ds_read_b128 a[120:123], v44 offset:192
  ds_read_b128 a[124:127], v44 offset:224
  v_lshlrev_b32 v43, 16, v43
  v_cndmask_b32_e64 v43, 0, v43, s[54:55]
  s_waitcnt lgkmcnt(7)
  v_mfma_f32_32x32x16_f16 v[112:127], a[64:67], a[96:99], 0
  s_waitcnt lgkmcnt(6)
  v_mfma_f32_32x32x16_f16 v[112:127], a[68:71], a[100:103], v[112:127]
  s_waitcnt lgkmcnt(5)
  v_mfma_f32_32x32x16_f16 v[112:127], a[72:75], a[104:107], v[112:127]
  s_waitcnt lgkmcnt(4)
  v_mfma_f32_32x32x16_f16 v[112:127], a[76:79], a[108:111], v[112:127]
  s_waitcnt lgkmcnt(3)
  v_mfma_f32_32x32x16_f16 v[112:127], a[80:83], a[112:115], v[112:127]
  s_waitcnt lgkmcnt(2)
  v_mfma_f32_32x32x16_f16 v[112:127], a[84:87], a[116:119], v[112:127]
  s_waitcnt lgkmcnt(1)
  v_mfma_f32_32x32x16_f16 v[112:127], a[88:91], a[120:123], v[112:127]
  s_waitcnt lgkmcnt(0)
  v_mfma_f32_32x32x16_f16 v[112:127], a[92:95], a[124:127], v[112:127]
  s_nop 11
  ds_write2_b32 v45, v112, v113 offset0:0 offset1:1
  ds_write2_b32 v45, v114, v115 offset0:2 offset1:3
  ds_write2_b32 v46, v116, v117 offset0:0 offset1:1
  ds_write2_b32 v47, v118, v119 offset0:0 offset1:1
  ds_write2_b32 v48, v120, v121 offset0:0 offset1:34
  ds_write2_b32 v48, v122, v123 offset0:68 offset1:102
  s_waitcnt lgkmcnt(0)
  s_barrier
  ds_read_b128 v[112:115], v49 offset:0
  ds_read_b128 v[116:119], v49 offset:8704
  ds_read_b128 v[120:123], v49 offset:17408
  ds_read_b128 v[124:127], v49 offset:26112
  ds_write_b128 v29, a[0:3] offset:7424
  s_waitcnt lgkmcnt(3)
  s_memrealtime s[70:71]
  v_add_f32 v112, v112, v116
  v_add_f32 v113, v113, v117
  v_add_f32 v114, v114, v118
  v_add_f32 v115, v115, v119
  s_waitcnt lgkmcnt(1)
  v_add_f32 v120, v120, v124
  v_add_f32 v121, v121, v125
  v_add_f32 v122, v122, v126
  v_add_f32 v123, v123, v127
  v_add_f32 v112, v112, v120
  v_add_f32 v113, v113, v121
  v_add_f32 v114, v114, v122
  v_add_f32 v115, v115, v123
  v_fma_f32 v112, v112, v31, v43
  v_mul_f32 v113, v113, v31
  v_mul_f32 v114, v114, v31
  v_mul_f32 v115, v115, v31
  ds_write_b128 v49, v[112:115]
  s_waitcnt lgkmcnt(0)
  s_barrier
  s_lshl_b32 s42, s68, 1
  s_sub_u32 s42, s42, 1600
  s_waitcnt lgkmcnt(0)
  s_sub_u32 s8, s8, s42
  s_sub_u32 s9, s9, s42
  s_sub_u32 s10, s10, s42
  s_sub_u32 s11, s11, s42
  s_sub_u32 s24, s24, s42
  s_sub_u32 s25, s25, s42
  s_sub_u32 s26, s26, s42
  s_sub_u32 s27, s27, s42
  s_max_u32 s8, s8, s9
  s_max_u32 s10, s10, s11
  s_max_u32 s24, s24, s25
  s_max_u32 s26, s26, s27
  s_max_u32 s8, s8, s10
  s_max_u32 s24, s24, s26
  s_max_u32 s8, s8, s24
  s_cmp_gt_u32 s8, 3200
  s_cbranch_scc1 MC_GS
MC_GT:
  s_add_u32 s8, s8, s42
  s_lshl_b32 s70, s70, 1
  s_sub_u32 s70, s70, s8
  s_cmp_lt_i32 s70, 540
  s_cbranch_scc1 MC_GW
MC_GR:
  ds_read_b32 v112, v32
  ds_read_b32 v113, v33
  buffer_load_dwordx4 v[80:83], v6, s[16:19], s34 offen offset:0 sc1
  ds_read_b32 v114, v34
  ds_read_b32 v115, v35
  buffer_load_dwordx4 v[88:91], v6, s[16:19], s47 offen offset:0 sc1
  ds_read_b32 v116, v36
  ds_read_b32 v117, v37
  buffer_load_dwordx4 v[84:87], v6, s[16:19], s34 offen offset:1024 sc1
  ds_read_b32 v118, v38
  ds_read_b32 v119, v39
  buffer_load_dwordx4 v[92:95], v6, s[16:19], s47 offen offset:1024 sc1
  ds_read_b32 v120, v40
  ds_read_b32 v121, v41
  s_mov_b64 exec, 15
  buffer_load_dwordx4 v[96:99], v7, s[16:19], s39 offen sc1
  s_mov_b64 exec, -1
  ds_read_b32 v122, v42
  s_waitcnt lgkmcnt(0)
  v_cvt_pk_bf16_f32 v32, v112, v113
  v_cvt_pk_bf16_f32 v33, v114, v115
  v_cvt_pk_bf16_f32 v34, v116, v117
  v_cvt_pk_bf16_f32 v35, v118, v119
  ds_write_b128 v49, v[32:35] offset:3328
  v_cvt_pk_bf16_f32 v36, v113, v114
  v_cvt_pk_bf16_f32 v37, v115, v116
  v_cvt_pk_bf16_f32 v38, v117, v118
  v_cvt_pk_bf16_f32 v39, v119, v120
  ds_write_b128 v49, v[36:39] offset:12096
  v_cvt_pk_bf16_f32 v40, v114, v115
  v_cvt_pk_bf16_f32 v41, v116, v117
  v_cvt_pk_bf16_f32 v42, v118, v119
  v_cvt_pk_bf16_f32 v43, v120, v121
  ds_write_b128 v49, v[40:43] offset:20864
  v_cvt_pk_bf16_f32 v44, v115, v116
  v_cvt_pk_bf16_f32 v45, v117, v118
  v_cvt_pk_bf16_f32 v46, v119, v120
  v_cvt_pk_bf16_f32 v47, v121, v122
  ds_write_b128 v49, v[44:47] offset:29632
  s_lshr_b32 s25, s3, 3
  s_lshl1_add_u32 s25, s25, s28
  s_mul_i32 s25, s25, 20
  s_add_u32 s25, s25, 2016
  v_min_u32 v21, 19, v2
  v_add_u32 v21, s25, v21
  v_mul_u32_u24 v4, 9363, v21
  v_lshrrev_b32 v4, 16, v4
  v_mul_u32_u24 v4, 2688, v4
  v_lshl_add_u32 v4, v21, 7, v4
  s_waitcnt vmcnt(5)
  s_waitcnt lgkmcnt(0)
  s_barrier
  s_lshl_b32 s25, s3, 6
  s_add_u32 s25, s25, 40960
  s_cmp_lg_u32 s4, 3
  s_cbranch_scc1 MC_NOF
  s_mov_b64 exec, 1
  buffer_store_dword v30, off, s[16:19], s25 sc1
  s_mov_b64 exec, -1
MC_NOF:
  buffer_load_dword v4, v4, s[12:15], s36 offen
  ds_read_b64 a[84:85], v8 offset:3840
  ds_read_b64 a[86:87], v8 offset:3848
  ds_read_b64 a[88:89], v8 offset:3584
  ds_read_b64 a[90:91], v8 offset:3592
  ds_read_b64 a[92:93], v8 offset:3328
  ds_read_b64 a[94:95], v8 offset:3336
  ds_read_b64 a[96:97], v8 offset:3072
  ds_read_b64 a[98:99], v8 offset:3080
  ds_read_b64 a[100:101], v8 offset:2816
  ds_read_b64 a[102:103], v8 offset:2824
  ds_read_b64 a[104:105], v8 offset:2560
  ds_read_b64 a[106:107], v8 offset:2568
  ds_read_b64 a[108:109], v8 offset:2304
  ds_read_b64 a[110:111], v8 offset:2312
  ds_read_b64 a[112:113], v8 offset:2048
  ds_read_b64 a[114:115], v8 offset:2056
  ds_read_b64 a[116:117], v8 offset:1792
  ds_read_b64 a[118:119], v8 offset:1800
  ds_read_b64 a[120:121], v8 offset:1536
  ds_read_b64 a[122:123], v8 offset:1544
  ds_read_b64 a[124:125], v8 offset:1280
  ds_read_b64 a[126:127], v8 offset:1288
  ds_read_b64 v[108:109], v8 offset:1024
  ds_read_b64 v[110:111], v8 offset:1032
  ds_read_b64 v[112:113], v8 offset:768
  ds_read_b64 v[114:115], v8 offset:776
  ds_read_b64 v[116:117], v8 offset:512
  ds_read_b64 v[118:119], v8 offset:520
  ds_read_b64 v[120:121], v8 offset:256
  ds_read_b64 v[122:123], v8 offset:264
  ds_read_b64 v[124:125], v8 offset:0
  ds_read_b64 v[126:127], v8 offset:8
  s_lshr_b32 s27, s4, 1
  v_lshrrev_b32 v21, 3, v2
  v_and_b32 v22, 7, v2
  v_and_b32 v23, 2, v21
  v_xor_b32 v22, v22, v23
  s_lshr_b32 s25, s32, 1
  s_lshl_b32 s25, s25, 2
  v_xor_b32 v22, s25, v22
  v_mul_u32_u24 v15, 3584, v21
  v_lshl_add_u32 v15, v22, 4, v15
  s_lshl_b32 s37, s6, 7
  s_lshl_b32 s61, s51, 1
  s_mul_i32 s25, s28, 28672
  s_add_u32 s37, s37, s25
  s_lshl_b32 s38, s32, 10
  s_add_u32 s40, s37, 0
  s_lshl_b32 s41, s4, 10
  s_add_u32 s41, s41, 87040
  s_lshl_b32 s26, s4, 9
  s_add_u32 s26, s26, 69632
  v_lshl_add_u32 v17, v2, 2, s26
  v_bfe_u32 v21, v2, 4, 1
  v_bfe_u32 v22, v2, 2, 2
  v_lshl_add_u32 v23, v21, 1, v3
  v_lshlrev_b32 v16, 10, v23
  v_lshl_add_u32 v16, v22, 7, v16
  v_lshrrev_b32 v22, 1, v22
  v_lshl_add_u32 v22, v21, 1, v22
  v_xor_b32 v22, s32, v22
  v_lshl_add_u32 v16, v22, 5, v16
  v_and_b32 v22, 3, v2
  v_lshl_add_u32 v16, v22, 3, v16
  v_add_u32 v16, 87040, v16
  v_bfe_u32 v12, v2, 3, 1
  v_mul_u32_u24 v12, 896, v12
  v_lshl_add_u32 v12, v3, 4, v12
  v_lshrrev_b32 v13, 2, v2
  v_xor_b32 v13, v13, v2
  v_and_b32 v13, 4, v13
  v_cmp_eq_u32 s[42:43], 0, v13
  v_mov_b32 v13, 2048
  v_bfe_u32 v21, v2, 2, 2
  v_cndmask_b32_e64 v12, v13, v12, s[42:43]
  v_add_u32 v12, 160768, v12
  v_lshl_add_u32 v21, v3, 3, v21
  v_lshlrev_b32 v22, 6, v21
  v_bfe_u32 v21, v2, 4, 1
  v_lshl_add_u32 v22, v21, 5, v22
  v_and_b32 v21, 3, v2
  v_lshl_add_u32 v22, v21, 3, v22
  v_add_u32 v23, 61440, v22
  v_add_u32 v14, 122880, v22
  v_add_u32 v18, s38, v6
  v_add_u32 v19, 61440, v18
  v_add_u32 v13, 122880, v18
  v_and_b32 v10, 31, v2
  v_lshlrev_b32 v10, 2, v10
  v_add_u32 v10, 162816, v10
  v_add_u32 v21, 61440, v16
  v_subrev_u32 v1, 87040, v16
  s_waitcnt vmcnt(2)
  v_subrev_u32 v64, s69, v81
  v_subrev_u32 v65, s69, v83
  v_subrev_u32 v66, s69, v85
  v_subrev_u32 v67, s69, v87
  v_subrev_u32 v68, s69, v89
  v_subrev_u32 v69, s69, v91
  v_subrev_u32 v70, s69, v93
  v_subrev_u32 v71, s69, v95
  v_max3_u32 v64, v64, v65, v66
  v_max3_u32 v67, v67, v68, v69
  v_max_u32 v70, v70, v71
  v_max3_u32 v64, v64, v67, v70
  v_cmp_lt_u32 vcc, 16, v64
  s_cbranch_vccnz MC_SLOW0
MC_RET0:
  s_mov_b32 s42, 0x05040100
  s_mov_b32 s43, 0x07060302
  s_mov_b64 exec, 15
  s_waitcnt vmcnt(1)
  v_subrev_u32 v97, s69, v97
  v_subrev_u32 v99, s69, v99
  v_max_u32 v97, v97, v99
  v_cmp_lt_u32 vcc, 16, v97
  s_cbranch_vccnz MC_SLOW1
MC_RET1:
  v_add_f32 v96, v96, v98
  v_cvt_pk_bf16_f32 v96, 0, v96
  s_mov_b64 exec, -1
  v_readlane_b32 s44, v96, 0
  v_readlane_b32 s45, v96, 1
  v_readlane_b32 s48, v96, 2
  v_readlane_b32 s49, v96, 3
  v_lshlrev_b32 v72, 16, v88
  v_lshlrev_b32 v73, 16, v90
  v_lshlrev_b32 v74, 16, v92
  v_lshlrev_b32 v75, 16, v94
  v_rcp_f32 v72, v72
  v_and_b32 v88, 0xffff0000, v88
  s_add_u32 m0, s41, 65536
  s_add_u32 s25, s40, 917504
  buffer_load_dwordx4 v15, s[12:15], s25 offen  lds
  v_rcp_f32 v73, v73
  v_and_b32 v90, 0xffff0000, v90
  v_rcp_f32 v74, v74
  v_and_b32 v92, 0xffff0000, v92
  v_rcp_f32 v75, v75
  v_and_b32 v94, 0xffff0000, v94
  s_lshl_b32 s25, s61, 13
  s_add_u32 m0, s41, s25
  s_mul_i32 s25, s61, 114688
  s_add_u32 s25, s25, s40
  buffer_load_dwordx4 v15, s[12:15], s25 offen  lds
  s_add_u32 s61, s61, 1
  s_and_b32 s61, s61, 7
  v_lshlrev_b32 v64, 16, v80
  v_and_b32 v65, 0xffff0000, v80
  v_lshlrev_b32 v66, 16, v82
  v_and_b32 v67, 0xffff0000, v82
  v_lshlrev_b32 v68, 16, v84
  v_and_b32 v69, 0xffff0000, v84
  s_lshl_b32 s25, s61, 13
  s_add_u32 m0, s41, s25
  s_mul_i32 s25, s61, 114688
  s_add_u32 s25, s25, s40
  buffer_load_dwordx4 v15, s[12:15], s25 offen  lds
  s_add_u32 s61, s61, 1
  s_and_b32 s61, s61, 7
  v_lshlrev_b32 v70, 16, v86
  v_and_b32 v71, 0xffff0000, v86
  v_sub_f32 v64, v64, v88
  v_sub_f32 v65, v65, v88
  v_sub_f32 v66, v66, v90
  v_sub_f32 v67, v67, v90
  s_lshl_b32 s25, s61, 13
  s_add_u32 m0, s41, s25
  s_mul_i32 s25, s61, 114688
  s_add_u32 s25, s25, s40
  buffer_load_dwordx4 v15, s[12:15], s25 offen  lds
  s_add_u32 s61, s61, 1
  s_and_b32 s61, s61, 7
  v_sub_f32 v68, v68, v92
  v_sub_f32 v69, v69, v92
  v_sub_f32 v70, v70, v94
  v_sub_f32 v71, v71, v94
  v_mul_f32 v100, s48, v72
  v_mul_f32 v101, s49, v72
  s_lshl_b32 s25, s61, 13
  s_add_u32 m0, s41, s25
  s_mul_i32 s25, s61, 114688
  s_add_u32 s25, s25, s40
  buffer_load_dwordx4 v15, s[12:15], s25 offen  lds
  s_add_u32 s61, s61, 1
  s_and_b32 s61, s61, 7
  v_mul_f32 v102, s48, v73
  v_mul_f32 v103, s49, v73
  v_mul_f32 v104, s48, v74
  v_mul_f32 v105, s49, v74
  v_mul_f32 v106, s48, v75
  v_mul_f32 v107, s49, v75
  v_fma_f32 v64, v64, v100, s44
  v_fma_f32 v65, v65, v101, s45
  v_fma_f32 v66, v66, v102, s44
  v_fma_f32 v67, v67, v103, s45
  v_fma_f32 v68, v68, v104, s44
  v_fma_f32 v69, v69, v105, s45
  v_fma_f32 v70, v70, v106, s44
  v_fma_f32 v71, v71, v107, s45
  v_cvt_pk_bf16_f32 v50, v64, v66
  v_cvt_pk_bf16_f32 v51, v68, v70
  ds_write2st64_b32 v17, v50, v51 offset0:2 offset1:3
  v_cvt_pk_bf16_f32 v52, v65, v67
  v_cvt_pk_bf16_f32 v53, v69, v71
  ds_write2st64_b32 v17, v52, v53 offset0:20 offset1:21
  v_perm_b32 v54, v82, v80, s42
  v_perm_b32 v55, v86, v84, s42
  ds_write2st64_b32 v17, v54, v55 offset0:36 offset1:37
  v_perm_b32 v56, v82, v80, s43
  v_perm_b32 v57, v86, v84, s43
  ds_write2st64_b32 v17, v56, v57 offset0:52 offset1:53
  s_waitcnt lgkmcnt(0)
  s_barrier
  ds_read_b128 v[44:47], v9 offset:256
  ds_read_b128 v[48:51], v9 offset:0
  ds_read_b128 v[52:55], v9 offset:768
  ds_read_b128 v[56:59], v9 offset:512
  s_waitcnt lgkmcnt(3)
  v_mfma_f32_16x16x32_bf16 v[28:31], a[84:87], v[44:47], 0
  s_lshr_b32 s44, s3, 3
  s_mul_i32 s59, s44, 37
  s_lshr_b32 s59, s59, 8
  v_mfma_f32_16x16x32_bf16 v[32:35], a[92:95], v[44:47], 0
  s_mul_i32 s58, s59, 7
  s_sub_u32 s58, s44, s58
  s_and_b32 s44, s58, 3
  s_waitcnt lgkmcnt(2)
  v_mfma_f32_16x16x32_bf16 v[28:31], a[88:91], v[48:51], v[28:31]
  s_lshl_b32 s44, s44, 3
  s_lshr_b32 s44, 0x2d78b1e4, s44
  s_add_u32 s45, s5, 32
  v_mfma_f32_16x16x32_bf16 v[32:35], a[96:99], v[48:51], v[32:35]
  s_add_u32 s50, s5, 0
  s_add_u32 s51, s5, 8
  s_add_u32 s52, s5, 16
  s_waitcnt lgkmcnt(1)
  v_mfma_f32_16x16x32_bf16 v[32:35], a[84:87], v[52:55], v[32:35]
  s_add_u32 s53, s5, 24
  s_bfe_u32 s54, s44, 0x20000
  s_lshl3_add_u32 s54, s54, s45
  s_waitcnt lgkmcnt(0)
  v_mfma_f32_16x16x32_bf16 v[32:35], a[88:91], v[56:59], v[32:35]
  s_bfe_u32 s55, s44, 0x20002
  s_lshl3_add_u32 s55, s55, s45
  s_bfe_u32 s56, s44, 0x20004
  v_mfma_f32_16x16x32_bf16 v[36:39], a[100:103], v[44:47], 0
  ds_read_b128 v[60:63], v9 offset:1280
  ds_read_b128 v[64:67], v9 offset:1024
  ds_read_b128 v[68:71], v9 offset:1792
  v_mfma_f32_16x16x32_bf16 v[40:43], a[108:111], v[44:47], 0
  ds_write_b128 v11, v[28:31] offset:0
  ds_write_b128 v11, v[32:35] offset:1024
  ds_read_b128 v[72:75], v9 offset:1536
  v_mfma_f32_16x16x32_bf16 v[36:39], a[104:107], v[48:51], v[36:39]
  s_waitcnt vmcnt(4) lgkmcnt(1)
  s_barrier
  ds_read_b64_tr_b16 a[64:65], v21 offset:4096
  ds_read_b64_tr_b16 a[66:67], v21 offset:4608
  v_mfma_f32_16x16x32_bf16 v[40:43], a[112:115], v[48:51], v[40:43]
  s_lshl_b32 s25, s61, 13
  s_add_u32 m0, s41, s25
  s_mul_i32 s25, s61, 114688
  s_add_u32 s25, s25, s40
  buffer_load_dwordx4 v15, s[12:15], s25 offen  lds
  s_add_u32 s61, s61, 1
  s_and_b32 s61, s61, 7
  ds_read_b64_tr_b16 a[68:69], v21 offset:8192
  ds_read_b64_tr_b16 a[70:71], v21 offset:8704
  ds_read_b128 v[76:79], v9 offset:2304
  v_mfma_f32_16x16x32_bf16 v[36:39], a[92:95], v[52:55], v[36:39]
  s_lshl_b32 s25, s61, 13
  s_add_u32 m0, s41, s25
  s_mul_i32 s25, s61, 114688
  s_add_u32 s25, s25, s40
  buffer_load_dwordx4 v15, s[12:15], s25 offen  lds
  s_add_u32 s61, s61, 1
  s_and_b32 s61, s61, 7
  ds_read_b128 v[80:83], v9 offset:2048
  ds_read_b128 v[84:87], v9 offset:2816
  ds_read_b128 v[88:91], v9 offset:2560
  v_mfma_f32_16x16x32_bf16 v[40:43], a[100:103], v[52:55], v[40:43]
  s_lshl_b32 s25, s61, 13
  s_add_u32 m0, s41, s25
  s_mul_i32 s25, s61, 114688
  s_add_u32 s25, s25, s40
  buffer_load_dwordx4 v15, s[12:15], s25 offen  lds
  s_add_u32 s61, s61, 1
  s_and_b32 s61, s61, 7
  s_lshl3_add_u32 s56, s56, s45
  s_bfe_u32 s57, s44, 0x20006
  s_lshl3_add_u32 s57, s57, s45
  v_mfma_f32_16x16x32_bf16 v[36:39], a[96:99], v[56:59], v[36:39]
  s_lshl_b32 s25, s61, 13
  s_add_u32 m0, s41, s25
  s_mul_i32 s25, s61, 114688
  s_add_u32 s25, s25, s40
  buffer_load_dwordx4 v15, s[12:15], s25 offen  lds
  s_lshl2_add_u32 s35, s6, s4
  s_lshl_b32 s35, s35, 10
  s_add_u32 s35, s35, 7536640
  v_mfma_f32_16x16x32_bf16 v[40:43], a[104:107], v[56:59], v[40:43]
  s_add_u32 m0, s38, 3328
  s_add_u32 s25, s37, 1032192
  buffer_load_dwordx4 v15, s[12:15], s25 offen  lds
  s_mul_i32 s34, s5, 114688
  s_add_u32 s34, s34, s35
  v_cmp_eq_u32 s[42:43], 0, v3
  v_mfma_f32_16x16x32_bf16 v[36:39], a[84:87], v[60:63], v[36:39]
  s_add_u32 m0, s38, 12096
  s_add_u32 s25, s37, 1089536
  buffer_load_dwordx4 v15, s[12:15], s25 offen  lds
  v_mfma_f32_16x16x32_bf16 v[40:43], a[92:95], v[60:63], v[40:43]
  s_add_u32 m0, s38, 20864
  s_add_u32 s25, s37, 1146880
  buffer_load_dwordx4 v15, s[12:15], s25 offen  lds
  v_mfma_f32_16x16x32_bf16 v[36:39], a[88:91], v[64:67], v[36:39]
  s_add_u32 m0, s38, 29632
  s_add_u32 s25, s37, 1204224
  buffer_load_dwordx4 v15, s[12:15], s25 offen  lds
  v_mfma_f32_16x16x32_bf16 v[40:43], a[96:99], v[64:67], v[40:43]
  s_add_u32 m0, s38, 38144
  s_add_u32 s25, s37, 1261568
  buffer_load_dwordx4 v15, s[12:15], s25 offen  lds
  v_mfma_f32_16x16x32_bf16 v[40:43], a[84:87], v[68:71], v[40:43]
  s_add_u32 m0, s38, 46912
  s_add_u32 s25, s37, 1318912
  buffer_load_dwordx4 v15, s[12:15], s25 offen  lds
  s_waitcnt lgkmcnt(8)
  v_mfma_f32_16x16x32_bf16 v[40:43], a[88:91], v[72:75], v[40:43]
  s_add_u32 m0, s38, 55680
  s_add_u32 s25, s37, 1376256
  buffer_load_dwordx4 v15, s[12:15], s25 offen  lds
  v_mfma_f32_16x16x32_bf16 v[28:31], a[116:119], v[44:47], 0
  ds_read_b128 v[92:95], v9 offset:3328
  ds_read_b128 v[96:99], v9 offset:3072
  ds_read_b128 v[100:103], v9 offset:3840
  v_mfma_f32_16x16x32_bf16 v[32:35], a[124:127], v[44:47], 0
  ds_write_b128 v11, v[36:39] offset:2048
  ds_write_b128 v11, v[40:43] offset:7680
  ds_read_b128 v[104:107], v9 offset:3584
  v_mfma_f32_16x16x32_bf16 v[28:31], a[120:123], v[48:51], v[28:31]
  s_waitcnt vmcnt(7) lgkmcnt(1)
  s_barrier
  ds_read_b64_tr_b16 a[0:1], v16 offset:0
  ds_read_b64_tr_b16 a[2:3], v16 offset:512
  v_mfma_f32_16x16x32_bf16 v[32:35], v[108:111], v[48:51], v[32:35]
  s_add_u32 m0, s38, 64448
  s_add_u32 s25, s37, 1433600
  buffer_load_dwordx4 v15, s[12:15], s25 offen  lds
  ds_read_b64_tr_b16 a[4:5], v16 offset:4096
  ds_read_b64_tr_b16 a[6:7], v16 offset:4608
  ds_read_b64_tr_b16 a[8:9], v16 offset:8192
  v_mfma_f32_16x16x32_bf16 v[28:31], a[108:111], v[52:55], v[28:31]
  s_add_u32 m0, s38, 152576
  s_add_u32 s25, s37, 1490944
  buffer_load_dwordx4 v15, s[12:15], s25 offen  lds
  ds_read_b64_tr_b16 a[10:11], v16 offset:8704
  ds_read_b64_tr_b16 a[12:13], v16 offset:12288
  ds_read_b64_tr_b16 a[14:15], v16 offset:12800
  v_mfma_f32_16x16x32_bf16 v[32:35], a[116:119], v[52:55], v[32:35]
  s_add_u32 m0, s38, 156672
  s_add_u32 s25, s37, 1548288
  buffer_load_dwordx4 v15, s[12:15], s25 offen  lds
  ds_read_b64_tr_b16 a[16:17], v16 offset:16384
  ds_read_b64_tr_b16 a[18:19], v16 offset:16896
  ds_read_b64_tr_b16 a[20:21], v16 offset:20480
  v_mfma_f32_16x16x32_bf16 v[28:31], a[112:115], v[56:59], v[28:31]
  ds_read_b64_tr_b16 a[22:23], v16 offset:20992
  ds_read_b64_tr_b16 a[24:25], v16 offset:24576
  ds_read_b64_tr_b16 a[26:27], v16 offset:25088
  v_mfma_f32_16x16x32_bf16 v[32:35], a[120:123], v[56:59], v[32:35]
  ds_read_b64_tr_b16 a[28:29], v16 offset:28672
  ds_read_b64_tr_b16 a[30:31], v16 offset:29184
  ds_read_b64_tr_b16 a[32:33], v16 offset:32768
  v_mfma_f32_16x16x32_bf16 v[28:31], a[100:103], v[60:63], v[28:31]
  ds_read_b64_tr_b16 a[34:35], v16 offset:33280
  ds_read_b64_tr_b16 a[36:37], v16 offset:36864
  ds_read_b64_tr_b16 a[38:39], v16 offset:37376
  v_mfma_f32_16x16x32_bf16 v[32:35], a[108:111], v[60:63], v[32:35]
  ds_read_b64_tr_b16 a[40:41], v16 offset:40960
  ds_read_b64_tr_b16 a[42:43], v16 offset:41472
  ds_read_b64_tr_b16 a[44:45], v16 offset:45056
  v_mfma_f32_16x16x32_bf16 v[28:31], a[104:107], v[64:67], v[28:31]
  ds_read_b64_tr_b16 a[46:47], v16 offset:45568
  ds_read_b64_tr_b16 a[48:49], v16 offset:49152
  ds_read_b64_tr_b16 a[50:51], v16 offset:49664
  v_mfma_f32_16x16x32_bf16 v[32:35], a[112:115], v[64:67], v[32:35]
  ds_read_b64_tr_b16 a[52:53], v16 offset:53248
  ds_read_b64_tr_b16 a[54:55], v16 offset:53760
  ds_read_b64_tr_b16 a[56:57], v16 offset:57344
  v_mfma_f32_16x16x32_bf16 v[28:31], a[92:95], v[68:71], v[28:31]
  ds_read_b64_tr_b16 a[58:59], v16 offset:57856
  ds_read_b64_tr_b16 a[60:61], v21 offset:0
  ds_read_b64_tr_b16 a[62:63], v21 offset:512
  v_mfma_f32_16x16x32_bf16 v[32:35], a[100:103], v[68:71], v[32:35]
  v_mfma_f32_16x16x32_bf16 v[28:31], a[96:99], v[72:75], v[28:31]
  v_mfma_f32_16x16x32_bf16 v[32:35], a[104:107], v[72:75], v[32:35]
  v_mfma_f32_16x16x32_bf16 v[28:31], a[84:87], v[76:79], v[28:31]
  v_mfma_f32_16x16x32_bf16 v[32:35], a[92:95], v[76:79], v[32:35]
  v_mfma_f32_16x16x32_bf16 v[28:31], a[88:91], v[80:83], v[28:31]
  v_mfma_f32_16x16x32_bf16 v[32:35], a[96:99], v[80:83], v[32:35]
  v_mfma_f32_16x16x32_bf16 v[32:35], a[84:87], v[84:87], v[32:35]
  v_mfma_f32_16x16x32_bf16 v[32:35], a[88:91], v[88:91], v[32:35]
  v_mfma_f32_16x16x32_bf16 v[36:39], v[112:115], v[44:47], 0
  v_mfma_f32_16x16x32_bf16 v[40:43], v[120:123], v[44:47], 0
  s_nop 2
  ds_write_b128 v11, v[28:31] offset:0
  s_nop 1
  ds_write_b128 v11, v[32:35] offset:1024
  v_mfma_f32_16x16x32_bf16 v[36:39], v[116:119], v[48:51], v[36:39]
  s_waitcnt vmcnt(0) lgkmcnt(0)
  s_barrier
  ds_read_b64_tr_b16 a[72:73], v1 offset:3328
  ds_read_b64_tr_b16 a[74:75], v1 offset:3840
  v_mfma_f32_16x16x32_bf16 v[40:43], v[124:127], v[48:51], v[40:43]
  ds_read_b64_tr_b16 a[76:77], v1 offset:12096
  ds_read_b64_tr_b16 a[78:79], v1 offset:12608
  ds_read_b64_tr_b16 a[80:81], v1 offset:20864
  v_mfma_f32_16x16x32_bf16 v[36:39], a[124:127], v[52:55], v[36:39]
  ds_read_b64_tr_b16 a[82:83], v1 offset:21376
  v_mfma_f32_16x16x32_bf16 v[40:43], v[112:115], v[52:55], v[40:43]
  v_mfma_f32_16x16x32_bf16 v[36:39], v[108:111], v[56:59], v[36:39]
  v_mfma_f32_16x16x32_bf16 v[40:43], v[116:119], v[56:59], v[40:43]
  v_mfma_f32_16x16x32_bf16 v[36:39], a[116:119], v[60:63], v[36:39]
  v_mfma_f32_16x16x32_bf16 v[40:43], a[124:127], v[60:63], v[40:43]
  v_mfma_f32_16x16x32_bf16 v[36:39], a[120:123], v[64:67], v[36:39]
  v_mfma_f32_16x16x32_bf16 v[40:43], v[108:111], v[64:67], v[40:43]
  v_mfma_f32_16x16x32_bf16 v[36:39], a[108:111], v[68:71], v[36:39]
  v_mfma_f32_16x16x32_bf16 v[40:43], a[116:119], v[68:71], v[40:43]
  v_mfma_f32_16x16x32_bf16 v[36:39], a[112:115], v[72:75], v[36:39]
  s_mul_i32 s36, s52, 114688
  s_add_u32 s36, s36, s35
  buffer_store_dwordx4 v[24:27], v6, s[16:19], s36 offen sc1
  v_mfma_f32_16x16x32_bf16 v[40:43], a[120:123], v[72:75], v[40:43]
  v_mfma_f32_16x16x32_bf16 v[36:39], a[100:103], v[76:79], v[36:39]
  v_mfma_f32_16x16x32_bf16 v[40:43], a[108:111], v[76:79], v[40:43]
  s_mul_i32 s36, s53, 114688
  s_add_u32 s36, s36, s35
  buffer_store_dwordx4 v[24:27], v6, s[16:19], s36 offen sc1
  v_mfma_f32_16x16x32_bf16 v[36:39], a[104:107], v[80:83], v[36:39]
  v_mfma_f32_16x16x32_bf16 v[40:43], a[112:115], v[80:83], v[40:43]
  v_mfma_f32_16x16x32_bf16 v[36:39], a[92:95], v[84:87], v[36:39]
  s_mul_i32 s36, s55, 114688
  s_add_u32 s36, s36, s35
  buffer_store_dwordx4 v[24:27], v6, s[16:19], s36 offen sc1
  v_mfma_f32_16x16x32_bf16 v[40:43], a[100:103], v[84:87], v[40:43]
  v_mfma_f32_16x16x32_bf16 v[36:39], a[96:99], v[88:91], v[36:39]
  v_mfma_f32_16x16x32_bf16 v[40:43], a[104:107], v[88:91], v[40:43]
  s_mul_i32 s36, s56, 114688
  s_add_u32 s36, s36, s35
  buffer_store_dwordx4 v[24:27], v6, s[16:19], s36 offen sc1
  v_mfma_f32_16x16x32_bf16 v[36:39], a[84:87], v[92:95], v[36:39]
  v_mfma_f32_16x16x32_bf16 v[40:43], a[92:95], v[92:95], v[40:43]
  v_mfma_f32_16x16x32_bf16 v[36:39], a[88:91], v[96:99], v[36:39]
  s_mul_i32 s36, s57, 114688
  s_add_u32 s36, s36, s35
  buffer_store_dwordx4 v[24:27], v6, s[16:19], s36 offen sc1
  v_mfma_f32_16x16x32_bf16 v[40:43], a[96:99], v[96:99], v[40:43]
  v_mfma_f32_16x16x32_bf16 v[40:43], a[84:87], v[100:103], v[40:43]
  v_mfma_f32_16x16x32_bf16 v[40:43], a[88:91], v[104:107], v[40:43]
  s_nop 1
  ds_write_b128 v11, v[36:39] offset:2048
  s_nop 4
  ds_write_b128 v11, v[40:43] offset:7680
  ds_read_b64_tr_b16 a[84:85], v1 offset:29632
  ds_read_b64_tr_b16 a[86:87], v1 offset:30144
  ds_read_b64_tr_b16 a[88:89], v1 offset:38144
  ds_read_b64_tr_b16 a[90:91], v1 offset:38656
  ds_read_b64_tr_b16 a[92:93], v1 offset:46912
  ds_read_b64_tr_b16 a[94:95], v1 offset:47424
  ds_read_b64_tr_b16 a[96:97], v1 offset:55680
  ds_read_b64_tr_b16 a[98:99], v1 offset:56192
  ds_read_b64_tr_b16 a[100:101], v1 offset:64448
  ds_read_b64_tr_b16 a[102:103], v1 offset:64960
  ds_read_b64_tr_b16 a[104:105], v21 offset:4096
  ds_read_b64_tr_b16 a[106:107], v21 offset:4608
  ds_read_b64_tr_b16 a[108:109], v21 offset:8192
  ds_read_b64_tr_b16 a[110:111], v21 offset:8704
  s_waitcnt lgkmcnt(14)
  s_barrier
  ds_read_b128 v[64:67], v12 offset:0
  ds_read_b128 v[68:71], v12 offset:32
  ds_read_b128 v[72:75], v12 offset:64
  ds_read_b128 v[76:79], v12 offset:96
  ds_read_b128 v[80:83], v12 offset:128
  ds_read_b128 v[84:87], v12 offset:160
  ds_read_b128 v[88:91], v12 offset:192
  ds_read_b128 v[92:95], v12 offset:224
  s_waitcnt lgkmcnt(7)
  v_mfma_f32_16x16x32_bf16 v[120:123], v[64:67], a[0:3], 0
  ds_read_b128 v[96:99], v12 offset:256
  s_waitcnt lgkmcnt(7)
  v_mfma_f32_16x16x32_bf16 v[124:127], v[68:71], a[4:7], 0
  ds_read_b128 v[100:103], v12 offset:288
  s_and_b32 s26, s3, 3
  s_mov_b32 s60, 0x3516240
  s_cmp_eq_u32 s26, 1
  s_cselect_b32 s60, 0x6204315, s60
  s_cmp_eq_u32 s26, 2
  s_cselect_b32 s60, 0x1504326, s60
  s_waitcnt lgkmcnt(7)
  v_mfma_f32_16x16x32_bf16 v[120:123], v[72:75], a[8:11], v[120:123]
  ds_read_b128 v[64:67], v12 offset:320
  s_waitcnt lgkmcnt(7)
  v_mfma_f32_16x16x32_bf16 v[124:127], v[76:79], a[12:15], v[124:127]
  ds_read_b128 v[68:71], v12 offset:352
  s_cmp_eq_u32 s26, 3
  s_cselect_b32 s60, 0x4026513, s60
  s_mul_i32 s25, s32, 28672
  s_mul_i32 s61, s58, 229376
  s_add_u32 s61, s61, s25
  s_add_u32 s61, s61, 5898240
  s_waitcnt lgkmcnt(7)
  v_mfma_f32_16x16x32_bf16 v[120:123], v[80:83], a[16:19], v[120:123]
  ds_read_b128 v[72:75], v12 offset:384
  s_waitcnt lgkmcnt(7)
  v_mfma_f32_16x16x32_bf16 v[124:127], v[84:87], a[20:23], v[124:127]
  ds_read_b128 v[76:79], v12 offset:416
  s_and_b32 s24, s3, 4
  s_add_u32 s24, s24, s59
  s_lshl3_add_u32 s24, s26, s24
  s_mul_i32 s44, s24, 114688
  s_add_u32 s44, s44, s25
  s_add_u32 s44, s44, 7536640
  s_add_u32 s45, s44, 3670016
  s_waitcnt lgkmcnt(7)
  v_mfma_f32_16x16x32_bf16 v[120:123], v[88:91], a[24:27], v[120:123]
  ds_read_b128 v[80:83], v12 offset:448
  s_waitcnt lgkmcnt(7)
  v_mfma_f32_16x16x32_bf16 v[124:127], v[92:95], a[28:31], v[124:127]
  ds_read_b128 v[84:87], v12 offset:480
  v_mov_b32 v15, v10
  s_waitcnt lgkmcnt(7)
  v_mfma_f32_16x16x32_bf16 v[120:123], v[96:99], a[32:35], v[120:123]
  ds_read_b128 v[88:91], v12 offset:512
  s_waitcnt lgkmcnt(7)
  v_mfma_f32_16x16x32_bf16 v[124:127], v[100:103], a[36:39], v[124:127]
  ds_read_b128 v[92:95], v12 offset:544
  s_waitcnt lgkmcnt(7)
  v_mfma_f32_16x16x32_bf16 v[120:123], v[64:67], a[40:43], v[120:123]
  ds_read_b128 v[96:99], v12 offset:576
  s_waitcnt lgkmcnt(7)
  v_mfma_f32_16x16x32_bf16 v[124:127], v[68:71], a[44:47], v[124:127]
  ds_read_b128 v[100:103], v12 offset:608
  s_waitcnt lgkmcnt(7)
  v_mfma_f32_16x16x32_bf16 v[120:123], v[72:75], a[48:51], v[120:123]
  ds_read_b128 v[64:67], v12 offset:640
  s_waitcnt lgkmcnt(7)
  v_mfma_f32_16x16x32_bf16 v[124:127], v[76:79], a[52:55], v[124:127]
  ds_read_b128 v[68:71], v12 offset:672
  s_waitcnt lgkmcnt(7)
  v_mfma_f32_16x16x32_bf16 v[120:123], v[80:83], a[56:59], v[120:123]
  ds_read_b128 v[72:75], v12 offset:704
  s_waitcnt lgkmcnt(7)
  v_mfma_f32_16x16x32_bf16 v[124:127], v[84:87], a[60:63], v[124:127]
  ds_read_b128 v[76:79], v12 offset:736
  s_waitcnt lgkmcnt(7)
  v_mfma_f32_16x16x32_bf16 v[120:123], v[88:91], a[64:67], v[120:123]
  ds_read_b128 v[80:83], v12 offset:768
  s_waitcnt lgkmcnt(7)
  v_mfma_f32_16x16x32_bf16 v[124:127], v[92:95], a[68:71], v[124:127]
  ds_read_b128 v[84:87], v12 offset:800
  s_waitcnt lgkmcnt(7)
  v_mfma_f32_16x16x32_bf16 v[120:123], v[96:99], a[72:75], v[120:123]
  ds_read_b128 v[88:91], v12 offset:832
  s_waitcnt lgkmcnt(7)
  v_mfma_f32_16x16x32_bf16 v[124:127], v[100:103], a[76:79], v[124:127]
  ds_read_b128 v[92:95], v12 offset:864
  s_waitcnt lgkmcnt(7)
  v_mfma_f32_16x16x32_bf16 v[120:123], v[64:67], a[80:83], v[120:123]
  s_waitcnt lgkmcnt(6)
  v_mfma_f32_16x16x32_bf16 v[124:127], v[68:71], a[84:87], v[124:127]
  s_waitcnt lgkmcnt(5)
  v_mfma_f32_16x16x32_bf16 v[120:123], v[72:75], a[88:91], v[120:123]
  s_waitcnt lgkmcnt(4)
  v_mfma_f32_16x16x32_bf16 v[124:127], v[76:79], a[92:95], v[124:127]
  s_waitcnt lgkmcnt(3)
  v_mfma_f32_16x16x32_bf16 v[120:123], v[80:83], a[96:99], v[120:123]
  s_waitcnt lgkmcnt(2)
  v_mfma_f32_16x16x32_bf16 v[124:127], v[84:87], a[100:103], v[124:127]
  s_waitcnt lgkmcnt(1)
  v_mfma_f32_16x16x32_bf16 v[120:123], v[88:91], a[104:107], v[120:123]
  s_waitcnt lgkmcnt(0)
  v_mfma_f32_16x16x32_bf16 v[124:127], v[92:95], a[108:111], v[124:127]
  v_mov_b32 v114, 0
  v_mov_b32 v115, 0
  v_mov_b32 v118, 0
  v_mov_b32 v119, 0
  s_nop 3
  v_add_f32 v120, v120, v124
  v_cndmask_b32_e64 v52, v120, -v120, s[42:43]
  v_cvt_pk_bf16_f32 v53, 0, v52
  v_sub_f32 v52, v52, v53
  v_cvt_pk_bf16_f32 v54, 0, v52
  v_sub_f32 v52, v52, v54
  v_cvt_pk_bf16_f32 v113, v52, 0
  v_lshrrev_b32 v53, 16, v53
  v_or_b32 v112, v53, v54
  s_barrier
  s_setprio 2
  ds_read_b64_tr_b16 a[112:113], v23 offset:25600
  ds_read_b64_tr_b16 a[114:115], v23 offset:25856
  ds_read_b64_tr_b16 a[116:117], v23 offset:26624
  ds_read_b64_tr_b16 a[118:119], v23 offset:26880
  ds_read_b64_tr_b16 a[120:121], v23 offset:27648
  ds_read_b64_tr_b16 a[122:123], v23 offset:27904
  ds_read_b64_tr_b16 a[124:125], v23 offset:28672
  ds_read_b64_tr_b16 a[126:127], v23 offset:28928
  s_waitcnt lgkmcnt(4)
  v_mfma_f32_32x32x16_bf16 v[64:79], a[0:3], a[112:115], 0
  ds_read_b64_tr_b16 v[44:45], v23 offset:29696
  ds_read_b64_tr_b16 v[46:47], v23 offset:29952
  v_mfma_f32_32x32x16_bf16 v[64:79], a[4:7], a[116:119], v[64:79]
  ds_read_b64_tr_b16 v[48:49], v23 offset:30720
  ds_read_b64_tr_b16 v[50:51], v23 offset:30976
  s_waitcnt lgkmcnt(4)
  v_mfma_f32_32x32x16_bf16 v[64:79], a[8:11], a[120:123], v[64:79]
  ds_read_b64_tr_b16 a[112:113], v23 offset:31744
  ds_read_b64_tr_b16 a[114:115], v23 offset:32000
  v_mfma_f32_32x32x16_bf16 v[64:79], a[12:15], a[124:127], v[64:79]
  ds_read_b64_tr_b16 a[116:117], v23 offset:32768
  ds_read_b64_tr_b16 a[118:119], v23 offset:33024
  s_waitcnt lgkmcnt(4)
  v_mfma_f32_32x32x16_bf16 v[64:79], a[16:19], v[44:47], v[64:79]
  ds_read_b64_tr_b16 a[120:121], v23 offset:33792
  ds_read_b64_tr_b16 a[122:123], v23 offset:34048
  v_mfma_f32_32x32x16_bf16 v[64:79], a[20:23], v[48:51], v[64:79]
  ds_read_b64_tr_b16 a[124:125], v23 offset:34816
  ds_read_b64_tr_b16 a[126:127], v23 offset:35072
  s_waitcnt lgkmcnt(4)
  v_mfma_f32_32x32x16_bf16 v[64:79], a[24:27], a[112:115], v[64:79]
  ds_read_b64_tr_b16 v[44:45], v23 offset:35840
  ds_read_b64_tr_b16 v[46:47], v23 offset:36096
  v_mfma_f32_32x32x16_bf16 v[64:79], a[28:31], a[116:119], v[64:79]
  ds_read_b64_tr_b16 v[48:49], v23 offset:36864
  ds_read_b64_tr_b16 v[50:51], v23 offset:37120
  s_waitcnt lgkmcnt(4)
  v_mfma_f32_32x32x16_bf16 v[64:79], a[32:35], a[120:123], v[64:79]
  ds_read_b64_tr_b16 a[112:113], v23 offset:37888
  ds_read_b64_tr_b16 a[114:115], v23 offset:38144
  v_mfma_f32_32x32x16_bf16 v[64:79], a[36:39], a[124:127], v[64:79]
  ds_read_b64_tr_b16 a[116:117], v23 offset:38912
  ds_read_b64_tr_b16 a[118:119], v23 offset:39168
  s_waitcnt lgkmcnt(4)
  v_mfma_f32_32x32x16_bf16 v[64:79], a[40:43], v[44:47], v[64:79]
  ds_read_b64_tr_b16 a[120:121], v23 offset:39936
  ds_read_b64_tr_b16 a[122:123], v23 offset:40192
  v_mfma_f32_32x32x16_bf16 v[64:79], a[44:47], v[48:51], v[64:79]
  ds_read_b64_tr_b16 a[124:125], v23 offset:40960
  ds_read_b64_tr_b16 a[126:127], v23 offset:41216
  s_waitcnt lgkmcnt(4)
  v_mfma_f32_32x32x16_bf16 v[64:79], a[48:51], a[112:115], v[64:79]
  ds_read_b64_tr_b16 v[44:45], v23 offset:41984
  ds_read_b64_tr_b16 v[46:47], v23 offset:42240
  v_mfma_f32_32x32x16_bf16 v[64:79], a[52:55], a[116:119], v[64:79]
  ds_read_b64_tr_b16 v[48:49], v23 offset:43008
  ds_read_b64_tr_b16 v[50:51], v23 offset:43264
  s_waitcnt lgkmcnt(4)
  v_mfma_f32_32x32x16_bf16 v[64:79], a[56:59], a[120:123], v[64:79]
  ds_read_b64_tr_b16 a[112:113], v23 offset:44032
  ds_read_b64_tr_b16 a[114:115], v23 offset:44288
  v_mfma_f32_32x32x16_bf16 v[64:79], a[60:63], a[124:127], v[64:79]
  ds_read_b64_tr_b16 a[116:117], v23 offset:45056
  ds_read_b64_tr_b16 a[118:119], v23 offset:45312
  s_waitcnt lgkmcnt(4)
  v_mfma_f32_32x32x16_bf16 v[64:79], a[64:67], v[44:47], v[64:79]
  ds_read_b64_tr_b16 a[120:121], v23 offset:46080
  ds_read_b64_tr_b16 a[122:123], v23 offset:46336
  v_mfma_f32_32x32x16_bf16 v[64:79], a[68:71], v[48:51], v[64:79]
  ds_read_b64_tr_b16 a[124:125], v23 offset:47104
  ds_read_b64_tr_b16 a[126:127], v23 offset:47360
  s_waitcnt lgkmcnt(4)
  v_mfma_f32_32x32x16_bf16 v[64:79], a[72:75], a[112:115], v[64:79]
  ds_read_b64_tr_b16 v[44:45], v23 offset:48128
  ds_read_b64_tr_b16 v[46:47], v23 offset:48384
  v_mfma_f32_32x32x16_bf16 v[64:79], a[76:79], a[116:119], v[64:79]
  ds_read_b64_tr_b16 v[48:49], v23 offset:49152
  ds_read_b64_tr_b16 v[50:51], v23 offset:49408
  s_waitcnt lgkmcnt(4)
  v_mfma_f32_32x32x16_bf16 v[64:79], a[80:83], a[120:123], v[64:79]
  ds_read_b64_tr_b16 a[112:113], v23 offset:50176
  ds_read_b64_tr_b16 a[114:115], v23 offset:50432
  v_mfma_f32_32x32x16_bf16 v[64:79], a[84:87], a[124:127], v[64:79]
  ds_read_b64_tr_b16 a[116:117], v23 offset:51200
  ds_read_b64_tr_b16 a[118:119], v23 offset:51456
  s_waitcnt lgkmcnt(4)
  v_mfma_f32_32x32x16_bf16 v[64:79], a[88:91], v[44:47], v[64:79]
  ds_read_b64_tr_b16 a[120:121], v23 offset:52224
  ds_read_b64_tr_b16 a[122:123], v23 offset:52480
  v_mfma_f32_32x32x16_bf16 v[64:79], a[92:95], v[48:51], v[64:79]
  ds_read_b64_tr_b16 a[124:125], v23 offset:53248
  ds_read_b64_tr_b16 a[126:127], v23 offset:53504
  s_barrier
  s_waitcnt lgkmcnt(4)
  v_mfma_f32_32x32x16_bf16 v[64:79], a[96:99], a[112:115], v[64:79]
  ds_read_b64_tr_b16 v[44:45], v23 offset:54272
  ds_read_b64_tr_b16 v[46:47], v23 offset:54528
  v_mfma_f32_32x32x16_bf16 v[64:79], a[100:103], a[116:119], v[64:79]
  ds_read_b64_tr_b16 v[48:49], v23 offset:55296
  ds_read_b64_tr_b16 v[50:51], v23 offset:55552
  s_waitcnt lgkmcnt(4)
  v_mfma_f32_32x32x16_bf16 v[64:79], a[104:107], a[120:123], v[64:79]
  ds_read_b64_tr_b16 a[112:113], v23 offset:56320
  ds_read_b64_tr_b16 a[114:115], v23 offset:56576
  v_mfma_f32_32x32x16_bf16 v[64:79], a[108:111], a[124:127], v[64:79]
  ds_read_b64_tr_b16 a[116:117], v23 offset:57344
  ds_read_b64_tr_b16 a[118:119], v23 offset:57600
  s_waitcnt lgkmcnt(4)
  v_mfma_f32_32x32x16_bf16 v[80:95], a[0:3], v[44:47], 0
  ds_read_b64_tr_b16 a[120:121], v23 offset:58368
  ds_read_b64_tr_b16 a[122:123], v23 offset:58624
  v_mfma_f32_32x32x16_bf16 v[80:95], a[4:7], v[48:51], v[80:95]
  ds_read_b64_tr_b16 a[124:125], v23 offset:59392
  ds_read_b64_tr_b16 a[126:127], v23 offset:59648
  s_waitcnt lgkmcnt(4)
  v_mfma_f32_32x32x16_bf16 v[80:95], a[8:11], a[112:115], v[80:95]
  ds_read_b64_tr_b16 v[44:45], v23 offset:60416
  ds_read_b64_tr_b16 v[46:47], v23 offset:60672
  v_mfma_f32_32x32x16_bf16 v[80:95], a[12:15], a[116:119], v[80:95]
  ds_read_b64_tr_b16 v[48:49], v14 offset:0
  ds_read_b64_tr_b16 v[50:51], v14 offset:256
  s_waitcnt lgkmcnt(4)
  v_mfma_f32_32x32x16_bf16 v[80:95], a[16:19], a[120:123], v[80:95]
  ds_read_b64_tr_b16 a[112:113], v14 offset:1024
  ds_read_b64_tr_b16 a[114:115], v14 offset:1280
  v_mfma_f32_32x32x16_bf16 v[80:95], a[20:23], a[124:127], v[80:95]
  ds_read_b64_tr_b16 a[116:117], v14 offset:2048
  ds_read_b64_tr_b16 a[118:119], v14 offset:2304
  s_waitcnt lgkmcnt(4)
  v_mfma_f32_32x32x16_bf16 v[80:95], a[24:27], v[44:47], v[80:95]
  ds_read_b64_tr_b16 a[120:121], v14 offset:3072
  ds_read_b64_tr_b16 a[122:123], v14 offset:3328
  v_mfma_f32_32x32x16_bf16 v[80:95], a[28:31], v[48:51], v[80:95]
  ds_read_b64_tr_b16 a[124:125], v14 offset:4096
  ds_read_b64_tr_b16 a[126:127], v14 offset:4352
  s_waitcnt lgkmcnt(4)
  v_mfma_f32_32x32x16_bf16 v[80:95], a[32:35], a[112:115], v[80:95]
  ds_read_b64_tr_b16 v[44:45], v14 offset:5120
  ds_read_b64_tr_b16 v[46:47], v14 offset:5376
  v_mfma_f32_32x32x16_bf16 v[80:95], a[36:39], a[116:119], v[80:95]
  ds_read_b64_tr_b16 v[48:49], v14 offset:6144
  ds_read_b64_tr_b16 v[50:51], v14 offset:6400
  s_waitcnt lgkmcnt(4)
  v_mfma_f32_32x32x16_bf16 v[80:95], a[40:43], a[120:123], v[80:95]
  ds_read_b64_tr_b16 a[112:113], v14 offset:7168
  ds_read_b64_tr_b16 a[114:115], v14 offset:7424
  v_mfma_f32_32x32x16_bf16 v[80:95], a[44:47], a[124:127], v[80:95]
  ds_read_b64_tr_b16 a[116:117], v14 offset:8192
  ds_read_b64_tr_b16 a[118:119], v14 offset:8448
  s_waitcnt lgkmcnt(4)
  v_mfma_f32_32x32x16_bf16 v[80:95], a[48:51], v[44:47], v[80:95]
  ds_read_b64_tr_b16 a[120:121], v14 offset:9216
  ds_read_b64_tr_b16 a[122:123], v14 offset:9472
  v_mfma_f32_32x32x16_bf16 v[80:95], a[52:55], v[48:51], v[80:95]
  ds_read_b64_tr_b16 a[124:125], v14 offset:10240
  ds_read_b64_tr_b16 a[126:127], v14 offset:10496
  s_waitcnt lgkmcnt(4)
  v_mfma_f32_32x32x16_bf16 v[80:95], a[56:59], a[112:115], v[80:95]
  ds_read_b64_tr_b16 v[44:45], v14 offset:11264
  ds_read_b64_tr_b16 v[46:47], v14 offset:11520
  v_mfma_f32_32x32x16_bf16 v[80:95], a[60:63], a[116:119], v[80:95]
  ds_read_b64_tr_b16 v[48:49], v14 offset:12288
  ds_read_b64_tr_b16 v[50:51], v14 offset:12544
  s_waitcnt lgkmcnt(4)
  v_mfma_f32_32x32x16_bf16 v[80:95], a[64:67], a[120:123], v[80:95]
  ds_read_b64_tr_b16 a[112:113], v14 offset:13312
  ds_read_b64_tr_b16 a[114:115], v14 offset:13568
  v_mfma_f32_32x32x16_bf16 v[80:95], a[68:71], a[124:127], v[80:95]
  ds_read_b64_tr_b16 a[116:117], v14 offset:14336
  ds_read_b64_tr_b16 a[118:119], v14 offset:14592
  s_waitcnt lgkmcnt(4)
  v_mfma_f32_32x32x16_bf16 v[80:95], a[72:75], v[44:47], v[80:95]
  ds_read_b64_tr_b16 a[120:121], v14 offset:15360
  ds_read_b64_tr_b16 a[122:123], v14 offset:15616
  v_mfma_f32_32x32x16_bf16 v[80:95], a[76:79], v[48:51], v[80:95]
  ds_read_b64_tr_b16 a[124:125], v14 offset:16384
  ds_read_b64_tr_b16 a[126:127], v14 offset:16640
  s_waitcnt lgkmcnt(4)
  v_mfma_f32_32x32x16_bf16 v[80:95], a[80:83], a[112:115], v[80:95]
  ds_read_b64_tr_b16 v[44:45], v14 offset:17408
  ds_read_b64_tr_b16 v[46:47], v14 offset:17664
  v_mfma_f32_32x32x16_bf16 v[80:95], a[84:87], a[116:119], v[80:95]
  ds_read_b64_tr_b16 v[48:49], v14 offset:18432
  ds_read_b64_tr_b16 v[50:51], v14 offset:18688
  s_waitcnt lgkmcnt(4)
  v_mfma_f32_32x32x16_bf16 v[80:95], a[88:91], a[120:123], v[80:95]
  ds_read_b64_tr_b16 a[112:113], v14 offset:19456
  ds_read_b64_tr_b16 a[114:115], v14 offset:19712
  v_mfma_f32_32x32x16_bf16 v[80:95], a[92:95], a[124:127], v[80:95]
  ds_read_b64_tr_b16 a[116:117], v14 offset:20480
  ds_read_b64_tr_b16 a[118:119], v14 offset:20736
  s_barrier
  s_waitcnt lgkmcnt(4)
  v_mfma_f32_32x32x16_bf16 v[80:95], a[96:99], v[44:47], v[80:95]
  ds_read_b64_tr_b16 a[120:121], v22 offset:3328
  ds_read_b64_tr_b16 a[122:123], v22 offset:3584
  v_mfma_f32_32x32x16_bf16 v[80:95], a[100:103], v[48:51], v[80:95]
  ds_read_b64_tr_b16 a[124:125], v22 offset:4352
  ds_read_b64_tr_b16 a[126:127], v22 offset:4608
  s_waitcnt lgkmcnt(4)
  v_mfma_f32_32x32x16_bf16 v[80:95], a[104:107], a[112:115], v[80:95]
  ds_read_b64_tr_b16 v[44:45], v22 offset:5376
  ds_read_b64_tr_b16 v[46:47], v22 offset:5632
  v_mfma_f32_32x32x16_bf16 v[80:95], a[108:111], a[116:119], v[80:95]
  ds_read_b64_tr_b16 v[48:49], v22 offset:6400
  ds_read_b64_tr_b16 v[50:51], v22 offset:6656
  s_waitcnt lgkmcnt(4)
  v_mfma_f32_32x32x16_bf16 v[96:111], a[0:3], a[120:123], 0
  ds_read_b64_tr_b16 a[112:113], v23 offset:8192
  ds_read_b64_tr_b16 a[114:115], v23 offset:8448
  v_mfma_f32_32x32x16_bf16 v[96:111], a[4:7], a[124:127], v[96:111]
  ds_read_b64_tr_b16 a[116:117], v23 offset:9216
  ds_read_b64_tr_b16 a[118:119], v23 offset:9472
  s_waitcnt lgkmcnt(4)
  v_mfma_f32_32x32x16_bf16 v[96:111], a[8:11], v[44:47], v[96:111]
  ds_read_b64_tr_b16 a[120:121], v23 offset:10240
  ds_read_b64_tr_b16 a[122:123], v23 offset:10496
  v_mfma_f32_32x32x16_bf16 v[96:111], a[12:15], v[48:51], v[96:111]
  ds_read_b64_tr_b16 a[124:125], v23 offset:11264
  ds_read_b64_tr_b16 a[126:127], v23 offset:11520
  s_waitcnt lgkmcnt(4)
  v_mfma_f32_32x32x16_bf16 v[96:111], a[16:19], a[112:115], v[96:111]
  ds_read_b64_tr_b16 v[44:45], v14 offset:29696
  ds_read_b64_tr_b16 v[46:47], v14 offset:29952
  v_mfma_f32_32x32x16_bf16 v[96:111], a[20:23], a[116:119], v[96:111]
  ds_read_b64_tr_b16 v[48:49], v14 offset:30720
  ds_read_b64_tr_b16 v[50:51], v14 offset:30976
  s_waitcnt lgkmcnt(4)
  v_mfma_f32_32x32x16_bf16 v[96:111], a[24:27], a[120:123], v[96:111]
  ds_read_b64_tr_b16 a[112:113], v14 offset:31744
  ds_read_b64_tr_b16 a[114:115], v14 offset:32000
  v_mfma_f32_32x32x16_bf16 v[96:111], a[28:31], a[124:127], v[96:111]
  ds_read_b64_tr_b16 a[116:117], v14 offset:32768
  ds_read_b64_tr_b16 a[118:119], v14 offset:33024
  s_waitcnt lgkmcnt(4)
  v_mfma_f32_32x32x16_bf16 v[96:111], a[32:35], v[44:47], v[96:111]
  ds_read_b64_tr_b16 a[120:121], v22 offset:55680
  ds_read_b64_tr_b16 a[122:123], v22 offset:55936
  v_mfma_f32_32x32x16_bf16 v[96:111], a[36:39], v[48:51], v[96:111]
  ds_read_b64_tr_b16 a[124:125], v22 offset:56704
  ds_read_b64_tr_b16 a[126:127], v22 offset:56960
  s_waitcnt lgkmcnt(4)
  v_mfma_f32_32x32x16_bf16 v[96:111], a[40:43], a[112:115], v[96:111]
  ds_read_b64_tr_b16 v[44:45], v22 offset:57728
  ds_read_b64_tr_b16 v[46:47], v22 offset:57984
  v_mfma_f32_32x32x16_bf16 v[96:111], a[44:47], a[116:119], v[96:111]
  ds_read_b64_tr_b16 v[48:49], v22 offset:58752
  ds_read_b64_tr_b16 v[50:51], v22 offset:59008
  s_waitcnt lgkmcnt(4)
  v_mfma_f32_32x32x16_bf16 v[96:111], a[48:51], a[120:123], v[96:111]
  ds_read_b64_tr_b16 a[112:113], v22 offset:12096
  ds_read_b64_tr_b16 a[114:115], v22 offset:12352
  v_mfma_f32_32x32x16_bf16 v[96:111], a[52:55], a[124:127], v[96:111]
  ds_read_b64_tr_b16 a[116:117], v22 offset:13120
  ds_read_b64_tr_b16 a[118:119], v22 offset:13376
  s_waitcnt lgkmcnt(4)
  v_mfma_f32_32x32x16_bf16 v[96:111], a[56:59], v[44:47], v[96:111]
  ds_read_b64_tr_b16 a[120:121], v22 offset:14144
  ds_read_b64_tr_b16 a[122:123], v22 offset:14400
  v_mfma_f32_32x32x16_bf16 v[96:111], a[60:63], v[48:51], v[96:111]
  ds_read_b64_tr_b16 a[124:125], v22 offset:15168
  ds_read_b64_tr_b16 a[126:127], v22 offset:15424
  s_waitcnt lgkmcnt(4)
  v_mfma_f32_32x32x16_bf16 v[96:111], a[64:67], a[112:115], v[96:111]
  ds_read_b64_tr_b16 v[44:45], v23 offset:12288
  ds_read_b64_tr_b16 v[46:47], v23 offset:12544
  v_mfma_f32_32x32x16_bf16 v[96:111], a[68:71], a[116:119], v[96:111]
  ds_read_b64_tr_b16 v[48:49], v23 offset:13312
  ds_read_b64_tr_b16 v[50:51], v23 offset:13568
  s_waitcnt lgkmcnt(4)
  v_mfma_f32_32x32x16_bf16 v[96:111], a[72:75], a[120:123], v[96:111]
  ds_read_b64_tr_b16 a[112:113], v23 offset:14336
  ds_read_b64_tr_b16 a[114:115], v23 offset:14592
  v_mfma_f32_32x32x16_bf16 v[96:111], a[76:79], a[124:127], v[96:111]
  ds_read_b64_tr_b16 a[116:117], v23 offset:15360
  ds_read_b64_tr_b16 a[118:119], v23 offset:15616
  s_waitcnt lgkmcnt(4)
  v_mfma_f32_32x32x16_bf16 v[96:111], a[80:83], v[44:47], v[96:111]
  ds_read_b64_tr_b16 a[120:121], v22 offset:59840
  ds_read_b64_tr_b16 a[122:123], v22 offset:60096
  v_mfma_f32_32x32x16_bf16 v[96:111], a[84:87], v[48:51], v[96:111]
  ds_read_b64_tr_b16 a[124:125], v22 offset:60864
  ds_read_b64_tr_b16 a[126:127], v22 offset:61120
  s_waitcnt lgkmcnt(4)
  v_mfma_f32_32x32x16_bf16 v[96:111], a[88:91], a[112:115], v[96:111]
  ds_read_b64_tr_b16 v[44:45], v23 offset:448
  ds_read_b64_tr_b16 v[46:47], v23 offset:704
  v_mfma_f32_32x32x16_bf16 v[96:111], a[92:95], a[116:119], v[96:111]
  ds_read_b64_tr_b16 v[48:49], v23 offset:1472
  ds_read_b64_tr_b16 v[50:51], v23 offset:1728
  s_barrier
  s_waitcnt lgkmcnt(4)
  v_mfma_f32_32x32x16_bf16 v[96:111], a[96:99], a[120:123], v[96:111]
  ds_read_b64_tr_b16 a[112:113], v22 offset:16256
  ds_read_b64_tr_b16 a[114:115], v22 offset:16512
  ds_read_b32 v120, v15 offset:0
  v_mfma_f32_32x32x16_bf16 v[96:111], a[100:103], a[124:127], v[96:111]
  ds_read_b64_tr_b16 a[116:117], v22 offset:17280
  ds_read_b64_tr_b16 a[118:119], v22 offset:17536
  s_waitcnt lgkmcnt(5)
  v_mfma_f32_32x32x16_bf16 v[96:111], a[104:107], v[44:47], v[96:111]
  ds_read_b64_tr_b16 a[120:121], v22 offset:18304
  ds_read_b64_tr_b16 a[122:123], v22 offset:18560
  v_mfma_f32_32x32x16_bf16 v[96:111], a[108:111], v[48:51], v[96:111]
  ds_read_b64_tr_b16 a[124:125], v22 offset:19328
  ds_read_b64_tr_b16 a[126:127], v22 offset:19584
  s_waitcnt lgkmcnt(6)
  v_lshlrev_b32 v121, 16, v120
  v_lshrrev_b32 v117, 16, v120
  v_and_b32 v120, 0xffff, v120
  v_cndmask_b32_e64 v117, v120, v117, s[42:43]
  v_lshl_or_b32 v116, v117, 16, v117
  v_rcp_f32 v122, v121
  s_waitcnt lgkmcnt(4)
  v_mfma_f32_32x32x16_bf16 v[28:43], a[0:3], a[112:115], 0
  ds_read_b64_tr_b16 v[44:45], v23 offset:20480
  ds_read_b64_tr_b16 v[46:47], v23 offset:20736
  v_mul_f32 v122, 0xbfb8aa3b, v122
  v_mfma_f32_32x32x16_bf16 v[64:79], v[112:115], v[116:119], v[64:79]
  v_mfma_f32_32x32x16_bf16 v[28:43], a[4:7], a[116:119], v[28:43]
  ds_read_b64_tr_b16 v[48:49], v23 offset:21504
  ds_read_b64_tr_b16 v[50:51], v23 offset:21760
  s_waitcnt lgkmcnt(4)
  v_mfma_f32_32x32x16_bf16 v[28:43], a[8:11], a[120:123], v[28:43]
  ds_read_b64_tr_b16 a[112:113], v23 offset:22528
  ds_read_b64_tr_b16 a[114:115], v23 offset:22784
  s_nop 4
  v_mul_f32 v52, v64, v122
  v_mul_f32 v53, v65, v122
  v_exp_f32 v52, v52
  v_mul_f32 v54, v66, v122
  v_exp_f32 v53, v53
  v_mfma_f32_32x32x16_bf16 v[28:43], a[12:15], a[124:127], v[28:43]
  ds_read_b64_tr_b16 a[116:117], v23 offset:23552
  ds_read_b64_tr_b16 a[118:119], v23 offset:23808
  v_mul_f32 v55, v67, v122
  v_exp_f32 v54, v54
  v_fma_f32 v52, v52, v121, v121
  v_mul_f32 v56, v68, v122
  s_waitcnt lgkmcnt(4)
  v_mfma_f32_32x32x16_bf16 v[28:43], a[16:19], v[44:47], v[28:43]
  ds_read_b64_tr_b16 a[120:121], v22 offset:46912
  ds_read_b64_tr_b16 a[122:123], v22 offset:47168
  v_exp_f32 v55, v55
  v_fma_f32 v53, v53, v121, v121
  v_rcp_f32 v52, v52
  v_mul_f32 v57, v69, v122
  v_mfma_f32_32x32x16_bf16 v[28:43], a[20:23], v[48:51], v[28:43]
  ds_read_b64_tr_b16 a[124:125], v22 offset:47936
  ds_read_b64_tr_b16 a[126:127], v22 offset:48192
  v_exp_f32 v56, v56
  v_fma_f32 v54, v54, v121, v121
  v_rcp_f32 v53, v53
  v_mul_f32 v58, v70, v122
  s_waitcnt lgkmcnt(4)
  v_mfma_f32_32x32x16_bf16 v[28:43], a[24:27], a[112:115], v[28:43]
  ds_read_b64_tr_b16 v[44:45], v22 offset:48960
  ds_read_b64_tr_b16 v[46:47], v22 offset:49216
  ds_read_b32 v120, v15 offset:128
  v_exp_f32 v57, v57
  v_fma_f32 v55, v55, v121, v121
  v_rcp_f32 v54, v54
  v_mul_f32 v52, v52, v72
  v_mfma_f32_32x32x16_bf16 v[28:43], a[28:31], a[116:119], v[28:43]
  ds_read_b64_tr_b16 v[48:49], v22 offset:49984
  ds_read_b64_tr_b16 v[50:51], v22 offset:50240
  v_mul_f32 v59, v71, v122
  v_exp_f32 v58, v58
  v_fma_f32 v56, v56, v121, v121
  v_rcp_f32 v55, v55
  s_waitcnt lgkmcnt(5)
  v_mfma_f32_32x32x16_bf16 v[28:43], a[32:35], a[120:123], v[28:43]
  ds_read_b64_tr_b16 a[112:113], v14 offset:21504
  ds_read_b64_tr_b16 a[114:115], v14 offset:21760
  v_mul_f32 v53, v53, v73
  v_exp_f32 v59, v59
  v_fma_f32 v57, v57, v121, v121
  v_rcp_f32 v56, v56
  v_mul_f32 v54, v54, v74
  v_mfma_f32_32x32x16_bf16 v[28:43], a[36:39], a[124:127], v[28:43]
  ds_read_b64_tr_b16 a[116:117], v14 offset:22528
  ds_read_b64_tr_b16 a[118:119], v14 offset:22784
  s_waitcnt lgkmcnt(6)
  v_lshlrev_b32 v123, 16, v120
  v_lshrrev_b32 v117, 16, v120
  v_and_b32 v120, 0xffff, v120
  v_cndmask_b32_e64 v117, v120, v117, s[42:43]
  v_lshl_or_b32 v116, v117, 16, v117
  v_cvt_pk_bf16_f32 v60, v52, v53
  s_waitcnt lgkmcnt(4)
  v_mfma_f32_32x32x16_bf16 v[28:43], a[40:43], v[44:47], v[28:43]
  ds_read_b64_tr_b16 a[120:121], v14 offset:23552
  ds_read_b64_tr_b16 a[122:123], v14 offset:23808
  v_rcp_f32 v124, v123
  s_nop 0
  v_mul_f32 v124, 0xbfb8aa3b, v124
  v_mfma_f32_32x32x16_bf16 v[80:95], v[112:115], v[116:119], v[80:95]
  v_fma_f32 v58, v58, v121, v121
  v_rcp_f32 v57, v57
  v_mul_f32 v55, v55, v75
  v_fma_f32 v59, v59, v121, v121
  v_mfma_f32_32x32x16_bf16 v[28:43], a[44:47], v[48:51], v[28:43]
  ds_read_b64_tr_b16 a[124:125], v14 offset:24576
  ds_read_b64_tr_b16 a[126:127], v14 offset:24832
  v_rcp_f32 v58, v58
  v_mul_f32 v56, v56, v76
  v_cvt_pk_bf16_f32 v61, v54, v55
  v_rcp_f32 v59, v59
  v_mul_f32 v57, v57, v77
  s_waitcnt lgkmcnt(4)
  v_mfma_f32_32x32x16_bf16 v[28:43], a[48:51], a[112:115], v[28:43]
  ds_read_b64_tr_b16 v[44:45], v23 offset:37888
  ds_read_b64_tr_b16 v[46:47], v23 offset:38144
  v_mul_f32 v58, v58, v78
  v_cvt_pk_bf16_f32 v62, v56, v57
  v_mul_f32 v59, v59, v79
  v_cvt_pk_bf16_f32 v63, v58, v59
  v_mul_f32 v52, v80, v124
  v_mul_f32 v53, v81, v124
  v_mfma_f32_32x32x16_bf16 v[28:43], a[52:55], a[116:119], v[28:43]
  ds_read_b64_tr_b16 v[48:49], v23 offset:38912
  ds_read_b64_tr_b16 v[50:51], v23 offset:39168
  v_exp_f32 v52, v52
  v_mul_f32 v54, v82, v124
  v_exp_f32 v53, v53
  v_mul_f32 v55, v83, v124
  s_waitcnt lgkmcnt(4)
  v_mfma_f32_32x32x16_bf16 v[28:43], a[56:59], a[120:123], v[28:43]
  ds_read_b64_tr_b16 a[112:113], v23 offset:39936
  ds_read_b64_tr_b16 a[114:115], v23 offset:40192
  v_exp_f32 v54, v54
  v_fma_f32 v52, v52, v123, v123
  v_mul_f32 v56, v84, v124
  v_exp_f32 v55, v55
  v_fma_f32 v53, v53, v123, v123
  v_mfma_f32_32x32x16_bf16 v[28:43], a[60:63], a[124:127], v[28:43]
  ds_read_b64_tr_b16 a[116:117], v23 offset:40960
  ds_read_b64_tr_b16 a[118:119], v23 offset:41216
  v_rcp_f32 v52, v52
  v_mul_f32 v57, v85, v124
  v_exp_f32 v56, v56
  v_fma_f32 v54, v54, v123, v123
  s_waitcnt lgkmcnt(4)
  v_mfma_f32_32x32x16_bf16 v[28:43], a[64:67], v[44:47], v[28:43]
  ds_read_b64_tr_b16 a[120:121], v22 offset:51072
  ds_read_b64_tr_b16 a[122:123], v22 offset:51328
  v_rcp_f32 v53, v53
  v_mul_f32 v58, v86, v124
  v_exp_f32 v57, v57
  v_fma_f32 v55, v55, v123, v123
  v_mfma_f32_32x32x16_bf16 v[28:43], a[68:71], v[48:51], v[28:43]
  ds_read_b64_tr_b16 a[124:125], v22 offset:52096
  ds_read_b64_tr_b16 a[126:127], v22 offset:52352
  v_rcp_f32 v54, v54
  v_mul_f32 v52, v52, v88
  v_mul_f32 v59, v87, v124
  v_exp_f32 v58, v58
  v_fma_f32 v56, v56, v123, v123
  s_waitcnt lgkmcnt(4)
  v_mfma_f32_32x32x16_bf16 v[28:43], a[72:75], a[112:115], v[28:43]
  ds_read_b64_tr_b16 v[44:45], v22 offset:53120
  ds_read_b64_tr_b16 v[46:47], v22 offset:53376
  v_rcp_f32 v55, v55
  v_mul_f32 v53, v53, v89
  v_exp_f32 v59, v59
  v_fma_f32 v57, v57, v123, v123
  v_mfma_f32_32x32x16_bf16 v[28:43], a[76:79], a[116:119], v[28:43]
  ds_read_b64_tr_b16 v[48:49], v22 offset:54144
  ds_read_b64_tr_b16 v[50:51], v22 offset:54400
  v_rcp_f32 v56, v56
  v_mul_f32 v54, v54, v90
  v_cvt_pk_bf16_f32 v24, v52, v53
  v_fma_f32 v58, v58, v123, v123
  v_rcp_f32 v57, v57
  s_waitcnt lgkmcnt(4)
  v_mfma_f32_32x32x16_bf16 v[28:43], a[80:83], a[120:123], v[28:43]
  ds_read_b64_tr_b16 a[112:113], v23 offset:25600
  ds_read_b64_tr_b16 a[114:115], v23 offset:25856
  v_mul_f32 v55, v55, v91
  v_fma_f32 v59, v59, v123, v123
  v_rcp_f32 v58, v58
  v_mul_f32 v56, v56, v92
  v_cvt_pk_bf16_f32 v25, v54, v55
  v_mfma_f32_32x32x16_bf16 v[28:43], a[84:87], a[124:127], v[28:43]
  ds_read_b64_tr_b16 a[116:117], v23 offset:26624
  ds_read_b64_tr_b16 a[118:119], v23 offset:26880
  v_rcp_f32 v59, v59
  v_mul_f32 v57, v57, v93
  v_mul_f32 v58, v58, v94
  v_cvt_pk_bf16_f32 v26, v56, v57
  v_mul_f32 v59, v59, v95
  v_cvt_pk_bf16_f32 v27, v58, v59
  s_waitcnt lgkmcnt(4)
  v_mfma_f32_32x32x16_bf16 v[28:43], a[88:91], v[44:47], v[28:43]
  ds_read_b64_tr_b16 a[120:121], v23 offset:27648
  ds_read_b64_tr_b16 a[122:123], v23 offset:27904
  v_mfma_f32_32x32x16_bf16 v[28:43], a[92:95], v[48:51], v[28:43]
  ds_read_b64_tr_b16 a[124:125], v23 offset:28672
  ds_read_b64_tr_b16 a[126:127], v23 offset:28928
  s_mul_i32 s36, s50, 114688
  s_add_u32 s36, s36, s35
  buffer_store_dwordx4 v[60:63], v6, s[16:19], s36 offen sc1
  s_mul_i32 s36, s51, 114688
  s_add_u32 s36, s36, s35
  buffer_store_dwordx4 v[24:27], v6, s[16:19], s36 offen sc1
  s_barrier
  s_waitcnt lgkmcnt(4)
  v_mfma_f32_32x32x16_bf16 v[28:43], a[96:99], a[112:115], v[28:43]
  ds_read_b64_tr_b16 v[44:45], v14 offset:33792
  ds_read_b64_tr_b16 v[46:47], v14 offset:34048
  ds_read_b32 v120, v15 offset:256
  v_mfma_f32_32x32x16_bf16 v[28:43], a[100:103], a[116:119], v[28:43]
  ds_read_b64_tr_b16 v[48:49], v14 offset:34816
  ds_read_b64_tr_b16 v[50:51], v14 offset:35072
  s_waitcnt lgkmcnt(5)
  v_mfma_f32_32x32x16_bf16 v[28:43], a[104:107], a[120:123], v[28:43]
  ds_read_b64_tr_b16 a[112:113], v14 offset:35840
  ds_read_b64_tr_b16 a[114:115], v14 offset:36096
  v_mfma_f32_32x32x16_bf16 v[28:43], a[108:111], a[124:127], v[28:43]
  ds_read_b64_tr_b16 a[116:117], v14 offset:36864
  ds_read_b64_tr_b16 a[118:119], v14 offset:37120
  s_waitcnt lgkmcnt(6)
  v_lshlrev_b32 v121, 16, v120
  v_lshrrev_b32 v117, 16, v120
  v_and_b32 v120, 0xffff, v120
  v_cndmask_b32_e64 v117, v120, v117, s[42:43]
  v_lshl_or_b32 v116, v117, 16, v117
  v_rcp_f32 v122, v121
  s_waitcnt lgkmcnt(4)
  v_mfma_f32_32x32x16_bf16 v[64:79], a[0:3], v[44:47], 0
  ds_read_b64_tr_b16 a[120:121], v22 offset:29632
  ds_read_b64_tr_b16 a[122:123], v22 offset:29888
  v_mul_f32 v122, 0xbfb8aa3b, v122
  v_mfma_f32_32x32x16_bf16 v[96:111], v[112:115], v[116:119], v[96:111]
  v_mfma_f32_32x32x16_bf16 v[64:79], a[4:7], v[48:51], v[64:79]
  ds_read_b64_tr_b16 a[124:125], v22 offset:30656
  ds_read_b64_tr_b16 a[126:127], v22 offset:30912
  s_waitcnt lgkmcnt(4)
  v_mfma_f32_32x32x16_bf16 v[64:79], a[8:11], a[112:115], v[64:79]
  ds_read_b64_tr_b16 v[44:45], v22 offset:31680
  ds_read_b64_tr_b16 v[46:47], v22 offset:31936
  s_nop 4
  v_mul_f32 v52, v96, v122
  v_mul_f32 v53, v97, v122
  v_exp_f32 v52, v52
  v_mul_f32 v54, v98, v122
  v_exp_f32 v53, v53
  v_mfma_f32_32x32x16_bf16 v[64:79], a[12:15], a[116:119], v[64:79]
  ds_read_b64_tr_b16 v[48:49], v22 offset:32704
  ds_read_b64_tr_b16 v[50:51], v22 offset:32960
  v_mul_f32 v55, v99, v122
  v_exp_f32 v54, v54
  v_fma_f32 v52, v52, v121, v121
  v_mul_f32 v56, v100, v122
  s_waitcnt lgkmcnt(4)
  v_mfma_f32_32x32x16_bf16 v[64:79], a[16:19], a[120:123], v[64:79]
  ds_read_b64_tr_b16 a[112:113], v23 offset:16384
  ds_read_b64_tr_b16 a[114:115], v23 offset:16640
  v_exp_f32 v55, v55
  v_fma_f32 v53, v53, v121, v121
  v_rcp_f32 v52, v52
  v_mul_f32 v57, v101, v122
  v_mfma_f32_32x32x16_bf16 v[64:79], a[20:23], a[124:127], v[64:79]
  ds_read_b64_tr_b16 a[116:117], v23 offset:17408
  ds_read_b64_tr_b16 a[118:119], v23 offset:17664
  v_exp_f32 v56, v56
  v_fma_f32 v54, v54, v121, v121
  v_rcp_f32 v53, v53
  v_mul_f32 v58, v102, v122
  s_waitcnt lgkmcnt(4)
  v_mfma_f32_32x32x16_bf16 v[64:79], a[24:27], v[44:47], v[64:79]
  ds_read_b64_tr_b16 a[120:121], v23 offset:18432
  ds_read_b64_tr_b16 a[122:123], v23 offset:18688
  ds_read_b32 v120, v15 offset:384
  v_exp_f32 v57, v57
  v_fma_f32 v55, v55, v121, v121
  v_rcp_f32 v54, v54
  v_mul_f32 v52, v52, v104
  v_mfma_f32_32x32x16_bf16 v[64:79], a[28:31], v[48:51], v[64:79]
  ds_read_b64_tr_b16 a[124:125], v23 offset:19456
  ds_read_b64_tr_b16 a[126:127], v23 offset:19712
  v_mul_f32 v59, v103, v122
  v_exp_f32 v58, v58
  v_fma_f32 v56, v56, v121, v121
  v_rcp_f32 v55, v55
  s_waitcnt lgkmcnt(5)
  v_mfma_f32_32x32x16_bf16 v[64:79], a[32:35], a[112:115], v[64:79]
  ds_read_b64_tr_b16 v[44:45], v23 offset:29696
  ds_read_b64_tr_b16 v[46:47], v23 offset:29952
  v_mul_f32 v53, v53, v105
  v_exp_f32 v59, v59
  v_fma_f32 v57, v57, v121, v121
  v_rcp_f32 v56, v56
  v_mul_f32 v54, v54, v106
  v_mfma_f32_32x32x16_bf16 v[64:79], a[36:39], a[116:119], v[64:79]
  ds_read_b64_tr_b16 v[48:49], v23 offset:30720
  ds_read_b64_tr_b16 v[50:51], v23 offset:30976
  s_waitcnt lgkmcnt(6)
  v_lshlrev_b32 v123, 16, v120
  v_lshrrev_b32 v117, 16, v120
  v_and_b32 v120, 0xffff, v120
  v_cndmask_b32_e64 v117, v120, v117, s[42:43]
  v_lshl_or_b32 v116, v117, 16, v117
  v_cvt_pk_bf16_f32 v8, v52, v53
  s_waitcnt lgkmcnt(4)
  v_mfma_f32_32x32x16_bf16 v[64:79], a[40:43], a[120:123], v[64:79]
  ds_read_b64_tr_b16 a[112:113], v23 offset:31744
  ds_read_b64_tr_b16 a[114:115], v23 offset:32000
  v_rcp_f32 v124, v123
  s_nop 0
  v_mul_f32 v124, 0xbfb8aa3b, v124
  v_mfma_f32_32x32x16_bf16 v[28:43], v[112:115], v[116:119], v[28:43]
  v_fma_f32 v58, v58, v121, v121
  v_rcp_f32 v57, v57
  v_mul_f32 v55, v55, v107
  v_fma_f32 v59, v59, v121, v121
  v_mfma_f32_32x32x16_bf16 v[64:79], a[44:47], a[124:127], v[64:79]
  ds_read_b64_tr_b16 a[116:117], v23 offset:32768
  ds_read_b64_tr_b16 a[118:119], v23 offset:33024
  v_rcp_f32 v58, v58
  v_mul_f32 v56, v56, v108
  v_cvt_pk_bf16_f32 v9, v54, v55
  v_rcp_f32 v59, v59
  v_mul_f32 v57, v57, v109
  s_waitcnt lgkmcnt(4)
  v_mfma_f32_32x32x16_bf16 v[64:79], a[48:51], v[44:47], v[64:79]
  ds_read_b64_tr_b16 a[120:121], v22 offset:7488
  ds_read_b64_tr_b16 a[122:123], v22 offset:7744
  v_mul_f32 v58, v58, v110
  v_cvt_pk_bf16_f32 v10, v56, v57
  v_mul_f32 v59, v59, v111
  v_cvt_pk_bf16_f32 v11, v58, v59
  v_mul_f32 v52, v28, v124
  v_mul_f32 v53, v29, v124
  v_mfma_f32_32x32x16_bf16 v[64:79], a[52:55], v[48:51], v[64:79]
  ds_read_b64_tr_b16 a[124:125], v22 offset:8512
  ds_read_b64_tr_b16 a[126:127], v22 offset:8768
  v_exp_f32 v52, v52
  v_mul_f32 v54, v30, v124
  v_exp_f32 v53, v53
  v_mul_f32 v55, v31, v124
  s_waitcnt lgkmcnt(4)
  v_mfma_f32_32x32x16_bf16 v[64:79], a[56:59], a[112:115], v[64:79]
  ds_read_b64_tr_b16 v[44:45], v22 offset:9536
  ds_read_b64_tr_b16 v[46:47], v22 offset:9792
  v_exp_f32 v54, v54
  v_fma_f32 v52, v52, v123, v123
  v_mul_f32 v56, v32, v124
  v_exp_f32 v55, v55
  v_fma_f32 v53, v53, v123, v123
  v_mfma_f32_32x32x16_bf16 v[64:79], a[60:63], a[116:119], v[64:79]
  ds_read_b64_tr_b16 v[48:49], v22 offset:10560
  ds_read_b64_tr_b16 v[50:51], v22 offset:10816
  v_rcp_f32 v52, v52
  v_mul_f32 v57, v33, v124
  v_exp_f32 v56, v56
  v_fma_f32 v54, v54, v123, v123
  s_waitcnt lgkmcnt(4)
  v_mfma_f32_32x32x16_bf16 v[64:79], a[64:67], a[120:123], v[64:79]
  ds_read_b64_tr_b16 a[112:113], v14 offset:9216
  ds_read_b64_tr_b16 a[114:115], v14 offset:9472
  v_rcp_f32 v53, v53
  v_mul_f32 v58, v34, v124
  v_exp_f32 v57, v57
  v_fma_f32 v55, v55, v123, v123
  v_mfma_f32_32x32x16_bf16 v[64:79], a[68:71], a[124:127], v[64:79]
  ds_read_b64_tr_b16 a[116:117], v14 offset:10240
  ds_read_b64_tr_b16 a[118:119], v14 offset:10496
  v_rcp_f32 v54, v54
  v_mul_f32 v52, v52, v36
  v_mul_f32 v59, v35, v124
  v_exp_f32 v58, v58
  v_fma_f32 v56, v56, v123, v123
  s_waitcnt lgkmcnt(4)
  v_mfma_f32_32x32x16_bf16 v[64:79], a[72:75], v[44:47], v[64:79]
  ds_read_b64_tr_b16 a[120:121], v14 offset:11264
  ds_read_b64_tr_b16 a[122:123], v14 offset:11520
  v_rcp_f32 v55, v55
  v_mul_f32 v53, v53, v37
  v_exp_f32 v59, v59
  v_fma_f32 v57, v57, v123, v123
  v_mfma_f32_32x32x16_bf16 v[64:79], a[76:79], v[48:51], v[64:79]
  ds_read_b64_tr_b16 a[124:125], v14 offset:12288
  ds_read_b64_tr_b16 a[126:127], v14 offset:12544
  v_rcp_f32 v56, v56
  v_mul_f32 v54, v54, v38
  v_cvt_pk_bf16_f32 v60, v52, v53
  v_fma_f32 v58, v58, v123, v123
  v_rcp_f32 v57, v57
  s_waitcnt lgkmcnt(4)
  v_mfma_f32_32x32x16_bf16 v[64:79], a[80:83], a[112:115], v[64:79]
  ds_read_b64_tr_b16 v[44:45], v14 offset:5120
  ds_read_b64_tr_b16 v[46:47], v14 offset:5376
  v_mul_f32 v55, v55, v39
  v_fma_f32 v59, v59, v123, v123
  v_rcp_f32 v58, v58
  v_mul_f32 v56, v56, v40
  v_cvt_pk_bf16_f32 v61, v54, v55
  v_mfma_f32_32x32x16_bf16 v[64:79], a[84:87], a[116:119], v[64:79]
  ds_read_b64_tr_b16 v[48:49], v14 offset:6144
  ds_read_b64_tr_b16 v[50:51], v14 offset:6400
  v_rcp_f32 v59, v59
  v_mul_f32 v57, v57, v41
  v_mul_f32 v58, v58, v42
  v_cvt_pk_bf16_f32 v62, v56, v57
  v_mul_f32 v59, v59, v43
  v_cvt_pk_bf16_f32 v63, v58, v59
  s_waitcnt lgkmcnt(4)
  v_mfma_f32_32x32x16_bf16 v[64:79], a[88:91], a[120:123], v[64:79]
  ds_read_b64_tr_b16 a[112:113], v14 offset:7168
  ds_read_b64_tr_b16 a[114:115], v14 offset:7424
  v_mfma_f32_32x32x16_bf16 v[64:79], a[92:95], a[124:127], v[64:79]
  ds_read_b64_tr_b16 a[116:117], v14 offset:8192
  ds_read_b64_tr_b16 a[118:119], v14 offset:8448
  s_waitcnt vmcnt(0)
  s_mul_i32 s36, s52, 114688
  s_add_u32 s36, s36, s35
  buffer_store_dwordx4 v[8:11], v6, s[16:19], s36 offen sc1
  s_mul_i32 s36, s53, 114688
  s_add_u32 s36, s36, s35
  buffer_store_dwordx4 v[60:63], v6, s[16:19], s36 offen sc1
  s_barrier
  s_waitcnt lgkmcnt(4)
  v_mfma_f32_32x32x16_bf16 v[64:79], a[96:99], v[44:47], v[64:79]
  ds_read_b64_tr_b16 a[120:121], v22 offset:33792
  ds_read_b64_tr_b16 a[122:123], v22 offset:34048
  ds_read_b32 v120, v15 offset:512
  v_mfma_f32_32x32x16_bf16 v[64:79], a[100:103], v[48:51], v[64:79]
  ds_read_b64_tr_b16 a[124:125], v22 offset:34816
  ds_read_b64_tr_b16 a[126:127], v22 offset:35072
  s_waitcnt lgkmcnt(5)
  v_mfma_f32_32x32x16_bf16 v[64:79], a[104:107], a[112:115], v[64:79]
  ds_read_b64_tr_b16 v[44:45], v22 offset:35840
  ds_read_b64_tr_b16 v[46:47], v22 offset:36096
  v_mfma_f32_32x32x16_bf16 v[64:79], a[108:111], a[116:119], v[64:79]
  ds_read_b64_tr_b16 v[48:49], v22 offset:36864
  ds_read_b64_tr_b16 v[50:51], v22 offset:37120
  s_waitcnt lgkmcnt(6)
  v_lshlrev_b32 v121, 16, v120
  v_lshrrev_b32 v117, 16, v120
  v_and_b32 v120, 0xffff, v120
  v_cndmask_b32_e64 v117, v120, v117, s[42:43]
  s_waitcnt lgkmcnt(4)
  v_mfma_f32_32x32x16_bf16 v[80:95], a[0:3], a[120:123], 0
  ds_read_b64_tr_b16 a[112:113], v23 offset:50176
  ds_read_b64_tr_b16 a[114:115], v23 offset:50432
  v_lshl_or_b32 v116, v117, 16, v117
  v_rcp_f32 v122, v121
  s_nop 0
  v_mul_f32 v122, 0xbfb8aa3b, v122
  v_mfma_f32_32x32x16_bf16 v[64:79], v[112:115], v[116:119], v[64:79]
  v_mfma_f32_32x32x16_bf16 v[80:95], a[4:7], a[124:127], v[80:95]
  ds_read_b64_tr_b16 a[116:117], v23 offset:51200
  ds_read_b64_tr_b16 a[118:119], v23 offset:51456
  s_waitcnt lgkmcnt(4)
  v_mfma_f32_32x32x16_bf16 v[80:95], a[8:11], v[44:47], v[80:95]
  ds_read_b64_tr_b16 a[120:121], v23 offset:52224
  ds_read_b64_tr_b16 a[122:123], v23 offset:52480
  s_nop 4
  v_mul_f32 v52, v64, v122
  v_mul_f32 v53, v65, v122
  v_exp_f32 v52, v52
  v_mfma_f32_32x32x16_bf16 v[80:95], a[12:15], v[48:51], v[80:95]
  ds_read_b64_tr_b16 a[124:125], v23 offset:53248
  ds_read_b64_tr_b16 a[126:127], v23 offset:53504
  v_mul_f32 v54, v66, v122
  v_exp_f32 v53, v53
  v_mul_f32 v55, v67, v122
  s_waitcnt lgkmcnt(4)
  v_mfma_f32_32x32x16_bf16 v[80:95], a[16:19], a[112:115], v[80:95]
  ds_read_b64_tr_b16 v[44:45], v22 offset:3328
  ds_read_b64_tr_b16 v[46:47], v22 offset:3584
  v_exp_f32 v54, v54
  v_fma_f32 v52, v52, v121, v121
  v_mul_f32 v56, v68, v122
  v_mfma_f32_32x32x16_bf16 v[80:95], a[20:23], a[116:119], v[80:95]
  ds_read_b64_tr_b16 v[48:49], v22 offset:4352
  ds_read_b64_tr_b16 v[50:51], v22 offset:4608
  v_exp_f32 v55, v55
  v_fma_f32 v53, v53, v121, v121
  s_waitcnt lgkmcnt(4)
  v_mfma_f32_32x32x16_bf16 v[80:95], a[24:27], a[120:123], v[80:95]
  ds_read_b64_tr_b16 a[112:113], v22 offset:5376
  ds_read_b64_tr_b16 a[114:115], v22 offset:5632
  v_rcp_f32 v52, v52
  v_mul_f32 v57, v69, v122
  v_mfma_f32_32x32x16_bf16 v[80:95], a[28:31], a[124:127], v[80:95]
  ds_read_b64_tr_b16 a[116:117], v22 offset:6400
  ds_read_b64_tr_b16 a[118:119], v22 offset:6656
  v_exp_f32 v56, v56
  v_fma_f32 v54, v54, v121, v121
  s_waitcnt lgkmcnt(4)
  v_mfma_f32_32x32x16_bf16 v[80:95], a[32:35], v[44:47], v[80:95]
  ds_read_b64_tr_b16 a[120:121], v23 offset:33792
  ds_read_b64_tr_b16 a[122:123], v23 offset:34048
  v_rcp_f32 v53, v53
  v_mul_f32 v58, v70, v122
  v_mfma_f32_32x32x16_bf16 v[80:95], a[36:39], v[48:51], v[80:95]
  ds_read_b64_tr_b16 a[124:125], v23 offset:34816
  ds_read_b64_tr_b16 a[126:127], v23 offset:35072
  v_exp_f32 v57, v57
  v_fma_f32 v55, v55, v121, v121
  s_waitcnt lgkmcnt(4)
  v_mfma_f32_32x32x16_bf16 v[80:95], a[40:43], a[112:115], v[80:95]
  ds_read_b64_tr_b16 v[44:45], v23 offset:35840
  ds_read_b64_tr_b16 v[46:47], v23 offset:36096
  v_rcp_f32 v54, v54
  v_mul_f32 v52, v52, v72
  v_mul_f32 v59, v71, v122
  v_mfma_f32_32x32x16_bf16 v[80:95], a[44:47], a[116:119], v[80:95]
  ds_read_b64_tr_b16 v[48:49], v23 offset:36864
  ds_read_b64_tr_b16 v[50:51], v23 offset:37120
  v_exp_f32 v58, v58
  v_fma_f32 v56, v56, v121, v121
  s_waitcnt lgkmcnt(4)
  v_mfma_f32_32x32x16_bf16 v[80:95], a[48:51], a[120:123], v[80:95]
  ds_read_b64_tr_b16 a[112:113], v23 offset:41984
  ds_read_b64_tr_b16 a[114:115], v23 offset:42240
  v_rcp_f32 v55, v55
  v_mul_f32 v53, v53, v73
  v_mfma_f32_32x32x16_bf16 v[80:95], a[52:55], a[124:127], v[80:95]
  ds_read_b64_tr_b16 a[116:117], v23 offset:43008
  ds_read_b64_tr_b16 a[118:119], v23 offset:43264
  v_exp_f32 v59, v59
  v_fma_f32 v57, v57, v121, v121
  s_waitcnt lgkmcnt(4)
  v_mfma_f32_32x32x16_bf16 v[80:95], a[56:59], v[44:47], v[80:95]
  ds_read_b64_tr_b16 a[120:121], v23 offset:44032
  ds_read_b64_tr_b16 a[122:123], v23 offset:44288
  v_rcp_f32 v56, v56
  v_mul_f32 v54, v54, v74
  v_cvt_pk_bf16_f32 v24, v52, v53
  v_mfma_f32_32x32x16_bf16 v[80:95], a[60:63], v[48:51], v[80:95]
  ds_read_b64_tr_b16 a[124:125], v23 offset:45056
  ds_read_b64_tr_b16 a[126:127], v23 offset:45312
  v_fma_f32 v58, v58, v121, v121
  v_rcp_f32 v57, v57
  v_mul_f32 v55, v55, v75
  s_waitcnt lgkmcnt(4)
  v_mfma_f32_32x32x16_bf16 v[80:95], a[64:67], a[112:115], v[80:95]
  ds_read_b64_tr_b16 v[44:45], v23 offset:46080
  ds_read_b64_tr_b16 v[46:47], v23 offset:46336
  v_fma_f32 v59, v59, v121, v121
  v_rcp_f32 v58, v58
  v_mul_f32 v56, v56, v76
  v_mfma_f32_32x32x16_bf16 v[80:95], a[68:71], a[116:119], v[80:95]
  ds_read_b64_tr_b16 v[48:49], v23 offset:47104
  ds_read_b64_tr_b16 v[50:51], v23 offset:47360
  v_cvt_pk_bf16_f32 v25, v54, v55
  v_rcp_f32 v59, v59
  v_mul_f32 v57, v57, v77
  s_waitcnt lgkmcnt(4)
  v_mfma_f32_32x32x16_bf16 v[80:95], a[72:75], a[120:123], v[80:95]
  ds_read_b64_tr_b16 a[112:113], v23 offset:48128
  ds_read_b64_tr_b16 a[114:115], v23 offset:48384
  v_mul_f32 v58, v58, v78
  v_cvt_pk_bf16_f32 v26, v56, v57
  v_mul_f32 v59, v59, v79
  v_cvt_pk_bf16_f32 v27, v58, v59
  v_mfma_f32_32x32x16_bf16 v[80:95], a[76:79], a[124:127], v[80:95]
  ds_read_b64_tr_b16 a[116:117], v23 offset:49152
  ds_read_b64_tr_b16 a[118:119], v23 offset:49408
  s_waitcnt lgkmcnt(4)
  v_mfma_f32_32x32x16_bf16 v[80:95], a[80:83], v[44:47], v[80:95]
  ds_read_b64_tr_b16 a[120:121], v23 offset:54272
  ds_read_b64_tr_b16 a[122:123], v23 offset:54528
  v_mfma_f32_32x32x16_bf16 v[80:95], a[84:87], v[48:51], v[80:95]
  ds_read_b64_tr_b16 a[124:125], v23 offset:55296
  ds_read_b64_tr_b16 a[126:127], v23 offset:55552
  s_waitcnt lgkmcnt(4)
  v_mfma_f32_32x32x16_bf16 v[80:95], a[88:91], a[112:115], v[80:95]
  ds_read_b64_tr_b16 v[44:45], v23 offset:56320
  ds_read_b64_tr_b16 v[46:47], v23 offset:56576
  v_mfma_f32_32x32x16_bf16 v[80:95], a[92:95], a[116:119], v[80:95]
  ds_read_b64_tr_b16 v[48:49], v23 offset:57344
  ds_read_b64_tr_b16 v[50:51], v23 offset:57600
  s_mul_i32 s36, s54, 114688
  s_add_u32 s36, s36, s35
  buffer_store_dwordx4 v[24:27], v6, s[16:19], s36 offen sc1
  s_barrier
  s_waitcnt lgkmcnt(4)
  v_mfma_f32_32x32x16_bf16 v[80:95], a[96:99], a[120:123], v[80:95]
  ds_read_b64_tr_b16 a[112:113], v22 offset:55680
  ds_read_b64_tr_b16 a[114:115], v22 offset:55936
  ds_read_b32 v120, v15 offset:640
  v_mfma_f32_32x32x16_bf16 v[80:95], a[100:103], a[124:127], v[80:95]
  ds_read_b64_tr_b16 a[116:117], v22 offset:56704
  ds_read_b64_tr_b16 a[118:119], v22 offset:56960
  s_waitcnt lgkmcnt(5)
  v_mfma_f32_32x32x16_bf16 v[80:95], a[104:107], v[44:47], v[80:95]
  ds_read_b64_tr_b16 a[120:121], v22 offset:57728
  ds_read_b64_tr_b16 a[122:123], v22 offset:57984
  v_mfma_f32_32x32x16_bf16 v[80:95], a[108:111], v[48:51], v[80:95]
  ds_read_b64_tr_b16 a[124:125], v22 offset:58752
  ds_read_b64_tr_b16 a[126:127], v22 offset:59008
  s_waitcnt lgkmcnt(6)
  v_lshlrev_b32 v123, 16, v120
  v_lshrrev_b32 v117, 16, v120
  v_and_b32 v120, 0xffff, v120
  v_cndmask_b32_e64 v117, v120, v117, s[42:43]
  s_waitcnt lgkmcnt(4)
  v_mfma_f32_32x32x16_bf16 v[96:111], a[0:3], a[112:115], 0
  ds_read_b64_tr_b16 v[44:45], v14 offset:25600
  ds_read_b64_tr_b16 v[46:47], v14 offset:25856
  v_lshl_or_b32 v116, v117, 16, v117
  v_rcp_f32 v124, v123
  s_nop 0
  v_mul_f32 v124, 0xbfb8aa3b, v124
  v_mfma_f32_32x32x16_bf16 v[80:95], v[112:115], v[116:119], v[80:95]
  v_mfma_f32_32x32x16_bf16 v[96:111], a[4:7], a[116:119], v[96:111]
  ds_read_b64_tr_b16 v[48:49], v14 offset:26624
  ds_read_b64_tr_b16 v[50:51], v14 offset:26880
  s_waitcnt lgkmcnt(4)
  v_mfma_f32_32x32x16_bf16 v[96:111], a[8:11], a[120:123], v[96:111]
  ds_read_b64_tr_b16 a[112:113], v14 offset:27648
  ds_read_b64_tr_b16 a[114:115], v14 offset:27904
  s_nop 4
  v_mul_f32 v52, v80, v124
  v_mul_f32 v53, v81, v124
  v_exp_f32 v52, v52
  v_mfma_f32_32x32x16_bf16 v[96:111], a[12:15], a[124:127], v[96:111]
  ds_read_b64_tr_b16 a[116:117], v14 offset:28672
  ds_read_b64_tr_b16 a[118:119], v14 offset:28928
  v_mul_f32 v54, v82, v124
  v_exp_f32 v53, v53
  v_mul_f32 v55, v83, v124
  s_waitcnt lgkmcnt(4)
  v_mfma_f32_32x32x16_bf16 v[96:111], a[16:19], v[44:47], v[96:111]
  ds_read_b64_tr_b16 a[120:121], v22 offset:25024
  ds_read_b64_tr_b16 a[122:123], v22 offset:25280
  v_exp_f32 v54, v54
  v_fma_f32 v52, v52, v123, v123
  v_mul_f32 v56, v84, v124
  v_mfma_f32_32x32x16_bf16 v[96:111], a[20:23], v[48:51], v[96:111]
  ds_read_b64_tr_b16 a[124:125], v22 offset:26048
  ds_read_b64_tr_b16 a[126:127], v22 offset:26304
  v_exp_f32 v55, v55
  v_fma_f32 v53, v53, v123, v123
  s_waitcnt lgkmcnt(4)
  v_mfma_f32_32x32x16_bf16 v[96:111], a[24:27], a[112:115], v[96:111]
  ds_read_b64_tr_b16 v[44:45], v22 offset:27072
  ds_read_b64_tr_b16 v[46:47], v22 offset:27328
  v_rcp_f32 v52, v52
  v_mul_f32 v57, v85, v124
  v_mfma_f32_32x32x16_bf16 v[96:111], a[28:31], a[116:119], v[96:111]
  ds_read_b64_tr_b16 v[48:49], v22 offset:28096
  ds_read_b64_tr_b16 v[50:51], v22 offset:28352
  v_exp_f32 v56, v56
  v_fma_f32 v54, v54, v123, v123
  s_waitcnt lgkmcnt(4)
  v_mfma_f32_32x32x16_bf16 v[96:111], a[32:35], a[120:123], v[96:111]
  ds_read_b64_tr_b16 a[112:113], v23 offset:37888
  ds_read_b64_tr_b16 a[114:115], v23 offset:38144
  v_rcp_f32 v53, v53
  v_mul_f32 v58, v86, v124
  v_mfma_f32_32x32x16_bf16 v[96:111], a[36:39], a[124:127], v[96:111]
  ds_read_b64_tr_b16 a[116:117], v23 offset:38912
  ds_read_b64_tr_b16 a[118:119], v23 offset:39168
  v_exp_f32 v57, v57
  v_fma_f32 v55, v55, v123, v123
  s_waitcnt lgkmcnt(4)
  v_mfma_f32_32x32x16_bf16 v[96:111], a[40:43], v[44:47], v[96:111]
  ds_read_b64_tr_b16 a[120:121], v23 offset:39936
  ds_read_b64_tr_b16 a[122:123], v23 offset:40192
  v_rcp_f32 v54, v54
  v_mul_f32 v52, v52, v88
  v_mul_f32 v59, v87, v124
  v_mfma_f32_32x32x16_bf16 v[96:111], a[44:47], v[48:51], v[96:111]
  ds_read_b64_tr_b16 a[124:125], v23 offset:40960
  ds_read_b64_tr_b16 a[126:127], v23 offset:41216
  v_exp_f32 v58, v58
  v_fma_f32 v56, v56, v123, v123
  s_waitcnt lgkmcnt(4)
  v_mfma_f32_32x32x16_bf16 v[96:111], a[48:51], a[112:115], v[96:111]
  ds_read_b64_tr_b16 v[44:45], v23 offset:12288
  ds_read_b64_tr_b16 v[46:47], v23 offset:12544
  v_rcp_f32 v55, v55
  v_mul_f32 v53, v53, v89
  v_mfma_f32_32x32x16_bf16 v[96:111], a[52:55], a[116:119], v[96:111]
  ds_read_b64_tr_b16 v[48:49], v23 offset:13312
  ds_read_b64_tr_b16 v[50:51], v23 offset:13568
  v_exp_f32 v59, v59
  v_fma_f32 v57, v57, v123, v123
  s_waitcnt lgkmcnt(4)
  v_mfma_f32_32x32x16_bf16 v[96:111], a[56:59], a[120:123], v[96:111]
  ds_read_b64_tr_b16 a[112:113], v23 offset:14336
  ds_read_b64_tr_b16 a[114:115], v23 offset:14592
  v_rcp_f32 v56, v56
  v_mul_f32 v54, v54, v90
  v_cvt_pk_bf16_f32 v8, v52, v53
  v_mfma_f32_32x32x16_bf16 v[96:111], a[60:63], a[124:127], v[96:111]
  ds_read_b64_tr_b16 a[116:117], v23 offset:15360
  ds_read_b64_tr_b16 a[118:119], v23 offset:15616
  v_fma_f32 v58, v58, v123, v123
  v_rcp_f32 v57, v57
  v_mul_f32 v55, v55, v91
  s_waitcnt lgkmcnt(4)
  v_mfma_f32_32x32x16_bf16 v[96:111], a[64:67], v[44:47], v[96:111]
  ds_read_b64_tr_b16 a[120:121], v22 offset:20864
  ds_read_b64_tr_b16 a[122:123], v22 offset:21120
  v_fma_f32 v59, v59, v123, v123
  v_rcp_f32 v58, v58
  v_mul_f32 v56, v56, v92
  v_mfma_f32_32x32x16_bf16 v[96:111], a[68:71], v[48:51], v[96:111]
  ds_read_b64_tr_b16 a[124:125], v22 offset:21888
  ds_read_b64_tr_b16 a[126:127], v22 offset:22144
  v_cvt_pk_bf16_f32 v9, v54, v55
  v_rcp_f32 v59, v59
  v_mul_f32 v57, v57, v93
  s_waitcnt lgkmcnt(4)
  v_mfma_f32_32x32x16_bf16 v[96:111], a[72:75], a[112:115], v[96:111]
  ds_read_b64_tr_b16 v[44:45], v22 offset:22912
  ds_read_b64_tr_b16 v[46:47], v22 offset:23168
  v_mul_f32 v58, v58, v94
  v_cvt_pk_bf16_f32 v10, v56, v57
  v_mul_f32 v59, v59, v95
  v_cvt_pk_bf16_f32 v11, v58, v59
  v_mfma_f32_32x32x16_bf16 v[96:111], a[76:79], a[116:119], v[96:111]
  ds_read_b64_tr_b16 v[48:49], v22 offset:23936
  ds_read_b64_tr_b16 v[50:51], v22 offset:24192
  s_waitcnt lgkmcnt(4)
  v_mfma_f32_32x32x16_bf16 v[96:111], a[80:83], a[120:123], v[96:111]
  ds_read_b64_tr_b16 a[112:113], v23 offset:8192
  ds_read_b64_tr_b16 a[114:115], v23 offset:8448
  v_mfma_f32_32x32x16_bf16 v[96:111], a[84:87], a[124:127], v[96:111]
  ds_read_b64_tr_b16 a[116:117], v23 offset:9216
  ds_read_b64_tr_b16 a[118:119], v23 offset:9472
  s_waitcnt lgkmcnt(4)
  v_mfma_f32_32x32x16_bf16 v[96:111], a[88:91], v[44:47], v[96:111]
  ds_read_b64_tr_b16 a[120:121], v23 offset:10240
  ds_read_b64_tr_b16 a[122:123], v23 offset:10496
  v_mfma_f32_32x32x16_bf16 v[96:111], a[92:95], v[48:51], v[96:111]
  ds_read_b64_tr_b16 a[124:125], v23 offset:11264
  ds_read_b64_tr_b16 a[126:127], v23 offset:11520
  s_waitcnt vmcnt(0)
  s_mul_i32 s36, s55, 114688
  s_add_u32 s36, s36, s35
  buffer_store_dwordx4 v[8:11], v6, s[16:19], s36 offen sc1
  s_barrier
  s_waitcnt lgkmcnt(4)
  v_mfma_f32_32x32x16_bf16 v[96:111], a[96:99], a[112:115], v[96:111]
  ds_read_b64_tr_b16 v[44:45], v14 offset:29696
  ds_read_b64_tr_b16 v[46:47], v14 offset:29952
  ds_read_b32 v120, v15 offset:768
  v_mfma_f32_32x32x16_bf16 v[96:111], a[100:103], a[116:119], v[96:111]
  ds_read_b64_tr_b16 v[48:49], v14 offset:30720
  ds_read_b64_tr_b16 v[50:51], v14 offset:30976
  s_waitcnt lgkmcnt(5)
  v_mfma_f32_32x32x16_bf16 v[96:111], a[104:107], a[120:123], v[96:111]
  ds_read_b64_tr_b16 a[112:113], v14 offset:31744
  ds_read_b64_tr_b16 a[114:115], v14 offset:32000
  v_mfma_f32_32x32x16_bf16 v[96:111], a[108:111], a[124:127], v[96:111]
  ds_read_b64_tr_b16 a[116:117], v14 offset:32768
  ds_read_b64_tr_b16 a[118:119], v14 offset:33024
  s_waitcnt lgkmcnt(6)
  v_lshlrev_b32 v121, 16, v120
  v_lshrrev_b32 v117, 16, v120
  v_and_b32 v120, 0xffff, v120
  v_cndmask_b32_e64 v117, v120, v117, s[42:43]
  s_waitcnt lgkmcnt(4)
  v_mfma_f32_32x32x16_bf16 v[28:43], a[0:3], v[44:47], 0
  ds_read_b64_tr_b16 a[120:121], v14 offset:33792
  ds_read_b64_tr_b16 a[122:123], v14 offset:34048
  v_lshl_or_b32 v116, v117, 16, v117
  v_rcp_f32 v122, v121
  s_nop 0
  v_mul_f32 v122, 0xbfb8aa3b, v122
  v_mfma_f32_32x32x16_bf16 v[96:111], v[112:115], v[116:119], v[96:111]
  v_mfma_f32_32x32x16_bf16 v[28:43], a[4:7], v[48:51], v[28:43]
  ds_read_b64_tr_b16 a[124:125], v14 offset:34816
  ds_read_b64_tr_b16 a[126:127], v14 offset:35072
  ds_read_b128 a[0:3], v18 offset:38144
  s_waitcnt lgkmcnt(5)
  v_mfma_f32_32x32x16_bf16 v[28:43], a[8:11], a[112:115], v[28:43]
  ds_read_b64_tr_b16 v[44:45], v14 offset:35840
  ds_read_b64_tr_b16 v[46:47], v14 offset:36096
  s_nop 3
  v_mul_f32 v52, v96, v122
  v_mul_f32 v53, v97, v122
  v_exp_f32 v52, v52
  v_mfma_f32_32x32x16_bf16 v[28:43], a[12:15], a[116:119], v[28:43]
  ds_read_b64_tr_b16 v[48:49], v14 offset:36864
  ds_read_b64_tr_b16 v[50:51], v14 offset:37120
  v_mul_f32 v54, v98, v122
  v_exp_f32 v53, v53
  v_mul_f32 v55, v99, v122
  s_waitcnt lgkmcnt(5)
  v_mfma_f32_32x32x16_bf16 v[28:43], a[16:19], a[120:123], v[28:43]
  ds_read_b64_tr_b16 a[112:113], v23 offset:16384
  ds_read_b64_tr_b16 a[114:115], v23 offset:16640
  v_exp_f32 v54, v54
  v_fma_f32 v52, v52, v121, v121
  v_mul_f32 v56, v100, v122
  v_mfma_f32_32x32x16_bf16 v[28:43], a[20:23], a[124:127], v[28:43]
  ds_read_b64_tr_b16 a[116:117], v23 offset:17408
  ds_read_b64_tr_b16 a[118:119], v23 offset:17664
  v_exp_f32 v55, v55
  v_fma_f32 v53, v53, v121, v121
  ds_read_b128 a[4:7], v19 offset:3008
  s_waitcnt lgkmcnt(5)
  v_mfma_f32_32x32x16_bf16 v[28:43], a[24:27], v[44:47], v[28:43]
  ds_read_b64_tr_b16 a[120:121], v23 offset:18432
  ds_read_b64_tr_b16 a[122:123], v23 offset:18688
  v_rcp_f32 v52, v52
  v_mul_f32 v57, v101, v122
  ds_read_b128 a[8:11], v13 offset:17408
  v_mfma_f32_32x32x16_bf16 v[28:43], a[28:31], v[48:51], v[28:43]
  ds_read_b64_tr_b16 a[124:125], v23 offset:19456
  ds_read_b64_tr_b16 a[126:127], v23 offset:19712
  v_exp_f32 v56, v56
  v_fma_f32 v54, v54, v121, v121
  ds_read_b128 a[12:15], v18 offset:12096
  s_waitcnt lgkmcnt(7)
  v_mfma_f32_32x32x16_bf16 v[28:43], a[32:35], a[112:115], v[28:43]
  ds_read_b64_tr_b16 v[44:45], v14 offset:9216
  ds_read_b64_tr_b16 v[46:47], v14 offset:9472
  v_rcp_f32 v53, v53
  v_mul_f32 v58, v102, v122
  ds_read_b128 a[16:19], v19 offset:20480
  v_mfma_f32_32x32x16_bf16 v[28:43], a[36:39], a[116:119], v[28:43]
  ds_read_b64_tr_b16 v[48:49], v14 offset:10240
  ds_read_b64_tr_b16 v[50:51], v14 offset:10496
  v_exp_f32 v57, v57
  v_fma_f32 v55, v55, v121, v121
  ds_read_b128 a[20:23], v19 offset:58368
  s_waitcnt lgkmcnt(7)
  v_mfma_f32_32x32x16_bf16 v[28:43], a[40:43], a[120:123], v[28:43]
  ds_read_b64_tr_b16 a[112:113], v14 offset:11264
  ds_read_b64_tr_b16 a[114:115], v14 offset:11520
  v_rcp_f32 v54, v54
  v_mul_f32 v52, v52, v104
  v_mul_f32 v59, v103, v122
  v_mfma_f32_32x32x16_bf16 v[28:43], a[44:47], a[124:127], v[28:43]
  ds_read_b64_tr_b16 a[116:117], v14 offset:12288
  ds_read_b64_tr_b16 a[118:119], v14 offset:12544
  v_exp_f32 v58, v58
  v_fma_f32 v56, v56, v121, v121
  ds_read_b128 a[24:27], v13 offset:13312
  s_waitcnt lgkmcnt(6)
  v_mfma_f32_32x32x16_bf16 v[28:43], a[48:51], v[44:47], v[28:43]
  ds_read_b64_tr_b16 a[120:121], v23 offset:25600
  ds_read_b64_tr_b16 a[122:123], v23 offset:25856
  v_rcp_f32 v55, v55
  v_mul_f32 v53, v53, v105
  ds_read_b128 a[28:31], v18 offset:7488
  v_mfma_f32_32x32x16_bf16 v[28:43], a[52:55], v[48:51], v[28:43]
  ds_read_b64_tr_b16 a[124:125], v23 offset:26624
  ds_read_b64_tr_b16 a[126:127], v23 offset:26880
  v_exp_f32 v59, v59
  v_fma_f32 v57, v57, v121, v121
  ds_read_b128 a[32:35], v19 offset:29696
  s_waitcnt lgkmcnt(7)
  v_mfma_f32_32x32x16_bf16 v[28:43], a[56:59], a[112:115], v[28:43]
  ds_read_b64_tr_b16 v[44:45], v23 offset:27648
  ds_read_b64_tr_b16 v[46:47], v23 offset:27904
  v_rcp_f32 v56, v56
  v_mul_f32 v54, v54, v106
  v_cvt_pk_bf16_f32 v60, v52, v53
  v_mfma_f32_32x32x16_bf16 v[28:43], a[60:63], a[116:119], v[28:43]
  ds_read_b64_tr_b16 v[48:49], v23 offset:28672
  ds_read_b64_tr_b16 v[50:51], v23 offset:28928
  v_fma_f32 v58, v58, v121, v121
  v_rcp_f32 v57, v57
  v_mul_f32 v55, v55, v107
  s_waitcnt lgkmcnt(5)
  v_mfma_f32_32x32x16_bf16 v[28:43], a[64:67], a[120:123], v[28:43]
  ds_read_b64_tr_b16 a[112:113], v22 offset:46912
  ds_read_b64_tr_b16 a[114:115], v22 offset:47168
  v_fma_f32 v59, v59, v121, v121
  v_rcp_f32 v58, v58
  v_mul_f32 v56, v56, v108
  v_mfma_f32_32x32x16_bf16 v[28:43], a[68:71], a[124:127], v[28:43]
  ds_read_b64_tr_b16 a[116:117], v22 offset:47936
  ds_read_b64_tr_b16 a[118:119], v22 offset:48192
  v_cvt_pk_bf16_f32 v61, v54, v55
  v_rcp_f32 v59, v59
  v_mul_f32 v57, v57, v109
  s_waitcnt lgkmcnt(4)
  v_mfma_f32_32x32x16_bf16 v[28:43], a[72:75], v[44:47], v[28:43]
  ds_read_b64_tr_b16 a[120:121], v22 offset:48960
  ds_read_b64_tr_b16 a[122:123], v22 offset:49216
  v_mul_f32 v58, v58, v110
  v_cvt_pk_bf16_f32 v62, v56, v57
  v_mul_f32 v59, v59, v111
  v_cvt_pk_bf16_f32 v63, v58, v59
  v_mfma_f32_32x32x16_bf16 v[28:43], a[76:79], v[48:51], v[28:43]
  ds_read_b64_tr_b16 a[124:125], v22 offset:49984
  ds_read_b64_tr_b16 a[126:127], v22 offset:50240
  ds_read_b128 a[36:39], v18 offset:59840
  ds_read_b128 a[40:43], v18 offset:29632
  ds_read_b128 a[44:47], v18 offset:51072
  s_waitcnt lgkmcnt(7)
  v_mfma_f32_32x32x16_bf16 v[28:43], a[80:83], a[112:115], v[28:43]
  ds_read_b64_tr_b16 v[44:45], v22 offset:42304
  ds_read_b64_tr_b16 v[46:47], v22 offset:42560
  v_mfma_f32_32x32x16_bf16 v[28:43], a[84:87], a[116:119], v[28:43]
  ds_read_b64_tr_b16 v[48:49], v22 offset:43328
  ds_read_b64_tr_b16 v[50:51], v22 offset:43584
  s_waitcnt lgkmcnt(7)
  v_mfma_f32_32x32x16_bf16 v[28:43], a[88:91], a[120:123], v[28:43]
  ds_read_b64_tr_b16 a[112:113], v22 offset:44352
  ds_read_b64_tr_b16 a[114:115], v22 offset:44608
  v_mfma_f32_32x32x16_bf16 v[28:43], a[92:95], a[124:127], v[28:43]
  ds_read_b64_tr_b16 a[116:117], v22 offset:45376
  ds_read_b64_tr_b16 a[118:119], v22 offset:45632
  s_waitcnt lgkmcnt(4)
  v_mfma_f32_32x32x16_bf16 v[28:43], a[96:99], v[44:47], v[28:43]
  v_mfma_f32_32x32x16_bf16 v[28:43], a[100:103], v[48:51], v[28:43]
  s_waitcnt lgkmcnt(0)
  v_mfma_f32_32x32x16_bf16 v[28:43], a[104:107], a[112:115], v[28:43]
  v_mfma_f32_32x32x16_bf16 v[28:43], a[108:111], a[116:119], v[28:43]
  s_mul_i32 s36, s56, 114688
  s_add_u32 s36, s36, s35
  buffer_store_dwordx4 v[60:63], v6, s[16:19], s36 offen sc1
  s_barrier
  ds_read_b32 v120, v15 offset:896
  s_waitcnt lgkmcnt(0)
  v_lshlrev_b32 v123, 16, v120
  v_lshrrev_b32 v117, 16, v120
  v_and_b32 v120, 0xffff, v120
  v_cndmask_b32_e64 v117, v120, v117, s[42:43]
  v_lshl_or_b32 v116, v117, 16, v117
  v_rcp_f32 v124, v123
  s_nop 0
  v_mul_f32 v124, 0xbfb8aa3b, v124
  v_mfma_f32_32x32x16_bf16 v[28:43], v[112:115], v[116:119], v[28:43]
  ds_read_b128 a[48:51], v18 offset:16256
  ds_read_b128 a[52:55], v19 offset:50176
  ds_read_b128 a[56:59], v13 offset:5120
  ds_read_b128 a[60:63], v19 offset:46080
  ds_read_b128 a[64:67], v18 offset:3328
  ds_read_b128 a[68:71], v13 offset:21504
  ds_read_b128 a[72:75], v18 offset:33792
  ds_read_b128 a[76:79], v13 offset:1024
  ds_read_b128 a[80:83], v19 offset:33792
  ds_read_b128 a[84:87], v19 offset:12288
  ds_read_b128 a[88:91], v19 offset:41984
  ds_read_b128 a[92:95], v18 offset:25024
  ds_read_b128 a[96:99], v18 offset:20864
  ds_read_b128 a[100:103], v18 offset:55680
  ds_read_b128 a[104:107], v13 offset:25600
  ds_read_b128 a[108:111], v19 offset:37888
  v_mul_f32 v52, v28, v124
  v_mul_f32 v53, v29, v124
  v_exp_f32 v52, v52
  v_mul_f32 v54, v30, v124
  v_exp_f32 v53, v53
  s_bfe_u32 s25, s60, 0x4000c
  s_lshl_b32 s25, s25, 12
  s_add_u32 s25, s25, s44
  buffer_load_dwordx4 v[80:83], v6, s[16:19], s25 offen offset:2048 sc1
  buffer_load_dwordx4 v[84:87], v6, s[16:19], s25 offen offset:3072 sc1
  v_mul_f32 v55, v31, v124
  v_exp_f32 v54, v54
  v_fma_f32 v52, v52, v123, v123
  v_mul_f32 v56, v32, v124
  v_exp_f32 v55, v55
  s_bfe_u32 s25, s60, 0x40010
  s_lshl_b32 s25, s25, 12
  s_add_u32 s25, s25, s44
  buffer_load_dwordx4 v[88:91], v6, s[16:19], s25 offen offset:0 sc1
  buffer_load_dwordx4 v[92:95], v6, s[16:19], s25 offen offset:1024 sc1
  v_fma_f32 v53, v53, v123, v123
  v_rcp_f32 v52, v52
  v_mul_f32 v57, v33, v124
  v_exp_f32 v56, v56
  v_fma_f32 v54, v54, v123, v123
  s_bfe_u32 s25, s60, 0x40010
  s_lshl_b32 s25, s25, 12
  s_add_u32 s25, s25, s44
  buffer_load_dwordx4 v[96:99], v6, s[16:19], s25 offen offset:2048 sc1
  buffer_load_dwordx4 v[100:103], v6, s[16:19], s25 offen offset:3072 sc1
  v_rcp_f32 v53, v53
  v_mul_f32 v58, v34, v124
  v_exp_f32 v57, v57
  v_fma_f32 v55, v55, v123, v123
  v_rcp_f32 v54, v54
  s_bfe_u32 s25, s60, 0x40014
  s_lshl_b32 s25, s25, 12
  s_add_u32 s25, s25, s44
  buffer_load_dwordx4 v[104:107], v6, s[16:19], s25 offen offset:0 sc1
  buffer_load_dwordx4 v[108:111], v6, s[16:19], s25 offen offset:1024 sc1
  v_mul_f32 v52, v52, v36
  v_mul_f32 v59, v35, v124
  v_exp_f32 v58, v58
  v_fma_f32 v56, v56, v123, v123
  v_rcp_f32 v55, v55
  s_bfe_u32 s25, s60, 0x40014
  s_lshl_b32 s25, s25, 12
  s_add_u32 s25, s25, s44
  buffer_load_dwordx4 a[112:115], v6, s[16:19], s25 offen offset:2048 sc1
  buffer_load_dwordx4 a[116:119], v6, s[16:19], s25 offen offset:3072 sc1
  v_mul_f32 v53, v53, v37
  v_exp_f32 v59, v59
  v_fma_f32 v57, v57, v123, v123
  v_rcp_f32 v56, v56
  v_mul_f32 v54, v54, v38
  s_bfe_u32 s25, s60, 0x40018
  s_lshl_b32 s25, s25, 12
  s_add_u32 s25, s25, s44
  buffer_load_dwordx4 v[64:67], v6, s[16:19], s25 offen offset:0 sc1
  buffer_load_dwordx4 v[68:71], v6, s[16:19], s25 offen offset:1024 sc1
  v_cvt_pk_bf16_f32 v24, v52, v53
  v_fma_f32 v58, v58, v123, v123
  v_rcp_f32 v57, v57
  v_mul_f32 v55, v55, v39
  v_fma_f32 v59, v59, v123, v123
  s_bfe_u32 s25, s60, 0x40018
  s_lshl_b32 s25, s25, 12
  s_add_u32 s25, s25, s44
  buffer_load_dwordx4 v[72:75], v6, s[16:19], s25 offen offset:2048 sc1
  buffer_load_dwordx4 v[76:79], v6, s[16:19], s25 offen offset:3072 sc1
  v_rcp_f32 v58, v58
  v_mul_f32 v56, v56, v40
  v_cvt_pk_bf16_f32 v25, v54, v55
  v_rcp_f32 v59, v59
  v_mul_f32 v57, v57, v41
  v_mul_f32 v58, v58, v42
  v_cvt_pk_bf16_f32 v26, v56, v57
  v_mul_f32 v59, v59, v43
  v_cvt_pk_bf16_f32 v27, v58, v59
  s_mul_i32 s36, s57, 114688
  s_add_u32 s36, s36, s35
  buffer_store_dwordx4 v[24:27], v6, s[16:19], s36 offen sc1
  s_setprio 0
  s_waitcnt vmcnt(13)
  v_max_u32 v60, v80, v84
  v_cmp_eq_u32 vcc, -1, v60
  s_cbranch_vccnz MC_SLOW2
MC_RET2:
  v_mfma_f32_32x32x16_bf16 v[28:43], v[80:83], a[0:3], 0
  s_mov_b32 s20, s62
  s_and_b32 s21, s63, 0xffff
  s_mov_b32 s22, 0x1c0000
  v_mfma_f32_32x32x16_bf16 v[44:59], v[80:83], a[4:7], 0
  s_mov_b32 s23, 0x20000
  v_and_b32 v8, 0xf0, v6
  v_bfe_u32 v9, v2, 4, 1
  v_mfma_f32_32x32x16_bf16 v[28:43], v[84:87], a[8:11], v[28:43]
  v_lshl_add_u32 v12, v9, 12, v8
  v_lshl_add_u32 v12, v3, 8, v12
  v_and_b32 v10, 0x70, v6
  v_mfma_f32_32x32x16_bf16 v[44:59], v[84:87], a[12:15], v[44:59]
  v_lshl_add_u32 v10, v9, 7, v10
  v_bfe_u32 v9, v2, 3, 1
  v_lshl_add_u32 v9, v9, 2, v3
  s_waitcnt vmcnt(11)
  v_max_u32 v60, v88, v92
  v_cmp_eq_u32 vcc, -1, v60
  s_cbranch_vccnz MC_SLOW3
MC_RET3:
  v_mfma_f32_32x32x16_bf16 v[28:43], v[88:91], a[16:19], v[28:43]
  v_lshl_add_u32 v11, v9, 1, v10
  v_mul_u32_u24 v14, 896, v9
  v_lshrrev_b32 v9, 1, v10
  v_mfma_f32_32x32x16_bf16 v[44:59], v[88:91], a[20:23], v[44:59]
  v_add_u32 v14, v14, v9
  v_add_u32 v10, 160768, v10
  s_mul_i32 s41, s24, 28672
  v_mfma_f32_32x32x16_bf16 v[28:43], v[92:95], a[24:27], v[28:43]
  s_lshl_b32 s46, s58, 7
  s_add_u32 s41, s41, s46
  s_lshr_b32 s46, s4, 1
  v_mfma_f32_32x32x16_bf16 v[44:59], v[92:95], a[28:31], v[44:59]
  s_and_b32 s47, s4, 1
  s_lshl2_add_u32 s40, s46, s47
  s_mul_i32 s40, s40, 1792
  s_waitcnt vmcnt(9)
  v_max_u32 v60, v96, v100
  v_cmp_eq_u32 vcc, -1, v60
  s_cbranch_vccnz MC_SLOW4
MC_RET4:
  v_mfma_f32_32x32x16_bf16 v[28:43], v[96:99], a[32:35], v[28:43]
  s_add_u32 s40, s40, s41
  s_add_u32 s40, s40, 917504
  s_lshl_b32 s46, s46, 8
  v_mfma_f32_32x32x16_bf16 v[44:59], v[96:99], a[36:39], v[44:59]
  s_lshl2_add_u32 s46, s47, s46
  s_add_u32 s46, s46, 156672
  v_add_u32 v11, s46, v11
  v_mfma_f32_32x32x16_bf16 v[28:43], v[100:103], a[40:43], v[28:43]
  s_lshl_b32 s46, s4, 9
  s_add_u32 s46, s46, 65536
  v_add_u32 v8, s46, v12
  v_mfma_f32_32x32x16_bf16 v[44:59], v[100:103], a[44:47], v[44:59]
  s_waitcnt vmcnt(7)
  v_max_u32 v60, v104, v108
  v_cmp_eq_u32 vcc, -1, v60
  s_cbranch_vccnz MC_SLOW5
MC_RET5:
  s_waitcnt lgkmcnt(12)
  v_mfma_f32_32x32x16_bf16 v[28:43], v[104:107], a[48:51], v[28:43]
  v_mfma_f32_32x32x16_bf16 v[44:59], v[104:107], a[52:55], v[44:59]
  v_mfma_f32_32x32x16_bf16 v[28:43], v[108:111], a[56:59], v[28:43]
  v_mfma_f32_32x32x16_bf16 v[44:59], v[108:111], a[60:63], v[44:59]
  s_waitcnt vmcnt(5)
  v_accvgpr_read_b32 v60, a112
  v_accvgpr_read_b32 v61, a116
  v_max_u32 v60, v60, v61
  v_cmp_eq_u32 vcc, -1, v60
  s_cbranch_vccnz MC_SLOW6
MC_RET6:
  s_waitcnt lgkmcnt(8)
  v_mfma_f32_32x32x16_bf16 v[28:43], a[112:115], a[64:67], v[28:43]
  v_mfma_f32_32x32x16_bf16 v[44:59], a[112:115], a[68:71], v[44:59]
  v_mfma_f32_32x32x16_bf16 v[28:43], a[116:119], a[72:75], v[28:43]
  v_mfma_f32_32x32x16_bf16 v[44:59], a[116:119], a[76:79], v[44:59]
  s_waitcnt vmcnt(3)
  v_max_u32 v60, v64, v68
  v_cmp_eq_u32 vcc, -1, v60
  s_cbranch_vccnz MC_SLOW7
MC_RET7:
  s_waitcnt lgkmcnt(4)
  v_mfma_f32_32x32x16_bf16 v[28:43], v[64:67], a[80:83], v[28:43]
  v_mfma_f32_32x32x16_bf16 v[44:59], v[64:67], a[84:87], v[44:59]
  v_mfma_f32_32x32x16_bf16 v[28:43], v[68:71], a[88:91], v[28:43]
  v_mfma_f32_32x32x16_bf16 v[44:59], v[68:71], a[92:95], v[44:59]
  s_waitcnt vmcnt(1)
  v_max_u32 v60, v72, v76
  v_cmp_eq_u32 vcc, -1, v60
  s_cbranch_vccnz MC_SLOW8
MC_RET8:
  s_waitcnt lgkmcnt(0)
  v_mfma_f32_32x32x16_bf16 v[28:43], v[72:75], a[96:99], v[28:43]
  v_mfma_f32_32x32x16_bf16 v[44:59], v[72:75], a[100:103], v[44:59]
  v_mfma_f32_32x32x16_bf16 v[28:43], v[76:79], a[104:107], v[28:43]
  v_mfma_f32_32x32x16_bf16 v[44:59], v[76:79], a[108:111], v[44:59]
  s_waitcnt lgkmcnt(0)
  s_barrier
  s_bfe_u32 s25, s60, 0x4000c
  s_lshl_b32 s25, s25, 12
  s_add_u32 s25, s25, s45
  s_lshl_b32 m0, s4, 13
  buffer_load_dwordx4 a[120:123], v6, s[16:19], s25 offen offset:2048 sc1
  s_nop 3
  ds_write_addtid_b32 v28 offset:0
  ds_write_addtid_b32 v29 offset:256
  ds_write_addtid_b32 v30 offset:512
  ds_write_addtid_b32 v31 offset:768
  buffer_load_dwordx4 a[124:127], v6, s[16:19], s25 offen offset:3072 sc1
  s_bfe_u32 s25, s60, 0x40010
  s_lshl_b32 s25, s25, 12
  s_add_u32 s25, s25, s45
  ds_write_addtid_b32 v32 offset:1024
  ds_write_addtid_b32 v33 offset:1280
  ds_write_addtid_b32 v34 offset:1536
  ds_write_addtid_b32 v35 offset:1792
  buffer_load_dwordx4 v[20:23], v6, s[16:19], s25 offen offset:0 sc1
  ds_write_addtid_b32 v36 offset:2048
  ds_write_addtid_b32 v37 offset:2304
  ds_write_addtid_b32 v38 offset:2560
  ds_write_addtid_b32 v39 offset:2816
  buffer_load_dwordx4 v[24:27], v6, s[16:19], s25 offen offset:1024 sc1
  s_bfe_u32 s25, s60, 0x40010
  s_lshl_b32 s25, s25, 12
  s_add_u32 s25, s25, s45
  ds_write_addtid_b32 v40 offset:3072
  ds_write_addtid_b32 v41 offset:3328
  ds_write_addtid_b32 v42 offset:3584
  ds_write_addtid_b32 v43 offset:3840
  buffer_load_dwordx4 v[80:83], v6, s[16:19], s25 offen offset:2048 sc1
  ds_write_addtid_b32 v44 offset:4096
  ds_write_addtid_b32 v45 offset:4352
  ds_write_addtid_b32 v46 offset:4608
  ds_write_addtid_b32 v47 offset:4864
  buffer_load_dwordx4 v[84:87], v6, s[16:19], s25 offen offset:3072 sc1
  s_bfe_u32 s25, s60, 0x40014
  s_lshl_b32 s25, s25, 12
  s_add_u32 s25, s25, s45
  ds_write_addtid_b32 v48 offset:5120
  ds_write_addtid_b32 v49 offset:5376
  ds_write_addtid_b32 v50 offset:5632
  ds_write_addtid_b32 v51 offset:5888
  buffer_load_dwordx4 v[88:91], v6, s[16:19], s25 offen offset:0 sc1
  ds_write_addtid_b32 v52 offset:6144
  ds_write_addtid_b32 v53 offset:6400
  ds_write_addtid_b32 v54 offset:6656
  ds_write_addtid_b32 v55 offset:6912
  buffer_load_dwordx4 v[92:95], v6, s[16:19], s25 offen offset:1024 sc1
  s_bfe_u32 s25, s60, 0x40014
  s_lshl_b32 s25, s25, 12
  s_add_u32 s25, s25, s45
  ds_write_addtid_b32 v56 offset:7168
  ds_write_addtid_b32 v57 offset:7424
  ds_write_addtid_b32 v58 offset:7680
  ds_write_addtid_b32 v59 offset:7936
  buffer_load_dwordx4 v[96:99], v6, s[16:19], s25 offen offset:2048 sc1
  buffer_load_dwordx4 v[100:103], v6, s[16:19], s25 offen offset:3072 sc1
  s_bfe_u32 s25, s60, 0x40018
  s_lshl_b32 s25, s25, 12
  s_add_u32 s25, s25, s45
  buffer_load_dwordx4 v[104:107], v6, s[16:19], s25 offen offset:0 sc1
  buffer_load_dwordx4 v[108:111], v6, s[16:19], s25 offen offset:1024 sc1
  s_bfe_u32 s25, s60, 0x40018
  s_lshl_b32 s25, s25, 12
  s_add_u32 s25, s25, s45
  buffer_load_dwordx4 a[112:115], v6, s[16:19], s25 offen offset:2048 sc1
  buffer_load_dwordx4 a[116:119], v6, s[16:19], s25 offen offset:3072 sc1
  s_waitcnt vmcnt(12)
  v_accvgpr_read_b32 v60, a120
  v_accvgpr_read_b32 v61, a124
  v_max_u32 v60, v60, v61
  v_cmp_eq_u32 vcc, -1, v60
  s_cbranch_vccnz MC_SLOW9
MC_RET9:
  v_mfma_f32_32x32x16_bf16 v[112:127], a[120:123], a[0:3], 0
  v_mfma_f32_32x32x16_bf16 v[64:79], a[120:123], a[4:7], 0
  v_mfma_f32_32x32x16_bf16 v[112:127], a[124:127], a[8:11], v[112:127]
  v_mfma_f32_32x32x16_bf16 v[64:79], a[124:127], a[12:15], v[64:79]
  s_waitcnt vmcnt(10)
  v_max_u32 v60, v20, v24
  v_cmp_eq_u32 vcc, -1, v60
  s_cbranch_vccnz MC_SLOW10
MC_RET10:
  v_mfma_f32_32x32x16_bf16 v[112:127], v[20:23], a[16:19], v[112:127]
  v_mfma_f32_32x32x16_bf16 v[64:79], v[20:23], a[20:23], v[64:79]
  v_mfma_f32_32x32x16_bf16 v[112:127], v[24:27], a[24:27], v[112:127]
  v_mfma_f32_32x32x16_bf16 v[64:79], v[24:27], a[28:31], v[64:79]
  s_waitcnt lgkmcnt(0)
  s_barrier
  s_waitcnt vmcnt(8)
  v_max_u32 v60, v80, v84
  v_cmp_eq_u32 vcc, -1, v60
  s_cbranch_vccnz MC_SLOW11
MC_RET11:
  v_mfma_f32_32x32x16_bf16 v[112:127], v[80:83], a[32:35], v[112:127]
  v_mfma_f32_32x32x16_bf16 v[64:79], v[80:83], a[36:39], v[64:79]
  v_mfma_f32_32x32x16_bf16 v[112:127], v[84:87], a[40:43], v[112:127]
  v_mfma_f32_32x32x16_bf16 v[64:79], v[84:87], a[44:47], v[64:79]
  s_waitcnt vmcnt(6)
  v_max_u32 v60, v88, v92
  v_cmp_eq_u32 vcc, -1, v60
  s_cbranch_vccnz MC_SLOW12
MC_RET12:
  v_mfma_f32_32x32x16_bf16 v[112:127], v[88:91], a[48:51], v[112:127]
  v_mfma_f32_32x32x16_bf16 v[64:79], v[88:91], a[52:55], v[64:79]
  v_mfma_f32_32x32x16_bf16 v[112:127], v[92:95], a[56:59], v[112:127]
  v_mfma_f32_32x32x16_bf16 v[64:79], v[92:95], a[60:63], v[64:79]
  s_waitcnt vmcnt(4)
  v_max_u32 v60, v96, v100
  v_cmp_eq_u32 vcc, -1, v60
  s_cbranch_vccnz MC_SLOW13
MC_RET13:
  v_mfma_f32_32x32x16_bf16 v[112:127], v[96:99], a[64:67], v[112:127]
  ds_read_b128 v[40:43], v8 offset:32768
  ds_read_b128 v[44:47], v8 offset:40960
  ds_read_b128 v[48:51], v8 offset:49152
  v_mfma_f32_32x32x16_bf16 v[64:79], v[96:99], a[68:71], v[64:79]
  ds_read_b128 v[52:55], v8 offset:57344
  ds_read_u16 v36, v11 offset:0
  ds_read_u16 v37, v11 offset:1024
  v_mfma_f32_32x32x16_bf16 v[112:127], v[100:103], a[72:75], v[112:127]
  ds_read_u16 v38, v11 offset:2048
  ds_read_u16 v39, v11 offset:3072
  ds_read_b128 v[28:31], v10
  v_mfma_f32_32x32x16_bf16 v[64:79], v[100:103], a[76:79], v[64:79]
  ds_read_b128 v[32:35], v10 offset:256
  s_waitcnt vmcnt(2)
  v_max_u32 v60, v104, v108
  v_cmp_eq_u32 vcc, -1, v60
  s_cbranch_vccnz MC_SLOW14
MC_RET14:
  v_mfma_f32_32x32x16_bf16 v[112:127], v[104:107], a[80:83], v[112:127]
  v_mfma_f32_32x32x16_bf16 v[64:79], v[104:107], a[84:87], v[64:79]
  v_mfma_f32_32x32x16_bf16 v[112:127], v[108:111], a[88:91], v[112:127]
  v_mfma_f32_32x32x16_bf16 v[64:79], v[108:111], a[92:95], v[64:79]
  s_waitcnt vmcnt(0)
  v_accvgpr_read_b32 v60, a112
  v_accvgpr_read_b32 v61, a116
  v_max_u32 v60, v60, v61
  v_cmp_eq_u32 vcc, -1, v60
  s_cbranch_vccnz MC_SLOW15
MC_RET15:
  v_mfma_f32_32x32x16_bf16 v[112:127], a[112:115], a[96:99], v[112:127]
  s_waitcnt lgkmcnt(0)
  v_add_f32 v40, v40, v44
  v_add_f32 v41, v41, v45
  v_add_f32 v42, v42, v46
  v_add_f32 v43, v43, v47
  v_add_f32 v48, v48, v52
  v_mfma_f32_32x32x16_bf16 v[112:127], a[116:119], a[104:107], v[112:127]
  v_add_f32 v49, v49, v53
  v_add_f32 v50, v50, v54
  v_add_f32 v51, v51, v55
  v_add_f32 v40, v40, v48
  v_add_f32 v41, v41, v49
  v_add_f32 v42, v42, v50
  v_add_f32 v43, v43, v51
  v_mfma_f32_32x32x16_bf16 v[64:79], a[112:115], a[100:103], v[64:79]
  v_lshlrev_b32 v36, 16, v36
  v_lshlrev_b32 v37, 16, v37
  v_lshlrev_b32 v38, 16, v38
  v_lshlrev_b32 v39, 16, v39
  v_mul_f32 v36, v36, v32
  v_mul_f32 v37, v37, v33
  v_mfma_f32_32x32x16_bf16 v[64:79], a[116:119], a[108:111], v[64:79]
  v_mul_f32 v38, v38, v34
  v_mul_f32 v39, v39, v35
  v_fma_f32 v36, v40, v28, v36
  v_fma_f32 v37, v41, v29, v37
  v_fma_f32 v38, v42, v30, v38
  v_fma_f32 v39, v43, v31, v39
  s_lshl_b32 m0, s4, 13
  s_add_u32 m0, m0, 8064
  s_nop 0
  ds_write_addtid_b32 v112 offset:57472
  ds_write_addtid_b32 v113 offset:57728
  ds_write_addtid_b32 v114 offset:57984
  ds_write_addtid_b32 v115 offset:58240
  ds_write_addtid_b32 v116 offset:58496
  ds_write_addtid_b32 v117 offset:58752
  ds_write_addtid_b32 v118 offset:59008
  ds_write_addtid_b32 v119 offset:59264
  ds_write_addtid_b32 v120 offset:59520
  ds_write_addtid_b32 v121 offset:59776
  ds_write_addtid_b32 v122 offset:60032
  ds_write_addtid_b32 v123 offset:60288
  ds_write_addtid_b32 v124 offset:60544
  ds_write_addtid_b32 v125 offset:60800
  ds_write_addtid_b32 v126 offset:61056
  ds_write_addtid_b32 v127 offset:61312
  ds_write_addtid_b32 v64 offset:61568
  ds_write_addtid_b32 v65 offset:61824
  ds_write_addtid_b32 v66 offset:62080
  ds_write_addtid_b32 v67 offset:62336
  ds_write_addtid_b32 v68 offset:62592
  ds_write_addtid_b32 v69 offset:62848
  ds_write_addtid_b32 v70 offset:63104
  ds_write_addtid_b32 v71 offset:63360
  ds_write_addtid_b32 v72 offset:63616
  ds_write_addtid_b32 v73 offset:63872
  ds_write_addtid_b32 v74 offset:64128
  ds_write_addtid_b32 v75 offset:64384
  ds_write_addtid_b32 v76 offset:64640
  ds_write_addtid_b32 v77 offset:64896
  ds_write_addtid_b32 v78 offset:65152
  ds_write_addtid_b32 v79 offset:65408
  s_waitcnt lgkmcnt(0)
  s_barrier
  ds_read_b128 v[80:83], v8 offset:0
  ds_read_b128 v[84:87], v8 offset:8192
  ds_read_b128 v[88:91], v8 offset:16384
  ds_read_b128 v[92:95], v8 offset:24576
  s_waitcnt lgkmcnt(2)
  v_add_f32 v80, v80, v84
  v_add_f32 v81, v81, v85
  v_add_f32 v82, v82, v86
  v_add_f32 v83, v83, v87
  s_waitcnt lgkmcnt(0)
  v_add_f32 v88, v88, v92
  v_add_f32 v89, v89, v93
  v_add_f32 v90, v90, v94
  v_add_f32 v91, v91, v95
  v_add_f32 v80, v80, v88
  v_add_f32 v81, v81, v89
  v_add_f32 v82, v82, v90
  v_add_f32 v83, v83, v91
  v_fma_f32 v80, v80, v28, v36
  v_fma_f32 v81, v81, v29, v37
  v_fma_f32 v82, v82, v30, v38
  v_fma_f32 v83, v83, v31, v39
  v_cvt_pk_bf16_f32 v84, v80, v81
  v_cvt_pk_bf16_f32 v85, v82, v83
  buffer_store_dwordx2 v[84:85], v14, s[20:23], s40 offen sc1
END:
  s_endpgm
MH_CONT:
  s_mul_i32 s10, s18, 528384
  s_mul_i32 s11, s19, 528384
  s_lshl_b32 s25, s2, 6
  s_lshl_b32 s22, s22, 6
  s_add_u32 s10, s10, s25
  s_add_u32 s11, s11, s22
  s_add_u32 s10, s10, 2097152
  s_add_u32 s11, s11, 2097152
  v_lshrrev_b32 v21, 2, v2
  v_and_b32 v22, 3, v2
  v_mul_u32_u24 v84, 16512, v21
  v_lshl_add_u32 v84, v22, 4, v84
  v_lshlrev_b32 v23, 3, v22
  v_xor_b32 v23, v23, v21
  v_lshlrev_b32 v23, 2, v23
  v_lshl_add_u32 v23, v22, 8, v23
  v_add_u32 v85, s24, v23
  v_xor_b32 v86, 64, v85
  v_lshlrev_b32 v6, 4, v2
  s_mov_b32 s31, 20000
  s_and_b32 s5, s12, 1
  s_lshl2_add_u32 s5, s5, s13
  s_lshr_b32 s6, s12, 1
  s_mul_i32 s6, s6, 7
  s_add_u32 s6, s6, s14
  s_mul_i32 s29, s28, 34816
  s_mul_i32 s7, s7, 8704
  v_add_u32 v49, s29, v32
  v_and_b32 v21, 31, v2
  v_mul_u32_u24 v44, 272, v21
  v_add_u32 v44, s7, v44
  v_lshl_add_u32 v44, v3, 4, v44
  v_lshlrev_b32 v45, 3, v21
  v_lshl_add_u32 v45, v3, 2, v45
  v_cmp_eq_u32 s[16:17], 0, v3
  v_lshlrev_b32 v22, 2, v21
  v_lshlrev_b32 v23, 1, v21
  v_add_u32 v22, 256, v22
  v_add_u32 v23, 384, v23
  v_cndmask_b32_e64 v46, v23, v22, s[16:17]
  v_cndmask_b32_e64 v22, 64, 2, s[16:17]
  v_add_u32 v47, v46, v22
  v_lshl_add_u32 v48, v3, 7, v21
  v_add_u32 v48, 512, v48
  v_lshrrev_b32 v22, 4, v45
  v_add_u32 v45, v45, v22
  v_lshl_add_u32 v45, v45, 2, s7
  v_lshrrev_b32 v22, 4, v46
  v_add_u32 v46, v46, v22
  v_lshl_add_u32 v46, v46, 2, s7
  v_lshrrev_b32 v22, 4, v47
  v_add_u32 v47, v47, v22
  v_lshl_add_u32 v47, v47, 2, s7
  v_lshrrev_b32 v22, 4, v48
  v_add_u32 v48, v48, v22
  v_lshl_add_u32 v48, v48, 2, s7
  s_mov_b32 s32, s15
  s_mov_b32 s51, s13
  s_and_b32 s33, s14, 3
  s_cmp_lt_u32 s15, 2
  s_cselect_b32 s52, s52, s54
  s_cselect_b32 s53, s53, s55
  s_mov_b32 s12, s52
  s_and_b32 s13, s53, 0xffff
  s_mov_b32 s14, 0x188000
  s_mov_b32 s15, 0x20000
  s_mov_b32 s20, s64
  s_and_b32 s21, s65, 0xffff
  s_mov_b32 s22, 0x100
  s_mov_b32 s23, 0x20000
  s_mov_b32 s16, s66
  s_and_b32 s17, s67, 0xffff
  s_mov_b32 s18, 0x1400000
  s_mov_b32 s19, 0x20000
  s_lshr_b64 s[70:71], s[68:69], 8
  s_sub_u32 s69, s70, 3
  v_lshrrev_b32 v21, 3, v2
  v_and_b32 v22, 7, v2
  v_mul_u32_u24 v20, 28928, v21
  v_lshl_add_u32 v20, v22, 4, v20
  v_mov_b32 v24, -1
  v_mov_b32 v25, -1
  v_mov_b32 v26, -1
  v_mov_b32 v27, -1
  s_mul_i32 s35, s4, 231424
  s_lshl_b32 s25, s3, 7
  s_add_u32 s35, s35, s25
  s_add_u32 s35, s35, 147456
  s_lshl_b32 s39, s3, 5
  v_lshrrev_b32 v21, 1, v2
  v_cmp_eq_u32 vcc, 3, v21
  s_nop 1
  v_addc_co_u32 v21, vcc, 0, v21, vcc
  v_mul_u32_u24 v7, 7168, v21
  v_and_b32 v21, 1, v2
  v_lshl_add_u32 v7, v21, 4, v7
  s_add_u32 s39, s39, 90112
  s_movk_i32 s25, 255
  s_movk_i32 s26, 204
  v_cmp_ne_u32 s[54:55], s25, v1
  v_cmp_gt_u32 s[56:57], s26, v1
  s_lshr_b32 s27, s4, 1
  v_and_b32 v21, 15, v2
  v_lshrrev_b32 v22, 4, v2
  v_and_b32 v23, 3, v21
  v_sub_u32 v23, 3, v23
  v_mul_u32_u24 v8, 8768, v23
  v_lshrrev_b32 v23, 2, v21
  v_lshlrev_b32 v23, 3, v23
  v_sub_u32 v8, v8, v23
  v_lshl_add_u32 v8, v22, 4, v8
  s_lshl_b32 s50, s27, 6
  s_sub_u32 s26, s29, s50
  s_add_u32 s26, s26, 3544
  v_add_u32 v8, s26, v8
  v_lshlrev_b32 v9, 5, v21
  v_lshl_add_u32 v9, v22, 4, v9
  s_mul_i32 s26, s28, 4608
  s_sub_u32 s26, s26, s50
  s_add_u32 s26, s26, 69856
  v_add_u32 v9, s26, v9
  v_lshl_add_u32 v22, v21, 1, v3
  v_bfe_u32 v23, v22, 3, 1
  v_xor_b32 v22, v22, v23
  v_bfe_u32 v23, v2, 4, 1
  v_lshl_add_u32 v22, v23, 5, v22
  v_lshl_add_u32 v11, v22, 4, s7
  s_lshl_b32 s47, s4, 11
  s_mul_i32 s34, s3, 16512
  s_add_u32 s34, s34, s47
  s_add_u32 s34, s34, 2097152
  s_mov_b32 s46, 0x3e22f983
  s_waitcnt vmcnt(9)
  v_add_u32_sdwa v32, s29, v122 dst_sel:DWORD dst_unused:UNUSED_PAD src0_sel:DWORD src1_sel:WORD_0
  v_add_u32_sdwa v33, s29, v122 dst_sel:DWORD dst_unused:UNUSED_PAD src0_sel:DWORD src1_sel:WORD_1
  v_add_u32_sdwa v34, s29, v123 dst_sel:DWORD dst_unused:UNUSED_PAD src0_sel:DWORD src1_sel:WORD_0
  v_add_u32_sdwa v35, s29, v123 dst_sel:DWORD dst_unused:UNUSED_PAD src0_sel:DWORD src1_sel:WORD_1
  v_add_u32_sdwa v36, s29, v124 dst_sel:DWORD dst_unused:UNUSED_PAD src0_sel:DWORD src1_sel:WORD_0
  v_add_u32_sdwa v37, s29, v124 dst_sel:DWORD dst_unused:UNUSED_PAD src0_sel:DWORD src1_sel:WORD_1
  v_add_u32_sdwa v38, s29, v125 dst_sel:DWORD dst_unused:UNUSED_PAD src0_sel:DWORD src1_sel:WORD_0
  v_add_u32_sdwa v39, s29, v125 dst_sel:DWORD dst_unused:UNUSED_PAD src0_sel:DWORD src1_sel:WORD_1
  v_add_u32_sdwa v40, s29, v126 dst_sel:DWORD dst_unused:UNUSED_PAD src0_sel:DWORD src1_sel:WORD_0
  v_add_u32_sdwa v41, s29, v126 dst_sel:DWORD dst_unused:UNUSED_PAD src0_sel:DWORD src1_sel:WORD_1
  v_add_u32_sdwa v42, s29, v127 dst_sel:DWORD dst_unused:UNUSED_PAD src0_sel:DWORD src1_sel:WORD_0
  s_waitcnt vmcnt(2)
  v_lshlrev_b32 v31, 16, v31
  v_mul_f32 v31, 0x3fb8aa3b, v31
  v_exp_f32 v31, v31
  v_lshlrev_b32 v58, 16, v58
  v_lshlrev_b32 v59, 16, v59
  v_lshlrev_b32 v60, 16, v60
  v_lshlrev_b32 v61, 16, v61
  v_lshlrev_b32 v62, 16, v62
  v_lshlrev_b32 v63, 16, v63
  v_cvt_pk_bf16_f32 v31, 0, v31
  v_mul_f32 v121, 0x3fb8aa3b, v31
  v_mul_f32 v59, v59, v31
  v_mul_f32 v58, v58, v121
  v_mul_f32 v96, s46, v59
  v_mul_f32 v100, v62, v60
  v_mul_f32 v101, v62, v61
  v_fma_f32 v97, v59, s46, -v96
  v_fma_f32 v100, -v63, v61, v100
  v_fma_f32 v101, v63, v60, v101
  v_fmac_f32 v97, 0x31dc9c88, v59
  v_exp_f32 v98, v58
  v_fract_f32 v99, v96
  v_add_f32 v99, v99, v97
  v_cos_f32 v104, v99
  v_sin_f32 v105, v99
  v_mul_f32 v104, v104, v98
  v_mul_f32 v105, v105, v98
  v_mul_f32 v98, 0x43800000, v58
  v_mul_f32 v99, 0x43800000, v96
  v_exp_f32 v98, v98
  v_fract_f32 v99, v99
  v_fmac_f32 v99, 0x43800000, v97
  v_cos_f32 v106, v99
  v_sin_f32 v107, v99
  v_mul_f32 v106, v106, v98
  v_mul_f32 v107, v107, v98
  v_mul_f32 v98, 0x41000000, v58
  v_mul_f32 v99, 0x41000000, v96
  v_exp_f32 v98, v98
  v_fract_f32 v99, v99
  v_fmac_f32 v99, 0x41000000, v97
  v_cos_f32 v112, v99
  v_sin_f32 v113, v99
  v_pk_mul_f32 v[108:109], v[106:107], v[106:107] op_sel:[0,0] op_sel_hi:[1,0]
  v_pk_fma_f32 v[108:109], v[106:107], v[106:107], v[108:109] op_sel:[1,1,0] op_sel_hi:[0,1,1] neg_lo:[1,0,0]
  v_mul_f32 v112, v112, v98
  v_mul_f32 v113, -v113, v98
  v_pk_mul_f32 v[110:111], v[108:109], v[108:109] op_sel:[0,0] op_sel_hi:[1,0]
  v_pk_fma_f32 v[110:111], v[108:109], v[108:109], v[110:111] op_sel:[1,1,0] op_sel_hi:[0,1,1] neg_lo:[1,0,0]
  v_pk_mul_f32 v[114:115], v[112:113], v[112:113] op_sel:[0,0] op_sel_hi:[1,0]
  v_pk_fma_f32 v[114:115], v[112:113], v[112:113], v[114:115] op_sel:[1,1,0] op_sel_hi:[0,1,1] neg_lo:[1,0,0]
  s_mov_b32 m0, s7
  v_cvt_pk_f16_f32 v58, v106, v107
  v_cvt_pk_f16_f32 v59, v108, v109
  v_cvt_pk_f16_f32 v60, v110, v111
  v_add_u32_e64 v30, s69, 3
  v_mov_b32 v69, v30
  v_mov_b32 v71, v30
  v_mov_b32 v73, v30
  v_mov_b32 v75, v30
  v_mov_b32 v77, v30
  v_mov_b32 v79, v30
  v_mov_b32 v81, v30
  v_mov_b32 v83, v30
  s_waitcnt vmcnt(1)
  ds_read_b32 v68, v85 offset:0
  ds_read_b32 v70, v85 offset:128
  ds_read_b32 v72, v86 offset:0
  ds_read_b32 v74, v86 offset:128
  s_waitcnt vmcnt(0)
  ds_read_b32 v76, v85 offset:1024
  ds_read_b32 v78, v85 offset:1152
  ds_read_b32 v80, v86 offset:1024
  ds_read_b32 v82, v86 offset:1152
  s_waitcnt lgkmcnt(6)
  buffer_store_dwordx4 v[68:71], v84, s[16:19], s10 offen sc1
  s_add_u32 s10, s10, 264192
  s_waitcnt lgkmcnt(4)
  buffer_store_dwordx4 v[72:75], v84, s[16:19], s10 offen sc1
  s_waitcnt lgkmcnt(2)
  buffer_store_dwordx4 v[76:79], v84, s[16:19], s11 offen sc1
  s_add_u32 s11, s11, 264192
  s_waitcnt lgkmcnt(0)
  buffer_store_dwordx4 v[80:83], v84, s[16:19], s11 offen sc1
  s_setprio 0
  v_cvt_pk_f16_f32 v64, v100, v101
  v_pk_mul_f32 v[118:119], v[114:115], v[114:115] op_sel:[0,0] op_sel_hi:[1,0]
  v_pk_mul_f32 v[102:103], v[100:101], v[104:105] op_sel:[0,0] op_sel_hi:[1,0]
  v_pk_fma_f32 v[118:119], v[114:115], v[114:115], v[118:119] op_sel:[1,1,0] op_sel_hi:[0,1,1] neg_lo:[1,0,0]
  v_pk_fma_f32 v[102:103], v[100:101], v[104:105], v[102:103] op_sel:[1,1,0] op_sel_hi:[0,1,1] neg_lo:[1,0,0]
  v_pk_mul_f16 v72, v64, v58 op_sel:[0,0] op_sel_hi:[1,0]
  ds_write_addtid_b32 v64 offset:0
  v_pk_fma_f16 v72, v64, v58, v72 op_sel:[1,1,0] op_sel_hi:[0,1,1] neg_lo:[1,0,0]
  v_cvt_pk_f16_f32 v65, v102, v103
  ds_write_addtid_b32 v72 offset:2176
  v_pk_mul_f32 v[100:101], v[102:103], v[104:105] op_sel:[0,0] op_sel_hi:[1,0]
  v_pk_mul_f16 v76, v64, v59 op_sel:[0,0] op_sel_hi:[1,0]
  v_pk_fma_f32 v[100:101], v[102:103], v[104:105], v[100:101] op_sel:[1,1,0] op_sel_hi:[0,1,1] neg_lo:[1,0,0]
  v_pk_fma_f16 v76, v64, v59, v76 op_sel:[1,1,0] op_sel_hi:[0,1,1] neg_lo:[1,0,0]
  ds_write_addtid_b32 v65 offset:272
  ds_write_addtid_b32 v76 offset:3264
  v_cvt_pk_f16_f32 v66, v100, v101
  v_pk_mul_f16 v80, v64, v60 op_sel:[0,0] op_sel_hi:[1,0]
  v_pk_mul_f32 v[102:103], v[100:101], v[104:105] op_sel:[0,0] op_sel_hi:[1,0]
  v_pk_fma_f16 v80, v64, v60, v80 op_sel:[1,1,0] op_sel_hi:[0,1,1] neg_lo:[1,0,0]
  v_pk_fma_f32 v[102:103], v[100:101], v[104:105], v[102:103] op_sel:[1,1,0] op_sel_hi:[0,1,1] neg_lo:[1,0,0]
  ds_write_addtid_b32 v80 offset:4352
  ds_write_addtid_b32 v66 offset:544
  v_pk_mul_f16 v78, v72, v59 op_sel:[0,0] op_sel_hi:[1,0]
  v_cvt_pk_f16_f32 v67, v102, v103
  v_pk_fma_f16 v78, v72, v59, v78 op_sel:[1,1,0] op_sel_hi:[0,1,1] neg_lo:[1,0,0]
  v_pk_mul_f32 v[100:101], v[102:103], v[104:105] op_sel:[0,0] op_sel_hi:[1,0]
  ds_write_addtid_b32 v78 offset:3808
  v_pk_fma_f32 v[100:101], v[102:103], v[104:105], v[100:101] op_sel:[1,1,0] op_sel_hi:[0,1,1] neg_lo:[1,0,0]
  v_pk_mul_f16 v73, v66, v58 op_sel:[0,0] op_sel_hi:[1,0]
  ds_write_addtid_b32 v67 offset:816
  v_pk_fma_f16 v73, v66, v58, v73 op_sel:[1,1,0] op_sel_hi:[0,1,1] neg_lo:[1,0,0]
  v_cvt_pk_f16_f32 v68, v100, v101
  ds_write_addtid_b32 v73 offset:2448
  v_pk_mul_f32 v[102:103], v[100:101], v[104:105] op_sel:[0,0] op_sel_hi:[1,0]
  v_pk_mul_f16 v81, v72, v60 op_sel:[0,0] op_sel_hi:[1,0]
  v_pk_fma_f32 v[102:103], v[100:101], v[104:105], v[102:103] op_sel:[1,1,0] op_sel_hi:[0,1,1] neg_lo:[1,0,0]
  v_pk_fma_f16 v81, v72, v60, v81 op_sel:[1,1,0] op_sel_hi:[0,1,1] neg_lo:[1,0,0]
  ds_write_addtid_b32 v68 offset:1088
  ds_write_addtid_b32 v81 offset:4624
  v_cvt_pk_f16_f32 v69, v102, v103
  v_pk_mul_f16 v82, v76, v60 op_sel:[0,0] op_sel_hi:[1,0]
  v_pk_mul_f32 v[100:101], v[102:103], v[104:105] op_sel:[0,0] op_sel_hi:[1,0]
  v_pk_fma_f16 v82, v76, v60, v82 op_sel:[1,1,0] op_sel_hi:[0,1,1] neg_lo:[1,0,0]
  v_pk_fma_f32 v[100:101], v[102:103], v[104:105], v[100:101] op_sel:[1,1,0] op_sel_hi:[0,1,1] neg_lo:[1,0,0]
  ds_write_addtid_b32 v82 offset:4896
  ds_write_addtid_b32 v69 offset:1360
  v_pk_mul_f16 v74, v68, v58 op_sel:[0,0] op_sel_hi:[1,0]
  v_cvt_pk_f16_f32 v70, v100, v101
  v_pk_fma_f16 v74, v68, v58, v74 op_sel:[1,1,0] op_sel_hi:[0,1,1] neg_lo:[1,0,0]
  v_pk_mul_f32 v[102:103], v[100:101], v[104:105] op_sel:[0,0] op_sel_hi:[1,0]
  ds_write_addtid_b32 v74 offset:2720
  v_pk_fma_f32 v[102:103], v[100:101], v[104:105], v[102:103] op_sel:[1,1,0] op_sel_hi:[0,1,1] neg_lo:[1,0,0]
  v_pk_mul_f16 v84, v80, v60 op_sel:[0,0] op_sel_hi:[1,0]
  ds_write_addtid_b32 v70 offset:1632
  v_pk_fma_f16 v84, v80, v60, v84 op_sel:[1,1,0] op_sel_hi:[0,1,1] neg_lo:[1,0,0]
  v_cvt_pk_f16_f32 v71, v102, v103
  ds_write_addtid_b32 v84 offset:5440
  ds_write_addtid_b32 v71 offset:1904
  v_pk_mul_f16 v77, v68, v59 op_sel:[0,0] op_sel_hi:[1,0]
  v_pk_mul_f16 v83, v78, v60 op_sel:[0,0] op_sel_hi:[1,0]
  v_pk_mul_f32 v[116:117], v[114:115], v[112:113] op_sel:[0,0] op_sel_hi:[1,0]
  v_pk_fma_f16 v77, v68, v59, v77 op_sel:[1,1,0] op_sel_hi:[0,1,1] neg_lo:[1,0,0]
  v_pk_fma_f16 v83, v78, v60, v83 op_sel:[1,1,0] op_sel_hi:[0,1,1] neg_lo:[1,0,0]
  v_pk_fma_f32 v[116:117], v[114:115], v[112:113], v[116:117] op_sel:[1,1,0] op_sel_hi:[0,1,1] neg_lo:[1,0,0]
  ds_write_addtid_b32 v77 offset:3536
  ds_write_addtid_b32 v83 offset:5168
  v_mov_b32 v61, 0x3c00
  v_pk_mul_f16 v79, v74, v59 op_sel:[0,0] op_sel_hi:[1,0]
  v_pk_mul_f16 v75, v70, v58 op_sel:[0,0] op_sel_hi:[1,0]
  v_pk_fma_f16 v79, v74, v59, v79 op_sel:[1,1,0] op_sel_hi:[0,1,1] neg_lo:[1,0,0]
  v_pk_fma_f16 v75, v70, v58, v75 op_sel:[1,1,0] op_sel_hi:[0,1,1] neg_lo:[1,0,0]
  ds_write_addtid_b32 v79 offset:4080
  ds_write_addtid_b32 v75 offset:2992
  ds_read_b128 a[64:67], v44 offset:0
  v_cvt_pk_f16_f32 v58, v112, v113
  ds_read_b128 a[68:71], v44 offset:32
  v_cvt_pk_f16_f32 v59, v114, v115
  ds_read_b128 a[72:75], v44 offset:64
  v_cvt_pk_f16_f32 v60, v116, v117
  ds_read_b128 a[76:79], v44 offset:96
  v_cvt_pk_f16_f32 v65, v118, v119
  ds_read_b128 a[80:83], v44 offset:128
  v_pk_mul_f32 v[100:101], v[118:119], v[118:119] op_sel:[0,0] op_sel_hi:[1,0]
  ds_read_b128 a[84:87], v44 offset:160
  v_pk_fma_f32 v[100:101], v[118:119], v[118:119], v[100:101] op_sel:[1,1,0] op_sel_hi:[0,1,1] neg_lo:[1,0,0]
  ds_read_b128 a[88:91], v44 offset:192
  ds_read_b128 a[92:95], v44 offset:224
  ds_write_addtid_b32 v61 offset:0
  ds_write_addtid_b32 v58 offset:272
  ds_write_addtid_b32 v59 offset:544
  ds_write_addtid_b32 v60 offset:816
  ds_write_addtid_b32 v65 offset:1088
  v_pk_mul_f16 v72, v65, v58 op_sel:[0,0] op_sel_hi:[1,0]
  v_pk_mul_f16 v73, v65, v59 op_sel:[0,0] op_sel_hi:[1,0]
  v_pk_mul_f16 v74, v65, v60 op_sel:[0,0] op_sel_hi:[1,0]
  v_cvt_pk_f16_f32 v66, v100, v101
  v_pk_fma_f16 v72, v65, v58, v72 op_sel:[1,1,0] op_sel_hi:[0,1,1] neg_lo:[1,0,0]
  v_pk_fma_f16 v73, v65, v59, v73 op_sel:[1,1,0] op_sel_hi:[0,1,1] neg_lo:[1,0,0]
  v_pk_fma_f16 v74, v65, v60, v74 op_sel:[1,1,0] op_sel_hi:[0,1,1] neg_lo:[1,0,0]
  buffer_store_dwordx4 v[24:27], v20, s[16:19], s35 offen sc1
  v_pk_mul_f32 v[102:103], v[100:101], v[118:119] op_sel:[0,0] op_sel_hi:[1,0]
  ds_write_addtid_b32 v72 offset:1360
  ds_write_addtid_b32 v73 offset:1632
  ds_write_addtid_b32 v74 offset:1904
  v_pk_fma_f32 v[102:103], v[100:101], v[118:119], v[102:103] op_sel:[1,1,0] op_sel_hi:[0,1,1] neg_lo:[1,0,0]
  ds_write_addtid_b32 v66 offset:2176
  v_pk_mul_f16 v75, v66, v58 op_sel:[0,0] op_sel_hi:[1,0]
  v_pk_mul_f16 v76, v66, v59 op_sel:[0,0] op_sel_hi:[1,0]
  v_pk_mul_f16 v77, v66, v60 op_sel:[0,0] op_sel_hi:[1,0]
  v_cvt_pk_f16_f32 v67, v102, v103
  v_pk_fma_f16 v75, v66, v58, v75 op_sel:[1,1,0] op_sel_hi:[0,1,1] neg_lo:[1,0,0]
  v_pk_fma_f16 v76, v66, v59, v76 op_sel:[1,1,0] op_sel_hi:[0,1,1] neg_lo:[1,0,0]
  v_pk_fma_f16 v77, v66, v60, v77 op_sel:[1,1,0] op_sel_hi:[0,1,1] neg_lo:[1,0,0]
  v_pk_mul_f32 v[100:101], v[102:103], v[118:119] op_sel:[0,0] op_sel_hi:[1,0]
  ds_write_addtid_b32 v75 offset:2448
  ds_write_addtid_b32 v76 offset:2720
  ds_write_addtid_b32 v77 offset:2992
  v_pk_fma_f32 v[100:101], v[102:103], v[118:119], v[100:101] op_sel:[1,1,0] op_sel_hi:[0,1,1] neg_lo:[1,0,0]
  ds_write_addtid_b32 v67 offset:3264
  s_load_dwordx4 s[8:11], s[64:65], 128
  s_load_dwordx4 s[24:27], s[64:65], 144
  v_pk_mul_f16 v72, v67, v58 op_sel:[0,0] op_sel_hi:[1,0]
  v_pk_mul_f16 v73, v67, v59 op_sel:[0,0] op_sel_hi:[1,0]
  v_pk_mul_f16 v74, v67, v60 op_sel:[0,0] op_sel_hi:[1,0]
  v_cvt_pk_f16_f32 v68, v100, v101
  v_pk_fma_f16 v72, v67, v58, v72 op_sel:[1,1,0] op_sel_hi:[0,1,1] neg_lo:[1,0,0]
  v_pk_fma_f16 v73, v67, v59, v73 op_sel:[1,1,0] op_sel_hi:[0,1,1] neg_lo:[1,0,0]
  v_pk_fma_f16 v74, v67, v60, v74 op_sel:[1,1,0] op_sel_hi:[0,1,1] neg_lo:[1,0,0]
  v_pk_mul_f32 v[102:103], v[100:101], v[118:119] op_sel:[0,0] op_sel_hi:[1,0]
  ds_write_addtid_b32 v72 offset:3536
  ds_write_addtid_b32 v73 offset:3808
  ds_write_addtid_b32 v74 offset:4080
  v_pk_fma_f32 v[102:103], v[100:101], v[118:119], v[102:103] op_sel:[1,1,0] op_sel_hi:[0,1,1] neg_lo:[1,0,0]
  ds_write_addtid_b32 v68 offset:4352
  v_pk_mul_f16 v75, v68, v58 op_sel:[0,0] op_sel_hi:[1,0]
  v_pk_mul_f16 v76, v68, v59 op_sel:[0,0] op_sel_hi:[1,0]
  v_pk_mul_f16 v77, v68, v60 op_sel:[0,0] op_sel_hi:[1,0]
  v_cvt_pk_f16_f32 v69, v102, v103
  v_pk_fma_f16 v75, v68, v58, v75 op_sel:[1,1,0] op_sel_hi:[0,1,1] neg_lo:[1,0,0]
  v_pk_fma_f16 v76, v68, v59, v76 op_sel:[1,1,0] op_sel_hi:[0,1,1] neg_lo:[1,0,0]
  v_pk_fma_f16 v77, v68, v60, v77 op_sel:[1,1,0] op_sel_hi:[0,1,1] neg_lo:[1,0,0]
  v_pk_mul_f32 v[100:101], v[102:103], v[118:119] op_sel:[0,0] op_sel_hi:[1,0]
  ds_write_addtid_b32 v75 offset:4624
  ds_write_addtid_b32 v76 offset:4896
  ds_write_addtid_b32 v77 offset:5168
  v_pk_fma_f32 v[100:101], v[102:103], v[118:119], v[100:101] op_sel:[1,1,0] op_sel_hi:[0,1,1] neg_lo:[1,0,0]
  ds_write_addtid_b32 v69 offset:5440
  v_pk_mul_f16 v72, v69, v58 op_sel:[0,0] op_sel_hi:[1,0]
  v_pk_mul_f16 v73, v69, v59 op_sel:[0,0] op_sel_hi:[1,0]
  v_pk_mul_f16 v74, v69, v60 op_sel:[0,0] op_sel_hi:[1,0]
  v_cvt_pk_f16_f32 v70, v100, v101
  v_pk_fma_f16 v72, v69, v58, v72 op_sel:[1,1,0] op_sel_hi:[0,1,1] neg_lo:[1,0,0]
  v_pk_fma_f16 v73, v69, v59, v73 op_sel:[1,1,0] op_sel_hi:[0,1,1] neg_lo:[1,0,0]
  v_pk_fma_f16 v74, v69, v60, v74 op_sel:[1,1,0] op_sel_hi:[0,1,1] neg_lo:[1,0,0]
  v_pk_mul_f32 v[102:103], v[100:101], v[118:119] op_sel:[0,0] op_sel_hi:[1,0]
  ds_write_addtid_b32 v72 offset:5712
  ds_write_addtid_b32 v73 offset:5984
  ds_write_addtid_b32 v74 offset:6256
  v_pk_fma_f32 v[102:103], v[100:101], v[118:119], v[102:103] op_sel:[1,1,0] op_sel_hi:[0,1,1] neg_lo:[1,0,0]
  ds_write_addtid_b32 v70 offset:6528
  v_pk_mul_f16 v75, v70, v58 op_sel:[0,0] op_sel_hi:[1,0]
  v_pk_mul_f16 v76, v70, v59 op_sel:[0,0] op_sel_hi:[1,0]
  v_pk_mul_f16 v77, v70, v60 op_sel:[0,0] op_sel_hi:[1,0]
  v_cvt_pk_f16_f32 v71, v102, v103
  v_pk_fma_f16 v75, v70, v58, v75 op_sel:[1,1,0] op_sel_hi:[0,1,1] neg_lo:[1,0,0]
  v_pk_fma_f16 v76, v70, v59, v76 op_sel:[1,1,0] op_sel_hi:[0,1,1] neg_lo:[1,0,0]
  v_pk_fma_f16 v77, v70, v60, v77 op_sel:[1,1,0] op_sel_hi:[0,1,1] neg_lo:[1,0,0]
  ds_write_addtid_b32 v71 offset:7616
  ds_write_addtid_b32 v75 offset:6800
  ds_write_addtid_b32 v76 offset:7072
  ds_write_addtid_b32 v77 offset:7344
  v_pk_mul_f16 v72, v71, v58 op_sel:[0,0] op_sel_hi:[1,0]
  v_pk_mul_f16 v73, v71, v59 op_sel:[0,0] op_sel_hi:[1,0]
  v_pk_mul_f16 v74, v71, v60 op_sel:[0,0] op_sel_hi:[1,0]
  v_pk_fma_f16 v72, v71, v58, v72 op_sel:[1,1,0] op_sel_hi:[0,1,1] neg_lo:[1,0,0]
  v_pk_fma_f16 v73, v71, v59, v73 op_sel:[1,1,0] op_sel_hi:[0,1,1] neg_lo:[1,0,0]
  v_pk_fma_f16 v74, v71, v60, v74 op_sel:[1,1,0] op_sel_hi:[0,1,1] neg_lo:[1,0,0]
  ds_write_addtid_b32 v72 offset:7888
  ds_write_addtid_b32 v73 offset:8160
  ds_write_addtid_b32 v74 offset:8432
  ds_read_b128 a[96:99], v44 offset:0
  ds_read_b128 a[100:103], v44 offset:32
  ds_read_b128 a[104:107], v44 offset:64
  ds_read_b128 a[108:111], v44 offset:96
  ds_read_b128 a[112:115], v44 offset:128
  ds_read_b128 a[116:119], v44 offset:160
  ds_read_b128 a[120:123], v44 offset:192
  ds_read_b128 a[124:127], v44 offset:224
  s_waitcnt lgkmcnt(7)
  v_mfma_f32_32x32x16_f16 v[112:127], a[64:67], a[96:99], 0
  s_waitcnt lgkmcnt(6)
  v_mfma_f32_32x32x16_f16 v[112:127], a[68:71], a[100:103], v[112:127]
  s_waitcnt lgkmcnt(5)
  v_mfma_f32_32x32x16_f16 v[112:127], a[72:75], a[104:107], v[112:127]
  s_waitcnt lgkmcnt(4)
  v_mfma_f32_32x32x16_f16 v[112:127], a[76:79], a[108:111], v[112:127]
  s_waitcnt lgkmcnt(3)
  v_mfma_f32_32x32x16_f16 v[112:127], a[80:83], a[112:115], v[112:127]
  s_waitcnt lgkmcnt(2)
  v_mfma_f32_32x32x16_f16 v[112:127], a[84:87], a[116:119], v[112:127]
  s_waitcnt lgkmcnt(1)
  v_mfma_f32_32x32x16_f16 v[112:127], a[88:91], a[120:123], v[112:127]
  s_waitcnt lgkmcnt(0)
  v_mfma_f32_32x32x16_f16 v[112:127], a[92:95], a[124:127], v[112:127]
  s_nop 11
  ds_write2_b32 v45, v112, v113 offset0:0 offset1:1
  ds_write2_b32 v45, v114, v115 offset0:2 offset1:3
  ds_write2_b32 v46, v116, v117 offset0:0 offset1:1
  ds_write2_b32 v47, v118, v119 offset0:0 offset1:1
  ds_write2_b32 v48, v120, v121 offset0:0 offset1:34
  ds_write2_b32 v48, v122, v123 offset0:68 offset1:102
  s_waitcnt lgkmcnt(0)
  s_barrier
  ds_read_b128 v[112:115], v49 offset:0
  ds_read_b128 v[116:119], v49 offset:8704
  ds_read_b128 v[120:123], v49 offset:17408
  ds_read_b128 v[124:127], v49 offset:26112
  s_waitcnt lgkmcnt(2)
  v_add_f32 v112, v112, v116
  v_add_f32 v113, v113, v117
  v_add_f32 v114, v114, v118
  s_memrealtime s[70:71]
  v_add_f32 v115, v115, v119
  s_waitcnt lgkmcnt(0)
  v_add_f32 v120, v120, v124
  v_add_f32 v121, v121, v125
  v_add_f32 v122, v122, v126
  v_add_f32 v123, v123, v127
  v_add_f32 v112, v112, v120
  v_add_f32 v113, v113, v121
  v_add_f32 v114, v114, v122
  v_add_f32 v115, v115, v123
  v_mul_f32 v112, v112, v31
  v_mul_f32 v113, v113, v31
  v_mul_f32 v114, v114, v31
  v_mul_f32 v115, v115, v31
  s_mov_b64 exec, s[56:57]
  ds_write_b128 v49, v[112:115]
  s_mov_b64 exec, -1
  s_waitcnt lgkmcnt(0)
  s_barrier
  ds_read_b32 v112, v32
  ds_read_b32 v113, v33
  ds_read_b32 v114, v34
  s_lshl_b32 s42, s68, 1
  s_sub_u32 s42, s42, 1600
  s_waitcnt lgkmcnt(0)
  s_sub_u32 s8, s8, s42
  s_sub_u32 s9, s9, s42
  s_sub_u32 s10, s10, s42
  s_sub_u32 s11, s11, s42
  s_sub_u32 s24, s24, s42
  s_sub_u32 s25, s25, s42
  s_sub_u32 s26, s26, s42
  s_sub_u32 s27, s27, s42
  s_max_u32 s8, s8, s9
  s_max_u32 s10, s10, s11
  s_max_u32 s24, s24, s25
  s_max_u32 s26, s26, s27
  s_max_u32 s8, s8, s10
  s_max_u32 s24, s24, s26
  s_max_u32 s8, s8, s24
  s_cmp_gt_u32 s8, 3200
  s_cbranch_scc1 MH_GS
MH_GT:
  s_add_u32 s8, s8, s42
  s_lshl_b32 s70, s70, 1
  s_sub_u32 s70, s70, s8
  s_cmp_lt_i32 s70, 540
  s_cbranch_scc1 MH_GW
MH_GR:
  ds_read_b32 v115, v35
  ds_read_b32 v116, v36
  buffer_load_dwordx4 v[80:83], v6, s[16:19], s34 offen offset:0 sc1
  ds_read_b32 v117, v37
  ds_read_b32 v118, v38
  buffer_load_dwordx4 v[88:91], v6, s[16:19], s47 offen offset:0 sc1
  ds_read_b32 v119, v39
  ds_read_b32 v120, v40
  buffer_load_dwordx4 v[84:87], v6, s[16:19], s34 offen offset:1024 sc1
  ds_read_b32 v121, v41
  ds_read_b32 v122, v42
  buffer_load_dwordx4 v[92:95], v6, s[16:19], s47 offen offset:1024 sc1
  s_waitcnt lgkmcnt(0)
  v_cndmask_b32_e64 v120, 0, v120, s[54:55]
  s_mov_b64 exec, 15
  buffer_load_dwordx4 v[96:99], v7, s[16:19], s39 offen sc1
  s_mov_b64 exec, -1
  v_cndmask_b32_e64 v121, 0, v121, s[54:55]
  v_cndmask_b32_e64 v122, 0, v122, s[54:55]
  v_cvt_pk_bf16_f32 v32, v112, v113
  v_cvt_pk_bf16_f32 v33, v114, v115
  v_cvt_pk_bf16_f32 v34, v116, v117
  v_cvt_pk_bf16_f32 v35, v118, v119
  ds_write_b128 v49, v[32:35] offset:3328
  v_cvt_pk_bf16_f32 v36, v113, v114
  v_cvt_pk_bf16_f32 v37, v115, v116
  v_cvt_pk_bf16_f32 v38, v117, v118
  v_cvt_pk_bf16_f32 v39, v119, v120
  ds_write_b128 v49, v[36:39] offset:12096
  v_cvt_pk_bf16_f32 v40, v114, v115
  v_cvt_pk_bf16_f32 v41, v116, v117
  v_cvt_pk_bf16_f32 v42, v118, v119
  v_cvt_pk_bf16_f32 v43, v120, v121
  ds_write_b128 v49, v[40:43] offset:20864
  v_cvt_pk_bf16_f32 v44, v115, v116
  v_cvt_pk_bf16_f32 v45, v117, v118
  v_cvt_pk_bf16_f32 v46, v119, v120
  v_cvt_pk_bf16_f32 v47, v121, v122
  ds_write_b128 v49, v[44:47] offset:29632
  s_waitcnt vmcnt(5)
  s_waitcnt lgkmcnt(0)
  s_barrier
  ds_read_b64 a[4:5], v8 offset:3840
  ds_read_b64 a[6:7], v8 offset:3848
  ds_read_b64 a[12:13], v8 offset:3584
  ds_read_b64 a[14:15], v8 offset:3592
  ds_read_b64 a[20:21], v8 offset:3328
  ds_read_b64 a[22:23], v8 offset:3336
  ds_read_b64 a[28:29], v8 offset:3072
  ds_read_b64 a[30:31], v8 offset:3080
  ds_read_b64 a[36:37], v8 offset:2816
  ds_read_b64 a[38:39], v8 offset:2824
  ds_read_b64 a[44:45], v8 offset:2560
  ds_read_b64 a[46:47], v8 offset:2568
  ds_read_b64 a[52:53], v8 offset:2304
  ds_read_b64 a[54:55], v8 offset:2312
  ds_read_b64 a[60:61], v8 offset:2048
  ds_read_b64 a[62:63], v8 offset:2056
  ds_read_b64 a[68:69], v8 offset:1792
  ds_read_b64 a[70:71], v8 offset:1800
  ds_read_b64 a[76:77], v8 offset:1536
  ds_read_b64 a[78:79], v8 offset:1544
  ds_read_b64 a[84:85], v8 offset:1280
  ds_read_b64 a[86:87], v8 offset:1288
  ds_read_b64 a[92:93], v8 offset:1024
  ds_read_b64 a[94:95], v8 offset:1032
  ds_read_b64 a[100:101], v8 offset:768
  ds_read_b64 a[102:103], v8 offset:776
  ds_read_b64 a[108:109], v8 offset:512
  ds_read_b64 a[110:111], v8 offset:520
  ds_read_b64 a[116:117], v8 offset:256
  ds_read_b64 a[118:119], v8 offset:264
  ds_read_b64 a[124:125], v8 offset:0
  ds_read_b64 a[126:127], v8 offset:8
  s_lshr_b32 s27, s4, 1
  v_lshrrev_b32 v21, 3, v2
  v_and_b32 v22, 7, v2
  v_and_b32 v23, 2, v21
  v_xor_b32 v22, v22, v23
  s_lshr_b32 s25, s32, 1
  s_lshl_b32 s25, s25, 2
  v_xor_b32 v22, s25, v22
  v_mul_u32_u24 v15, 3584, v21
  v_lshl_add_u32 v15, v22, 4, v15
  s_lshl_b32 s37, s6, 7
  s_lshl_b32 s61, s51, 1
  s_mul_i32 s25, s28, 28672
  s_add_u32 s37, s37, s25
  s_lshl_b32 s38, s32, 10
  s_add_u32 s40, s37, 57344
  s_lshl_b32 s41, s4, 10
  s_add_u32 s41, s41, 87040
  s_lshl_b32 s26, s4, 9
  s_add_u32 s26, s26, 69632
  v_lshl_add_u32 v17, v2, 2, s26
  v_mov_b32 v64, 0
  v_mov_b32 v65, 0
  v_mov_b32 v66, 0
  v_mov_b32 v67, 0
  v_and_b32 v21, 31, v2
  v_lshlrev_b32 v22, 4, v21
  v_lshl_add_u32 v10, v3, 3, v22
  v_lshrrev_b32 v23, 2, v21
  v_mul_u32_u24 v14, 28928, v23
  v_and_b32 v23, 3, v21
  v_lshl_add_u32 v14, v23, 4, v14
  v_lshl_add_u32 v14, v3, 30, v14
  v_mul_u32_u24 v21, 4608, v3
  v_add_u32 v21, v21, v22
  v_add_u32 v21, 69632, v21
  ds_write_b128 v21, v[64:67]
  v_add_u32 v21, 162816, v6
  ds_write_b128 v21, v[64:67]
  s_add_u32 s52, s28, 4
  s_add_u32 s53, s28, 6
  s_and_b32 s50, s27, 1
  s_lshl_b32 s25, s50, 9
  s_lshl_b32 s26, s28, 12
  s_add_u32 s26, s26, s25
  s_add_u32 s26, s26, 78848
  v_add_u32 v10, s26, v10
  s_lshl_b32 s25, s50, 10
  s_add_u32 s25, s25, s29
  v_bfe_u32 v22, v2, 3, 1
  v_xor_b32 v22, v22, v2
  v_lshl_add_u32 v12, v22, 4, s25
  s_mul_i32 s25, s50, 5632
  s_add_u32 s25, s25, s29
  s_add_u32 s25, s25, 2048
  v_lshl_add_u32 v13, v22, 4, s25
  s_lshl_b32 s25, s3, 7
  s_lshl_b32 s26, s28, 6
  s_add_u32 s60, s25, s26
  s_mul_i32 s25, s50, 231424
  s_add_u32 s60, s60, s25
  s_add_u32 s60, s60, 147456
  v_min_u32 v28, 55, v2
  v_lshrrev_b32 v22, 3, v28
  v_mul_u32_u24 v22, 24, v22
  v_add_u32 v28, v28, v22
  s_lshl_b32 s25, s32, 9
  s_add_u32 s25, s25, 40960
  v_lshl_add_u32 v28, v28, 6, s25
  s_waitcnt vmcnt(1)
  v_subrev_u32 v64, s69, v81
  v_subrev_u32 v65, s69, v83
  v_subrev_u32 v66, s69, v85
  v_subrev_u32 v67, s69, v87
  v_subrev_u32 v68, s69, v89
  v_subrev_u32 v69, s69, v91
  v_subrev_u32 v70, s69, v93
  v_subrev_u32 v71, s69, v95
  v_max3_u32 v64, v64, v65, v66
  v_max3_u32 v67, v67, v68, v69
  v_max_u32 v70, v70, v71
  v_max3_u32 v64, v64, v67, v70
  v_cmp_lt_u32 vcc, 16, v64
  s_cbranch_vccnz MH_SLOW0
MH_RET0:
  s_mov_b32 s42, 0x05040100
  s_mov_b32 s43, 0x07060302
  s_mov_b64 exec, 15
  s_waitcnt vmcnt(0)
  v_subrev_u32 v97, s69, v97
  v_subrev_u32 v99, s69, v99
  v_max_u32 v97, v97, v99
  v_cmp_lt_u32 vcc, 16, v97
  s_cbranch_vccnz MH_SLOW1
MH_RET1:
  v_add_f32 v96, v96, v98
  v_cvt_pk_bf16_f32 v96, 0, v96
  s_mov_b64 exec, -1
  v_readlane_b32 s44, v96, 0
  v_readlane_b32 s45, v96, 1
  v_readlane_b32 s48, v96, 2
  v_readlane_b32 s49, v96, 3
  v_lshlrev_b32 v72, 16, v88
  v_lshlrev_b32 v73, 16, v90
  v_lshlrev_b32 v74, 16, v92
  v_lshlrev_b32 v75, 16, v94
  v_rcp_f32 v72, v72
  v_and_b32 v88, 0xffff0000, v88
  s_add_u32 m0, s41, 65536
  s_add_u32 s25, s40, 917504
  buffer_load_dwordx4 v15, s[12:15], s25 offen  lds
  v_rcp_f32 v73, v73
  v_and_b32 v90, 0xffff0000, v90
  v_rcp_f32 v74, v74
  v_and_b32 v92, 0xffff0000, v92
  v_rcp_f32 v75, v75
  v_and_b32 v94, 0xffff0000, v94
  s_lshl_b32 s25, s61, 13
  s_add_u32 m0, s41, s25
  s_mul_i32 s25, s61, 114688
  s_add_u32 s25, s25, s40
  buffer_load_dwordx4 v15, s[12:15], s25 offen  lds
  s_add_u32 s61, s61, 1
  s_and_b32 s61, s61, 7
  v_lshlrev_b32 v64, 16, v80
  v_and_b32 v65, 0xffff0000, v80
  v_lshlrev_b32 v66, 16, v82
  v_and_b32 v67, 0xffff0000, v82
  v_lshlrev_b32 v68, 16, v84
  v_and_b32 v69, 0xffff0000, v84
  s_lshl_b32 s25, s61, 13
  s_add_u32 m0, s41, s25
  s_mul_i32 s25, s61, 114688
  s_add_u32 s25, s25, s40
  buffer_load_dwordx4 v15, s[12:15], s25 offen  lds
  s_add_u32 s61, s61, 1
  s_and_b32 s61, s61, 7
  v_lshlrev_b32 v70, 16, v86
  v_and_b32 v71, 0xffff0000, v86
  v_sub_f32 v64, v64, v88
  v_sub_f32 v65, v65, v88
  v_sub_f32 v66, v66, v90
  v_sub_f32 v67, v67, v90
  s_lshl_b32 s25, s61, 13
  s_add_u32 m0, s41, s25
  s_mul_i32 s25, s61, 114688
  s_add_u32 s25, s25, s40
  buffer_load_dwordx4 v15, s[12:15], s25 offen  lds
  s_add_u32 s61, s61, 1
  s_and_b32 s61, s61, 7
  v_sub_f32 v68, v68, v92
  v_sub_f32 v69, v69, v92
  v_sub_f32 v70, v70, v94
  v_sub_f32 v71, v71, v94
  v_mul_f32 v100, s48, v72
  v_mul_f32 v101, s49, v72
  s_lshl_b32 s25, s61, 13
  s_add_u32 m0, s41, s25
  s_mul_i32 s25, s61, 114688
  s_add_u32 s25, s25, s40
  buffer_load_dwordx4 v15, s[12:15], s25 offen  lds
  s_add_u32 s61, s61, 1
  s_and_b32 s61, s61, 7
  v_mul_f32 v102, s48, v73
  v_mul_f32 v103, s49, v73
  v_mul_f32 v104, s48, v74
  v_mul_f32 v105, s49, v74
  v_mul_f32 v106, s48, v75
  v_mul_f32 v107, s49, v75
  s_mov_b64 exec, 0xf0
  buffer_load_dwordx4 v[108:111], v7, s[16:19], s39 offen sc1
  s_mov_b64 exec, -1
  v_fma_f32 v64, v64, v100, s44
  v_fma_f32 v65, v65, v101, s45
  v_fma_f32 v66, v66, v102, s44
  v_fma_f32 v67, v67, v103, s45
  v_fma_f32 v68, v68, v104, s44
  v_fma_f32 v69, v69, v105, s45
  v_fma_f32 v70, v70, v106, s44
  v_fma_f32 v71, v71, v107, s45
  v_cvt_pk_bf16_f32 v50, v64, v66
  v_cvt_pk_bf16_f32 v51, v68, v70
  ds_write2st64_b32 v17, v50, v51 offset0:2 offset1:3
  v_cvt_pk_bf16_f32 v52, v65, v67
  v_cvt_pk_bf16_f32 v53, v69, v71
  ds_write2st64_b32 v17, v52, v53 offset0:20 offset1:21
  v_perm_b32 v54, v82, v80, s42
  v_perm_b32 v55, v86, v84, s42
  ds_write2st64_b32 v17, v54, v55 offset0:36 offset1:37
  v_perm_b32 v56, v82, v80, s43
  v_perm_b32 v57, v86, v84, s43
  ds_write2st64_b32 v17, v56, v57 offset0:52 offset1:53
  s_setprio 1
  s_waitcnt lgkmcnt(0)
  s_barrier
  ds_read_b128 a[0:3], v9 offset:256
  ds_read_b128 a[8:11], v9 offset:0
  ds_read_b128 a[16:19], v9 offset:768
  ds_read_b128 a[24:27], v9 offset:512
  s_waitcnt lgkmcnt(3)
  v_mfma_f32_16x16x32_bf16 v[112:115], a[4:7], a[0:3], 0
  ds_read_b64 v[74:75], v10 offset:0
  s_waitcnt lgkmcnt(0)
  v_lshlrev_b32 v68, 16, v74
  v_mfma_f32_16x16x32_bf16 v[116:119], a[20:23], a[0:3], 0
  v_and_b32 v69, 0xffff0000, v74
  v_lshlrev_b32 v70, 16, v75
  v_and_b32 v71, 0xffff0000, v75
  s_mov_b64 exec, 0xf0
  s_waitcnt vmcnt(0)
  v_subrev_u32 v109, s69, v109
  v_subrev_u32 v111, s69, v111
  v_max_u32 v109, v109, v111
  v_cmp_lt_u32 vcc, 16, v109
  s_cbranch_vccnz MH_SLOW2
MH_RET2:
  v_add_f32 v108, v108, v110
  v_cvt_pk_bf16_f32 v108, 0, v108
  v_add_f32 v108, 0x2b800000, v108
  s_mov_b64 exec, -1
  v_readlane_b32 s52, v108, s52
  v_readlane_b32 s53, v108, s53
  s_nop 1
  v_mov_b32 v19, s53
  v_mul_f32 v18, s52, v19
  v_mul_f32 v68, v68, v19
  v_mfma_f32_16x16x32_bf16 v[112:115], a[12:15], a[8:11], v[112:115]
  v_mul_f32 v69, v69, v19
  v_mul_f32 v70, v70, v19
  v_mul_f32 v71, v71, v19
  v_mfma_f32_16x16x32_bf16 v[116:119], a[28:31], a[8:11], v[116:119]
  v_mfma_f32_16x16x32_bf16 v[116:119], a[4:7], a[16:19], v[116:119]
  v_mfma_f32_16x16x32_bf16 v[116:119], a[12:15], a[24:27], v[116:119]
  v_mfma_f32_16x16x32_bf16 v[120:123], a[36:39], a[0:3], 0
  ds_read_b128 a[32:35], v9 offset:1280
  ds_read_b128 a[40:43], v9 offset:1024
  ds_read_b128 a[48:51], v9 offset:1792
  ds_read_b128 a[56:59], v9 offset:1536
  ds_read_b128 a[64:67], v9 offset:2304
  v_mfma_f32_16x16x32_bf16 v[124:127], a[52:55], a[0:3], 0
  ds_write_b128 v11, v[112:115] offset:0
  ds_write_b128 v11, v[116:119] offset:1024
  ds_read_b128 a[72:75], v9 offset:2048
  ds_read_b128 a[80:83], v9 offset:2816
  ds_read_b128 a[88:91], v9 offset:2560
  v_mfma_f32_16x16x32_bf16 v[120:123], a[44:47], a[8:11], v[120:123]
  s_waitcnt lgkmcnt(3)
  s_barrier
  ds_read_b128 v[88:91], v12 offset:0
  ds_read_b128 v[92:95], v12 offset:8704
  ds_read_b128 v[96:99], v12 offset:17408
  ds_read_b128 v[100:103], v12 offset:26112
  v_mfma_f32_16x16x32_bf16 v[124:127], a[60:63], a[8:11], v[124:127]
  s_lshl_b32 s25, s61, 13
  s_add_u32 m0, s41, s25
  s_mul_i32 s25, s61, 114688
  s_add_u32 s25, s25, s40
  buffer_load_dwordx4 v15, s[12:15], s25 offen  lds
  s_add_u32 s61, s61, 1
  s_and_b32 s61, s61, 7
  s_add_u32 s44, s60, 0
  s_waitcnt lgkmcnt(2)
  v_add_f32 v88, v88, v92
  v_add_f32 v89, v89, v93
  v_add_f32 v90, v90, v94
  v_mfma_f32_16x16x32_bf16 v[120:123], a[20:23], a[16:19], v[120:123]
  s_lshl_b32 s25, s61, 13
  s_add_u32 m0, s41, s25
  s_mul_i32 s25, s61, 114688
  s_add_u32 s25, s25, s40
  buffer_load_dwordx4 v15, s[12:15], s25 offen  lds
  s_add_u32 s61, s61, 1
  s_and_b32 s61, s61, 7
  v_add_f32 v91, v91, v95
  s_waitcnt lgkmcnt(0)
  v_add_f32 v96, v96, v100
  v_add_f32 v97, v97, v101
  v_add_f32 v98, v98, v102
  v_mfma_f32_16x16x32_bf16 v[124:127], a[36:39], a[16:19], v[124:127]
  s_lshl_b32 s25, s61, 13
  s_add_u32 m0, s41, s25
  s_mul_i32 s25, s61, 114688
  s_add_u32 s25, s25, s40
  buffer_load_dwordx4 v15, s[12:15], s25 offen  lds
  s_add_u32 s61, s61, 1
  s_and_b32 s61, s61, 7
  v_add_f32 v99, v99, v103
  v_add_f32 v88, v88, v96
  v_add_f32 v89, v89, v97
  v_add_f32 v90, v90, v98
  v_add_f32 v91, v91, v99
  v_mfma_f32_16x16x32_bf16 v[120:123], a[28:31], a[24:27], v[120:123]
  s_lshl_b32 s25, s61, 13
  s_add_u32 m0, s41, s25
  s_mul_i32 s25, s61, 114688
  s_add_u32 s25, s25, s40
  buffer_load_dwordx4 v15, s[12:15], s25 offen  lds
  v_fma_f32 v88, v88, v18, v68
  v_fma_f32 v89, v89, v18, v69
  v_fma_f32 v90, v90, v18, v70
  v_fma_f32 v91, v91, v18, v71
  v_cvt_pk_bf16_f32 v76, v88, v89
  v_mfma_f32_16x16x32_bf16 v[124:127], a[44:47], a[24:27], v[124:127]
  v_cvt_pk_bf16_f32 v77, v90, v91
  v_permlane32_swap_b32 v76, v78
  s_nop 0
  v_permlane32_swap_b32 v77, v79
  buffer_store_dwordx4 v[76:79], v14, s[16:19], s44 offen sc1
  v_mfma_f32_16x16x32_bf16 v[120:123], a[4:7], a[32:35], v[120:123]
  ds_read_b64 v[74:75], v10 offset:1024
  s_waitcnt lgkmcnt(0)
  v_lshlrev_b32 v68, 16, v74
  v_mfma_f32_16x16x32_bf16 v[124:127], a[20:23], a[32:35], v[124:127]
  v_and_b32 v69, 0xffff0000, v74
  v_lshlrev_b32 v70, 16, v75
  v_and_b32 v71, 0xffff0000, v75
  v_mul_f32 v68, v68, v19
  v_mul_f32 v69, v69, v19
  v_mfma_f32_16x16x32_bf16 v[120:123], a[12:15], a[40:43], v[120:123]
  v_mul_f32 v70, v70, v19
  v_mul_f32 v71, v71, v19
  s_lshr_b32 s42, s3, 3
  s_mul_i32 s59, s42, 37
  s_lshr_b32 s59, s59, 8
  v_mfma_f32_16x16x32_bf16 v[124:127], a[28:31], a[40:43], v[124:127]
  s_mul_i32 s58, s59, 7
  s_sub_u32 s58, s42, s58
  s_and_b32 s42, s58, 3
  s_lshl_b32 s42, s42, 3
  s_lshr_b32 s42, 0x2d78b1e4, s42
  v_mfma_f32_16x16x32_bf16 v[124:127], a[4:7], a[48:51], v[124:127]
  s_add_u32 s43, s5, 32
  s_add_u32 s50, s5, 0
  s_add_u32 s51, s5, 8
  s_add_u32 s52, s5, 16
  s_add_u32 s53, s5, 24
  v_mfma_f32_16x16x32_bf16 v[124:127], a[12:15], a[56:59], v[124:127]
  s_bfe_u32 s54, s42, 0x20000
  s_lshl3_add_u32 s54, s54, s43
  s_bfe_u32 s55, s42, 0x20002
  s_lshl3_add_u32 s55, s55, s43
  s_bfe_u32 s56, s42, 0x20004
  v_mfma_f32_16x16x32_bf16 v[112:115], a[68:71], a[0:3], 0
  s_lshl3_add_u32 s56, s56, s43
  s_bfe_u32 s57, s42, 0x20006
  s_lshl3_add_u32 s57, s57, s43
  s_add_u32 s35, s38, 147456
  v_bfe_u32 v16, v2, 3, 2
  v_mfma_f32_16x16x32_bf16 v[116:119], a[84:87], a[0:3], 0
  v_lshl_add_u32 v16, v16, 2, v6
  v_add_u32 v16, s38, v16
  v_add_u32 v17, 0x10000, v16
  v_add_u32 v20, 0x20000, v16
  ds_write_b128 v11, v[120:123] offset:2048
  v_mfma_f32_16x16x32_bf16 v[112:115], a[76:79], a[8:11], v[112:115]
  ds_write_b128 v11, v[124:127] offset:7680
  s_waitcnt vmcnt(1) lgkmcnt(0)
  s_barrier
  ds_read_b128 v[88:91], v13 offset:0
  ds_read_b128 v[92:95], v13 offset:8704
  ds_read_b128 v[96:99], v13 offset:17408
  v_mfma_f32_16x16x32_bf16 v[116:119], a[92:95], a[8:11], v[116:119]
  ds_read_b128 v[100:103], v13 offset:26112
  s_add_u32 s44, s60, 462848
  s_waitcnt lgkmcnt(2)
  v_add_f32 v88, v88, v92
  v_add_f32 v89, v89, v93
  v_mfma_f32_16x16x32_bf16 v[112:115], a[52:55], a[16:19], v[112:115]
  v_add_f32 v90, v90, v94
  v_add_f32 v91, v91, v95
  s_waitcnt lgkmcnt(0)
  v_add_f32 v96, v96, v100
  v_add_f32 v97, v97, v101
  v_mfma_f32_16x16x32_bf16 v[116:119], a[68:71], a[16:19], v[116:119]
  v_add_f32 v98, v98, v102
  v_add_f32 v99, v99, v103
  v_add_f32 v88, v88, v96
  v_add_f32 v89, v89, v97
  v_add_f32 v90, v90, v98
  v_mfma_f32_16x16x32_bf16 v[112:115], a[60:63], a[24:27], v[112:115]
  v_add_f32 v91, v91, v99
  v_fma_f32 v88, v88, v18, v68
  v_fma_f32 v89, v89, v18, v69
  v_fma_f32 v90, v90, v18, v70
  v_fma_f32 v91, v91, v18, v71
  v_mfma_f32_16x16x32_bf16 v[116:119], a[76:79], a[24:27], v[116:119]
  v_cvt_pk_bf16_f32 v80, v88, v89
  v_cvt_pk_bf16_f32 v81, v90, v91
  s_nop 0
  v_permlane32_swap_b32 v80, v82
  v_permlane32_swap_b32 v81, v83
  v_mfma_f32_16x16x32_bf16 v[112:115], a[36:39], a[32:35], v[112:115]
  buffer_store_dwordx4 v[80:83], v14, s[16:19], s44 offen sc1
  buffer_load_dword v29, v28, s[16:19], 0 offen sc1
  ds_read_b64 v[74:75], v10 offset:2048
  v_mfma_f32_16x16x32_bf16 v[116:119], a[52:55], a[32:35], v[116:119]
  s_waitcnt lgkmcnt(0)
  v_lshlrev_b32 v68, 16, v74
  v_and_b32 v69, 0xffff0000, v74
  v_lshlrev_b32 v70, 16, v75
  v_and_b32 v71, 0xffff0000, v75
  v_mfma_f32_16x16x32_bf16 v[112:115], a[44:47], a[40:43], v[112:115]
  v_mul_f32 v68, v68, v19
  v_mul_f32 v69, v69, v19
  v_mul_f32 v70, v70, v19
  v_mul_f32 v71, v71, v19
  ds_read_b128 a[96:99], v9 offset:3328
  v_mfma_f32_16x16x32_bf16 v[116:119], a[60:63], a[40:43], v[116:119]
  ds_read_b128 a[104:107], v9 offset:3072
  ds_read_b128 a[112:115], v9 offset:3840
  ds_read_b128 a[120:123], v9 offset:3584
  v_mfma_f32_16x16x32_bf16 v[112:115], a[20:23], a[48:51], v[112:115]
  v_mfma_f32_16x16x32_bf16 v[116:119], a[36:39], a[48:51], v[116:119]
  v_mfma_f32_16x16x32_bf16 v[112:115], a[28:31], a[56:59], v[112:115]
  v_mfma_f32_16x16x32_bf16 v[116:119], a[44:47], a[56:59], v[116:119]
  v_mfma_f32_16x16x32_bf16 v[112:115], a[4:7], a[64:67], v[112:115]
  s_mul_i32 s46, s32, 1792
  s_add_u32 s46, s46, 111616
  s_add_u32 s47, s46, 7168
  v_lshlrev_b32 v36, 5, v2
  buffer_load_dwordx4 v[40:43], v36, s[16:19], s46 offen offset:0 sc1
  v_mfma_f32_16x16x32_bf16 v[116:119], a[20:23], a[64:67], v[116:119]
  buffer_load_dwordx4 v[44:47], v36, s[16:19], s46 offen offset:16 sc1
  buffer_load_dwordx4 v[48:51], v36, s[16:19], s47 offen offset:0 sc1
  buffer_load_dwordx4 v[52:55], v36, s[16:19], s47 offen offset:16 sc1
  s_mul_i32 s42, s32, 224
  s_add_u32 s42, s42, 160768
  v_mfma_f32_16x16x32_bf16 v[112:115], a[12:15], a[72:75], v[112:115]
  v_lshl_add_u32 v37, v2, 2, s42
  v_mfma_f32_16x16x32_bf16 v[116:119], a[28:31], a[72:75], v[116:119]
  v_mfma_f32_16x16x32_bf16 v[116:119], a[4:7], a[80:83], v[116:119]
  v_mfma_f32_16x16x32_bf16 v[116:119], a[12:15], a[88:91], v[116:119]
  v_mfma_f32_16x16x32_bf16 v[120:123], a[100:103], a[0:3], 0
  v_mfma_f32_16x16x32_bf16 v[124:127], a[116:119], a[0:3], 0
  s_nop 1
  ds_write_b128 v11, v[112:115] offset:0
  s_nop 2
  ds_write_b128 v11, v[116:119] offset:1024
  v_mfma_f32_16x16x32_bf16 v[120:123], a[108:111], a[8:11], v[120:123]
  s_waitcnt lgkmcnt(0)
  s_barrier
  ds_read_b128 v[88:91], v12 offset:0
  ds_read_b128 v[92:95], v12 offset:8704
  ds_read_b128 v[96:99], v12 offset:17408
  ds_read_b128 v[100:103], v12 offset:26112
  v_mfma_f32_16x16x32_bf16 v[124:127], a[124:127], a[8:11], v[124:127]
  s_add_u32 s44, s60, 925696
  s_waitcnt lgkmcnt(2)
  v_add_f32 v88, v88, v92
  v_add_f32 v89, v89, v93
  v_add_f32 v90, v90, v94
  v_mfma_f32_16x16x32_bf16 v[120:123], a[84:87], a[16:19], v[120:123]
  s_waitcnt vmcnt(4)
  v_subrev_u32 v29, s69, v29
  v_cmp_lt_u32 vcc, 16, v29
  s_cbranch_vccnz MH_SLOW3
MH_RET3:
  s_mul_i32 s26, s50, 28928
  s_add_u32 s26, s26, s35
  s_add_u32 m0, s38, 87040
  s_add_u32 s25, s26, 0
  buffer_load_dwordx4 v6, s[16:19], s25 offen sc1 lds
  v_add_f32 v91, v91, v95
  s_waitcnt lgkmcnt(0)
  v_add_f32 v96, v96, v100
  v_add_f32 v97, v97, v101
  v_add_f32 v98, v98, v102
  v_mfma_f32_16x16x32_bf16 v[124:127], a[100:103], a[16:19], v[124:127]
  s_add_u32 m0, s38, 91136
  s_add_u32 s25, s26, 4096
  buffer_load_dwordx4 v6, s[16:19], s25 offen sc1 lds
  v_add_f32 v99, v99, v103
  v_add_f32 v88, v88, v96
  v_add_f32 v89, v89, v97
  v_add_f32 v90, v90, v98
  v_add_f32 v91, v91, v99
  v_mfma_f32_16x16x32_bf16 v[120:123], a[92:95], a[24:27], v[120:123]
  s_add_u32 m0, s38, 95232
  s_add_u32 s25, s26, 8192
  buffer_load_dwordx4 v6, s[16:19], s25 offen sc1 lds
  v_fma_f32 v88, v88, v18, v68
  v_fma_f32 v89, v89, v18, v69
  v_fma_f32 v90, v90, v18, v70
  v_fma_f32 v91, v91, v18, v71
  v_cvt_pk_bf16_f32 v76, v88, v89
  v_mfma_f32_16x16x32_bf16 v[124:127], a[108:111], a[24:27], v[124:127]
  s_add_u32 m0, s38, 99328
  s_add_u32 s25, s26, 12288
  buffer_load_dwordx4 v6, s[16:19], s25 offen sc1 lds
  v_cvt_pk_bf16_f32 v77, v90, v91
  v_permlane32_swap_b32 v76, v78
  s_nop 0
  v_permlane32_swap_b32 v77, v79
  buffer_store_dwordx4 v[76:79], v14, s[16:19], s44 offen sc1
  v_mfma_f32_16x16x32_bf16 v[120:123], a[68:71], a[32:35], v[120:123]
  s_add_u32 m0, s38, 103424
  s_add_u32 s25, s26, 16384
  buffer_load_dwordx4 v6, s[16:19], s25 offen sc1 lds
  ds_read_b64 v[74:75], v10 offset:3072
  s_waitcnt lgkmcnt(0)
  v_lshlrev_b32 v68, 16, v74
  v_mfma_f32_16x16x32_bf16 v[124:127], a[84:87], a[32:35], v[124:127]
  s_add_u32 m0, s38, 107520
  s_add_u32 s25, s26, 20480
  buffer_load_dwordx4 v6, s[16:19], s25 offen sc1 lds
  v_and_b32 v69, 0xffff0000, v74
  v_lshlrev_b32 v70, 16, v75
  v_and_b32 v71, 0xffff0000, v75
  v_mul_f32 v68, v68, v19
  v_mul_f32 v69, v69, v19
  v_mfma_f32_16x16x32_bf16 v[120:123], a[76:79], a[40:43], v[120:123]
  s_add_u32 m0, s38, 111616
  s_add_u32 s25, s26, 24576
  buffer_load_dwordx4 v6, s[16:19], s25 offen sc1 lds
  v_mul_f32 v70, v70, v19
  v_mul_f32 v71, v71, v19
  v_mfma_f32_16x16x32_bf16 v[124:127], a[92:95], a[40:43], v[124:127]
  v_mfma_f32_16x16x32_bf16 v[120:123], a[52:55], a[48:51], v[120:123]
  v_mfma_f32_16x16x32_bf16 v[124:127], a[68:71], a[48:51], v[124:127]
  v_mfma_f32_16x16x32_bf16 v[120:123], a[60:63], a[56:59], v[120:123]
  v_mfma_f32_16x16x32_bf16 v[124:127], a[76:79], a[56:59], v[124:127]
  v_mfma_f32_16x16x32_bf16 v[120:123], a[36:39], a[64:67], v[120:123]
  v_mfma_f32_16x16x32_bf16 v[124:127], a[52:55], a[64:67], v[124:127]
  v_mfma_f32_16x16x32_bf16 v[120:123], a[44:47], a[72:75], v[120:123]
  v_mfma_f32_16x16x32_bf16 v[124:127], a[60:63], a[72:75], v[124:127]
  v_mfma_f32_16x16x32_bf16 v[120:123], a[20:23], a[80:83], v[120:123]
  v_mfma_f32_16x16x32_bf16 v[124:127], a[36:39], a[80:83], v[124:127]
  v_mfma_f32_16x16x32_bf16 v[120:123], a[28:31], a[88:91], v[120:123]
  v_mfma_f32_16x16x32_bf16 v[124:127], a[44:47], a[88:91], v[124:127]
  v_mfma_f32_16x16x32_bf16 v[120:123], a[4:7], a[96:99], v[120:123]
  v_mfma_f32_16x16x32_bf16 v[124:127], a[20:23], a[96:99], v[124:127]
  v_mfma_f32_16x16x32_bf16 v[120:123], a[12:15], a[104:107], v[120:123]
  v_mfma_f32_16x16x32_bf16 v[124:127], a[28:31], a[104:107], v[124:127]
  v_mfma_f32_16x16x32_bf16 v[124:127], a[4:7], a[112:115], v[124:127]
  v_mfma_f32_16x16x32_bf16 v[124:127], a[12:15], a[120:123], v[124:127]
  s_nop 4
  ds_write_b128 v11, v[120:123] offset:2048
  s_nop 1
  ds_write_b128 v11, v[124:127] offset:7680
  s_waitcnt vmcnt(8)
  s_mov_b32 exec_hi, 0x00ffffff
  v_subrev_u32 v41, s69, v41
  v_subrev_u32 v43, s69, v43
  v_subrev_u32 v45, s69, v45
  v_subrev_u32 v47, s69, v47
  v_subrev_u32 v49, s69, v49
  v_subrev_u32 v51, s69, v51
  v_subrev_u32 v53, s69, v53
  v_subrev_u32 v55, s69, v55
  v_max3_u32 v41, v41, v43, v45
  v_max3_u32 v47, v47, v49, v51
  v_max_u32 v53, v53, v55
  v_max3_u32 v41, v41, v47, v53
  v_cmp_lt_u32 vcc, 16, v41
  s_cbranch_vccnz MH_SLOW4
MH_RET4:
  v_add_f32 v40, v40, v42
  v_add_f32 v44, v44, v46
  v_add_f32 v48, v48, v50
  v_add_f32 v52, v52, v54
  v_cvt_pk_bf16_f32 v40, v40, v44
  v_cvt_pk_bf16_f32 v48, v48, v52
  ds_write2_b32 v37, v48, v40 offset0:0 offset1:224
  s_mov_b64 exec, -1
  s_waitcnt lgkmcnt(0)
  s_barrier
  ds_read_b128 v[88:91], v13 offset:0
  ds_read_b128 v[92:95], v13 offset:8704
  ds_read_b128 v[96:99], v13 offset:17408
  ds_read_b128 v[100:103], v13 offset:26112
  s_add_u32 s44, s60, 1388544
  s_waitcnt lgkmcnt(2)
  v_add_f32 v88, v88, v92
  v_add_f32 v89, v89, v93
  v_add_f32 v90, v90, v94
  v_add_f32 v91, v91, v95
  s_waitcnt lgkmcnt(0)
  v_add_f32 v96, v96, v100
  v_add_f32 v97, v97, v101
  v_add_f32 v98, v98, v102
  v_add_f32 v99, v99, v103
  v_add_f32 v88, v88, v96
  v_add_f32 v89, v89, v97
  v_add_f32 v90, v90, v98
  v_add_f32 v91, v91, v99
  v_fma_f32 v88, v88, v18, v68
  v_fma_f32 v89, v89, v18, v69
  v_fma_f32 v90, v90, v18, v70
  v_fma_f32 v91, v91, v18, v71
  v_cvt_pk_bf16_f32 v80, v88, v89
  v_cvt_pk_bf16_f32 v81, v90, v91
  s_nop 0
  v_permlane32_swap_b32 v80, v82
  v_permlane32_swap_b32 v81, v83
  buffer_store_dwordx4 v[80:83], v14, s[16:19], s44 offen sc1
  v_min_u32 v19, 6, v2
  s_mul_i32 s42, s32, 448
  v_lshl_add_u32 v19, v19, 6, s42
  s_mov_b32 s42, 55296
  v_and_b32 v21, 31, v2
  v_lshlrev_b32 v22, 2, v21
  v_lshlrev_b32 v21, 3, v21
  v_add_u32 v22, 162816, v22
  v_lshl_add_u32 v24, v3, 11, v21
  v_lshl_add_u32 v25, v3, 7, v22
  s_and_b32 s26, s3, 3
  s_mov_b32 s60, 0x3516240
  s_cmp_eq_u32 s26, 1
  s_cselect_b32 s60, 0x6204315, s60
  s_cmp_eq_u32 s26, 2
  s_cselect_b32 s60, 0x1504326, s60
  s_cmp_eq_u32 s26, 3
  s_cselect_b32 s60, 0x4026513, s60
  s_mul_i32 s25, s32, 28672
  s_mul_i32 s61, s58, 229376
  s_add_u32 s61, s61, s25
  s_add_u32 s61, s61, 5898240
  s_and_b32 s24, s3, 4
  s_add_u32 s24, s24, s59
  s_lshl3_add_u32 s24, s26, s24
  s_mul_i32 s44, s24, 114688
  s_add_u32 s44, s44, s25
  s_add_u32 s44, s44, 7536640
  s_add_u32 s45, s44, 3670016
  s_lshl2_add_u32 s34, s6, s32
  s_lshl_b32 s34, s34, 10
  s_add_u32 s34, s34, 7536640
  s_waitcnt vmcnt(1)
  ds_read_b32 v88, v17 offset:21504
  ds_read_b32 v89, v17 offset:25600
  ds_read_b32 v90, v17 offset:29696
  ds_read_b32 v91, v17 offset:33792
  ds_read_b32 v92, v17 offset:37888
  ds_read_b32 v93, v17 offset:41984
  ds_read_b32 v94, v17 offset:46080
  s_mul_i32 s26, s51, 28928
  s_add_u32 s26, s26, s35
  s_add_u32 m0, s38, 115712
  s_add_u32 s25, s26, 0
  buffer_load_dwordx4 v6, s[16:19], s25 offen sc1 lds
  s_add_u32 m0, s38, 119808
  s_add_u32 s25, s26, 4096
  buffer_load_dwordx4 v6, s[16:19], s25 offen sc1 lds
  s_add_u32 m0, s38, 123904
  s_add_u32 s25, s26, 8192
  buffer_load_dwordx4 v6, s[16:19], s25 offen sc1 lds
  s_add_u32 m0, s38, 128000
  s_add_u32 s25, s26, 12288
  buffer_load_dwordx4 v6, s[16:19], s25 offen sc1 lds
  s_add_u32 m0, s38, 132096
  s_add_u32 s25, s26, 16384
  buffer_load_dwordx4 v6, s[16:19], s25 offen sc1 lds
  s_add_u32 m0, s38, 136192
  s_add_u32 s25, s26, 20480
  buffer_load_dwordx4 v6, s[16:19], s25 offen sc1 lds
  s_add_u32 m0, s38, 140288
  s_add_u32 s25, s26, 24576
  buffer_load_dwordx4 v6, s[16:19], s25 offen sc1 lds
  s_waitcnt lgkmcnt(0)
  v_max3_u32 v88, v88, v89, v90
  v_max3_u32 v91, v91, v92, v93
  v_max3_u32 v88, v88, v91, v94
  v_cmp_eq_u32 vcc, -1, v88
  s_cbranch_vccnz MH_SLOW5
MH_RET5:
  s_barrier
  s_setprio 0
  buffer_load_dword v23, v19, s[16:19], s42 offen sc1
  s_mul_i32 s26, s52, 28928
  s_add_u32 s26, s26, s35
  s_add_u32 m0, s38, 3328
  s_add_u32 s25, s26, 0
  buffer_load_dwordx4 v6, s[16:19], s25 offen sc1 lds
  s_add_u32 m0, s38, 69632
  s_add_u32 s25, s26, 4096
  buffer_load_dwordx4 v6, s[16:19], s25 offen sc1 lds
  s_add_u32 m0, s38, 152576
  s_add_u32 s25, s26, 8192
  buffer_load_dwordx4 v6, s[16:19], s25 offen sc1 lds
  s_add_u32 m0, s38, 55680
  s_add_u32 s25, s26, 12288
  buffer_load_dwordx4 v6, s[16:19], s25 offen sc1 lds
  s_add_u32 m0, s38, 12096
  s_add_u32 s25, s26, 16384
  buffer_load_dwordx4 v6, s[16:19], s25 offen sc1 lds
  s_add_u32 m0, s38, 73728
  s_add_u32 s25, s26, 20480
  buffer_load_dwordx4 v6, s[16:19], s25 offen sc1 lds
  s_add_u32 m0, s38, 59840
  s_add_u32 s25, s26, 24576
  buffer_load_dwordx4 v6, s[16:19], s25 offen sc1 lds
  s_waitcnt vmcnt(7)
  v_subrev_u32 v23, s69, v23
  v_cmp_lt_u32 vcc, 16, v23
  s_cbranch_vccnz MH_SLOW6
MH_RET6:
  s_bfe_u32 s25, s60, 0x40000
  s_lshl_b32 s25, s25, 12
  s_add_u32 s25, s25, s61
  s_add_u32 s26, s25, 114688
  buffer_load_dwordx4 a[0:3], v6, s[16:19], s25 offen offset:0 sc1
  buffer_load_dwordx4 a[4:7], v6, s[16:19], s26 offen offset:0 sc1
  buffer_load_dwordx4 a[8:11], v6, s[16:19], s25 offen offset:1024 sc1
  buffer_load_dwordx4 a[12:15], v6, s[16:19], s26 offen offset:1024 sc1
  ds_read_b32 v88, v17 offset:50176
  ds_read_b32 v89, v17 offset:54272
  ds_read_b32 v90, v17 offset:58368
  ds_read_b32 v91, v17 offset:62464
  ds_read_b32 v92, v20 offset:1024
  ds_read_b32 v93, v20 offset:5120
  ds_read_b32 v94, v20 offset:9216
  s_waitcnt lgkmcnt(0)
  v_max3_u32 v88, v88, v89, v90
  v_max3_u32 v91, v91, v92, v93
  v_max3_u32 v88, v88, v91, v94
  v_cmp_eq_u32 vcc, -1, v88
  s_cbranch_vccnz MH_SLOW7
MH_RET7:
  s_waitcnt lgkmcnt(0)
  s_barrier
  s_mul_i32 s26, s53, 28928
  s_add_u32 s26, s26, s35
  s_add_u32 m0, s38, 16256
  s_add_u32 s25, s26, 0
  buffer_load_dwordx4 v6, s[16:19], s25 offen sc1 lds
  s_add_u32 m0, s38, 81920
  s_add_u32 s25, s26, 4096
  buffer_load_dwordx4 v6, s[16:19], s25 offen sc1 lds
  s_add_u32 m0, s38, 46912
  s_add_u32 s25, s26, 8192
  buffer_load_dwordx4 v6, s[16:19], s25 offen sc1 lds
  s_add_u32 m0, s38, 144384
  s_add_u32 s25, s26, 12288
  buffer_load_dwordx4 v6, s[16:19], s25 offen sc1 lds
  s_add_u32 m0, s38, 99328
  s_add_u32 s25, s26, 16384
  buffer_load_dwordx4 v6, s[16:19], s25 offen sc1 lds
  s_add_u32 m0, s38, 51072
  s_add_u32 s25, s26, 20480
  buffer_load_dwordx4 v6, s[16:19], s25 offen sc1 lds
  s_add_u32 m0, s38, 87040
  s_add_u32 s25, s26, 24576
  buffer_load_dwordx4 v6, s[16:19], s25 offen sc1 lds
  s_waitcnt vmcnt(11)
  ds_read_b32 v88, v16 offset:3328
  ds_read_b32 v89, v17 offset:4096
  ds_read_b32 v90, v20 offset:21504
  ds_read_b32 v91, v16 offset:55680
  ds_read_b32 v92, v16 offset:12096
  ds_read_b32 v93, v17 offset:8192
  ds_read_b32 v94, v16 offset:59840
  s_bfe_u32 s25, s60, 0x40000
  s_lshl_b32 s25, s25, 12
  s_add_u32 s25, s25, s61
  s_add_u32 s26, s25, 114688
  buffer_load_dwordx4 a[16:19], v6, s[16:19], s25 offen offset:2048 sc1
  buffer_load_dwordx4 a[20:23], v6, s[16:19], s26 offen offset:2048 sc1
  buffer_load_dwordx4 a[24:27], v6, s[16:19], s25 offen offset:3072 sc1
  buffer_load_dwordx4 a[28:31], v6, s[16:19], s26 offen offset:3072 sc1
  s_waitcnt lgkmcnt(0)
  v_max3_u32 v88, v88, v89, v90
  v_max3_u32 v91, v91, v92, v93
  v_max3_u32 v88, v88, v91, v94
  v_cmp_eq_u32 vcc, -1, v88
  s_cbranch_vccnz MH_SLOW8
MH_RET8:
  s_waitcnt lgkmcnt(0)
  s_barrier
  v_lshrrev_b32 v26, 4, v2
  v_lshlrev_b32 v26, 3, v26
  v_and_b32 v60, 0xf0, v6
  v_lshl_add_u32 v26, v26, 8, v60
  v_lshrrev_b32 v27, 1, v6
  v_add_u32 v27, 162816, v27
  s_lshl_b32 s25, s50, 8
  s_add_u32 s25, s25, 73728
  buffer_load_dwordx4 v[60:63], v26, s[16:19], s25 offen sc1
  s_mul_i32 s26, s54, 28928
  s_add_u32 s26, s26, s35
  s_add_u32 m0, s38, 156672
  s_add_u32 s25, s26, 0
  buffer_load_dwordx4 v6, s[16:19], s25 offen sc1 lds
  s_add_u32 m0, s38, 29632
  s_add_u32 s25, s26, 4096
  buffer_load_dwordx4 v6, s[16:19], s25 offen sc1 lds
  s_add_u32 m0, s38, 77824
  s_add_u32 s25, s26, 8192
  buffer_load_dwordx4 v6, s[16:19], s25 offen sc1 lds
  s_add_u32 m0, s38, 91136
  s_add_u32 s25, s26, 12288
  buffer_load_dwordx4 v6, s[16:19], s25 offen sc1 lds
  s_add_u32 m0, s38, 7488
  s_add_u32 s25, s26, 16384
  buffer_load_dwordx4 v6, s[16:19], s25 offen sc1 lds
  s_add_u32 m0, s38, 132096
  s_add_u32 s25, s26, 20480
  buffer_load_dwordx4 v6, s[16:19], s25 offen sc1 lds
  s_add_u32 m0, s38, 128000
  s_add_u32 s25, s26, 24576
  buffer_load_dwordx4 v6, s[16:19], s25 offen sc1 lds
  s_waitcnt vmcnt(12)
  ds_read_b32 v88, v16 offset:16256
  ds_read_b32 v89, v17 offset:16384
  ds_read_b32 v90, v16 offset:46912
  ds_read_b32 v91, v20 offset:13312
  ds_read_b32 v92, v17 offset:33792
  ds_read_b32 v93, v16 offset:51072
  ds_read_b32 v94, v17 offset:21504
  s_bfe_u32 s25, s60, 0x40004
  s_lshl_b32 s25, s25, 12
  s_add_u32 s25, s25, s61
  s_add_u32 s26, s25, 114688
  buffer_load_dwordx4 a[32:35], v6, s[16:19], s25 offen offset:0 sc1
  buffer_load_dwordx4 a[36:39], v6, s[16:19], s26 offen offset:0 sc1
  buffer_load_dwordx4 a[40:43], v6, s[16:19], s25 offen offset:1024 sc1
  buffer_load_dwordx4 a[44:47], v6, s[16:19], s26 offen offset:1024 sc1
  s_waitcnt lgkmcnt(0)
  v_max3_u32 v88, v88, v89, v90
  v_max3_u32 v91, v91, v92, v93
  v_max3_u32 v88, v88, v91, v94
  v_cmp_eq_u32 vcc, -1, v88
  s_cbranch_vccnz MH_SLOW9
MH_RET9:
  s_waitcnt vmcnt(11)
  v_subrev_u32 v61, s69, v61
  v_subrev_u32 v63, s69, v63
  v_max_u32 v61, v61, v63
  v_cmp_lt_u32 vcc, 16, v61
  s_cbranch_vccnz MH_SLOW10
MH_RET10:
  ds_write2_b32 v27, v60, v62 offset0:0 offset1:1
  s_waitcnt lgkmcnt(0)
  s_barrier
  s_mul_i32 s26, s55, 28928
  s_add_u32 s26, s26, s35
  s_add_u32 m0, s38, 33792
  s_add_u32 s25, s26, 0
  buffer_load_dwordx4 v6, s[16:19], s25 offen sc1 lds
  s_add_u32 m0, s38, 111616
  s_add_u32 s25, s26, 4096
  buffer_load_dwordx4 v6, s[16:19], s25 offen sc1 lds
  s_add_u32 m0, s38, 3328
  s_add_u32 s25, s26, 8192
  buffer_load_dwordx4 v6, s[16:19], s25 offen sc1 lds
  s_add_u32 m0, s38, 95232
  s_add_u32 s25, s26, 12288
  buffer_load_dwordx4 v6, s[16:19], s25 offen sc1 lds
  s_add_u32 m0, s38, 103424
  s_add_u32 s25, s26, 16384
  buffer_load_dwordx4 v6, s[16:19], s25 offen sc1 lds
  s_add_u32 m0, s38, 107520
  s_add_u32 s25, s26, 20480
  buffer_load_dwordx4 v6, s[16:19], s25 offen sc1 lds
  s_add_u32 m0, s38, 115712
  s_add_u32 s25, s26, 24576
  buffer_load_dwordx4 v6, s[16:19], s25 offen sc1 lds
  s_waitcnt vmcnt(11)
  ds_read_b32 v88, v20 offset:25600
  ds_read_b32 v89, v16 offset:29632
  ds_read_b32 v90, v17 offset:12288
  ds_read_b32 v91, v17 offset:25600
  ds_read_b32 v92, v16 offset:7488
  ds_read_b32 v93, v20 offset:1024
  ds_read_b32 v94, v17 offset:62464
  s_bfe_u32 s25, s60, 0x40004
  s_lshl_b32 s25, s25, 12
  s_add_u32 s25, s25, s61
  s_add_u32 s26, s25, 114688
  buffer_load_dwordx4 a[48:51], v6, s[16:19], s25 offen offset:2048 sc1
  buffer_load_dwordx4 a[52:55], v6, s[16:19], s26 offen offset:2048 sc1
  buffer_load_dwordx4 a[56:59], v6, s[16:19], s25 offen offset:3072 sc1
  buffer_load_dwordx4 a[60:63], v6, s[16:19], s26 offen offset:3072 sc1
  s_waitcnt lgkmcnt(0)
  v_max3_u32 v88, v88, v89, v90
  v_max3_u32 v91, v91, v92, v93
  v_max3_u32 v88, v88, v91, v94
  v_cmp_eq_u32 vcc, -1, v88
  s_cbranch_vccnz MH_SLOW11
MH_RET11:
  s_bfe_u32 s25, s60, 0x40008
  s_lshl_b32 s25, s25, 12
  s_add_u32 s25, s25, s61
  s_add_u32 s26, s25, 114688
  buffer_load_dwordx4 a[64:67], v6, s[16:19], s25 offen offset:0 sc1
  buffer_load_dwordx4 a[68:71], v6, s[16:19], s26 offen offset:0 sc1
  buffer_load_dwordx4 a[72:75], v6, s[16:19], s25 offen offset:1024 sc1
  buffer_load_dwordx4 a[76:79], v6, s[16:19], s26 offen offset:1024 sc1
  s_bfe_u32 s25, s60, 0x40008
  s_lshl_b32 s25, s25, 12
  s_add_u32 s25, s25, s61
  s_add_u32 s26, s25, 114688
  buffer_load_dwordx4 a[80:83], v6, s[16:19], s25 offen offset:2048 sc1
  buffer_load_dwordx4 a[84:87], v6, s[16:19], s26 offen offset:2048 sc1
  buffer_load_dwordx4 a[88:91], v6, s[16:19], s25 offen offset:3072 sc1
  buffer_load_dwordx4 a[92:95], v6, s[16:19], s26 offen offset:3072 sc1
  s_waitcnt lgkmcnt(0)
  s_barrier
  s_mul_i32 s26, s56, 28928
  s_add_u32 s26, s26, s35
  s_add_u32 m0, s38, 55680
  s_add_u32 s25, s26, 0
  buffer_load_dwordx4 v6, s[16:19], s25 offen sc1 lds
  s_add_u32 m0, s38, 148480
  s_add_u32 s25, s26, 4096
  buffer_load_dwordx4 v6, s[16:19], s25 offen sc1 lds
  s_add_u32 m0, s38, 25024
  s_add_u32 s25, s26, 8192
  buffer_load_dwordx4 v6, s[16:19], s25 offen sc1 lds
  s_add_u32 m0, s38, 99328
  s_add_u32 s25, s26, 12288
  buffer_load_dwordx4 v6, s[16:19], s25 offen sc1 lds
  s_add_u32 m0, s38, 73728
  s_add_u32 s25, s26, 16384
  buffer_load_dwordx4 v6, s[16:19], s25 offen sc1 lds
  s_add_u32 m0, s38, 20864
  s_add_u32 s25, s26, 20480
  buffer_load_dwordx4 v6, s[16:19], s25 offen sc1 lds
  s_add_u32 m0, s38, 69632
  s_add_u32 s25, s26, 24576
  buffer_load_dwordx4 v6, s[16:19], s25 offen sc1 lds
  v_mov_b32 v26, s57
  s_mov_b32 exec_hi, 0xffff
  v_mov_b32 v26, s56
  s_mov_b32 exec_hi, 0
  v_mov_b32 v26, s55
  s_mov_b32 exec_lo, 0xffff
  v_mov_b32 v26, s54
  s_mov_b64 exec, -1
  v_and_b32 v60, 0xf0, v6
  v_lshl_add_u32 v26, v26, 8, v60
  v_lshrrev_b32 v27, 1, v6
  v_add_u32 v27, 163328, v27
  s_mov_b32 s25, 73728
  buffer_load_dwordx4 v[60:63], v26, s[16:19], s25 offen sc1
  s_waitcnt vmcnt(20)
  ds_read_b32 v88, v16 offset:33792
  ds_read_b32 v89, v17 offset:46080
  ds_read_b32 v90, v16 offset:3328
  ds_read_b32 v91, v17 offset:29696
  ds_read_b32 v92, v17 offset:37888
  ds_read_b32 v93, v17 offset:41984
  ds_read_b32 v94, v17 offset:50176
  s_bfe_u32 s25, s60, 0x4000c
  s_lshl_b32 s25, s25, 12
  s_add_u32 s25, s25, s61
  s_add_u32 s26, s25, 114688
  buffer_load_dwordx4 a[96:99], v6, s[16:19], s25 offen offset:0 sc1
  buffer_load_dwordx4 a[100:103], v6, s[16:19], s26 offen offset:0 sc1
  buffer_load_dwordx4 a[104:107], v6, s[16:19], s25 offen offset:1024 sc1
  buffer_load_dwordx4 a[108:111], v6, s[16:19], s26 offen offset:1024 sc1
  s_waitcnt lgkmcnt(0)
  v_max3_u32 v88, v88, v89, v90
  v_max3_u32 v91, v91, v92, v93
  v_max3_u32 v88, v88, v91, v94
  v_cmp_eq_u32 vcc, -1, v88
  s_cbranch_vccnz MH_SLOW12
MH_RET12:
  s_bfe_u32 s26, s60, 0x4000c
  s_lshl_b32 s26, s26, 12
  s_add_u32 s26, s26, s61
  s_add_u32 m0, s38, 38144
  s_add_u32 s25, s26, 2048
  buffer_load_dwordx4 v6, s[16:19], s25 offen sc1 lds
  s_add_u32 m0, s38, 64448
  s_add_u32 s25, s26, 116736
  buffer_load_dwordx4 v6, s[16:19], s25 offen sc1 lds
  s_add_u32 m0, s38, 140288
  s_add_u32 s25, s26, 3072
  buffer_load_dwordx4 v6, s[16:19], s25 offen sc1 lds
  s_add_u32 m0, s38, 12096
  s_add_u32 s25, s26, 117760
  buffer_load_dwordx4 v6, s[16:19], s25 offen sc1 lds
  s_waitcnt vmcnt(8)
  v_subrev_u32 v61, s69, v61
  v_subrev_u32 v63, s69, v63
  v_max_u32 v61, v61, v63
  v_cmp_lt_u32 vcc, 16, v61
  s_cbranch_vccnz MH_SLOW13
MH_RET13:
  ds_write2_b32 v27, v60, v62 offset0:0 offset1:1
  s_waitcnt lgkmcnt(0)
  s_barrier
  s_mul_i32 s25, s5, 28
  s_add_u32 s25, s25, s6
  s_lshl_b32 s25, s25, 6
  s_add_u32 s25, s25, 57344
  v_add_u32_e64 v7, s69, 3
  s_cmp_lg_u32 s4, 7
  s_cbranch_scc1 MH_NOF5
  s_mov_b64 exec, 1
  buffer_store_dword v7, off, s[16:19], s25 sc1
  s_mov_b64 exec, -1
MH_NOF5:
  s_mul_i32 s26, s57, 28928
  s_add_u32 s26, s26, s35
  s_add_u32 m0, s38, 152576
  s_add_u32 s25, s26, 0
  buffer_load_dwordx4 v6, s[16:19], s25 offen sc1 lds
  s_add_u32 m0, s38, 156672
  s_add_u32 s25, s26, 4096
  buffer_load_dwordx4 v6, s[16:19], s25 offen sc1 lds
  s_add_u32 m0, s38, 77824
  s_add_u32 s25, s26, 8192
  buffer_load_dwordx4 v6, s[16:19], s25 offen sc1 lds
  s_add_u32 m0, s38, 132096
  s_add_u32 s25, s26, 12288
  buffer_load_dwordx4 v6, s[16:19], s25 offen sc1 lds
  s_add_u32 m0, s38, 87040
  s_add_u32 s25, s26, 16384
  buffer_load_dwordx4 v6, s[16:19], s25 offen sc1 lds
  s_add_u32 m0, s38, 46912
  s_add_u32 s25, s26, 20480
  buffer_load_dwordx4 v6, s[16:19], s25 offen sc1 lds
  s_add_u32 m0, s38, 42304
  s_add_u32 s25, s26, 24576
  buffer_load_dwordx4 v6, s[16:19], s25 offen sc1 lds
  ds_read_b32 v88, v16 offset:55680
  ds_read_b32 v89, v20 offset:17408
  ds_read_b32 v90, v16 offset:25024
  ds_read_b32 v91, v17 offset:33792
  ds_read_b32 v92, v17 offset:8192
  ds_read_b32 v93, v16 offset:20864
  ds_read_b32 v94, v17 offset:4096
  s_bfe_u32 s26, s60, 0x40010
  s_lshl_b32 s26, s26, 12
  s_add_u32 s26, s26, s61
  s_add_u32 m0, s38, 81920
  s_add_u32 s25, s26, 0
  buffer_load_dwordx4 v6, s[16:19], s25 offen sc1 lds
  s_add_u32 m0, s38, 119808
  s_add_u32 s25, s26, 114688
  buffer_load_dwordx4 v6, s[16:19], s25 offen sc1 lds
  s_add_u32 m0, s38, 136192
  s_add_u32 s25, s26, 1024
  buffer_load_dwordx4 v6, s[16:19], s25 offen sc1 lds
  s_add_u32 m0, s38, 7488
  s_add_u32 s25, s26, 115712
  buffer_load_dwordx4 v6, s[16:19], s25 offen sc1 lds
  s_waitcnt lgkmcnt(0)
  v_max3_u32 v88, v88, v89, v90
  v_max3_u32 v91, v91, v92, v93
  v_max3_u32 v88, v88, v91, v94
  v_cmp_eq_u32 vcc, -1, v88
  s_cbranch_vccnz MH_SLOW14
MH_RET14:
  s_bfe_u32 s26, s60, 0x40010
  s_lshl_b32 s26, s26, 12
  s_add_u32 s26, s26, s61
  s_add_u32 m0, s38, 91136
  s_add_u32 s25, s26, 2048
  buffer_load_dwordx4 v6, s[16:19], s25 offen sc1 lds
  s_add_u32 m0, s38, 59840
  s_add_u32 s25, s26, 116736
  buffer_load_dwordx4 v6, s[16:19], s25 offen sc1 lds
  s_add_u32 m0, s38, 29632
  s_add_u32 s25, s26, 3072
  buffer_load_dwordx4 v6, s[16:19], s25 offen sc1 lds
  s_add_u32 m0, s38, 51072
  s_add_u32 s25, s26, 117760
  buffer_load_dwordx4 v6, s[16:19], s25 offen sc1 lds
  s_waitcnt lgkmcnt(0)
  s_barrier
  s_and_b32 s36, s24, 7
  s_mul_i32 s36, s36, 1792
  s_add_u32 s36, s36, 57344
  buffer_load_dword v23, v19, s[16:19], s36 offen sc1
  s_bfe_u32 s26, s60, 0x40014
  s_lshl_b32 s26, s26, 12
  s_add_u32 s26, s26, s61
  s_add_u32 m0, s38, 16256
  s_add_u32 s25, s26, 0
  buffer_load_dwordx4 v6, s[16:19], s25 offen sc1 lds
  s_add_u32 m0, s38, 111616
  s_add_u32 s25, s26, 114688
  buffer_load_dwordx4 v6, s[16:19], s25 offen sc1 lds
  s_add_u32 m0, s38, 128000
  s_add_u32 s25, s26, 1024
  buffer_load_dwordx4 v6, s[16:19], s25 offen sc1 lds
  s_add_u32 m0, s38, 107520
  s_add_u32 s25, s26, 115712
  buffer_load_dwordx4 v6, s[16:19], s25 offen sc1 lds
  s_waitcnt vmcnt(13)
  ds_read_b32 v88, v20 offset:21504
  ds_read_b32 v89, v20 offset:25600
  ds_read_b32 v90, v17 offset:12288
  ds_read_b32 v91, v20 offset:1024
  ds_read_b32 v92, v17 offset:21504
  ds_read_b32 v93, v16 offset:46912
  ds_read_b32 v94, v16 offset:42304
  s_bfe_u32 s26, s60, 0x40014
  s_lshl_b32 s26, s26, 12
  s_add_u32 s26, s26, s61
  s_add_u32 m0, s38, 3328
  s_add_u32 s25, s26, 2048
  buffer_load_dwordx4 v6, s[16:19], s25 offen sc1 lds
  s_add_u32 m0, s38, 144384
  s_add_u32 s25, s26, 116736
  buffer_load_dwordx4 v6, s[16:19], s25 offen sc1 lds
  s_add_u32 m0, s38, 33792
  s_add_u32 s25, s26, 3072
  buffer_load_dwordx4 v6, s[16:19], s25 offen sc1 lds
  s_add_u32 m0, s38, 123904
  s_add_u32 s25, s26, 117760
  buffer_load_dwordx4 v6, s[16:19], s25 offen sc1 lds
  s_waitcnt lgkmcnt(0)
  v_max3_u32 v88, v88, v89, v90
  v_max3_u32 v91, v91, v92, v93
  v_max3_u32 v88, v88, v91, v94
  v_cmp_eq_u32 vcc, -1, v88
  s_cbranch_vccnz MH_SLOW15
MH_RET15:
  s_waitcnt vmcnt(8)
  v_subrev_u32 v23, s69, v23
  v_cmp_lt_u32 vcc, 16, v23
  s_cbranch_vccnz MH_SLOW16
MH_RET16:
  s_bfe_u32 s25, s60, 0x40000
  s_lshl_b32 s25, s25, 12
  s_add_u32 s25, s25, s44
  buffer_load_dwordx4 v[28:31], v6, s[16:19], s25 offen offset:0 sc1
  buffer_load_dwordx4 v[32:35], v6, s[16:19], s25 offen offset:1024 sc1
  s_bfe_u32 s25, s60, 0x40000
  s_lshl_b32 s25, s25, 12
  s_add_u32 s25, s25, s44
  buffer_load_dwordx4 v[36:39], v6, s[16:19], s25 offen offset:2048 sc1
  buffer_load_dwordx4 v[40:43], v6, s[16:19], s25 offen offset:3072 sc1
  s_bfe_u32 s25, s60, 0x40004
  s_lshl_b32 s25, s25, 12
  s_add_u32 s25, s25, s44
  buffer_load_dwordx4 v[44:47], v6, s[16:19], s25 offen offset:0 sc1
  buffer_load_dwordx4 v[48:51], v6, s[16:19], s25 offen offset:1024 sc1
  s_waitcnt lgkmcnt(0)
  s_barrier
  s_mul_i32 s25, s5, 28
  s_add_u32 s25, s25, s6
  s_lshl_b32 s25, s25, 6
  s_add_u32 s25, s25, 16384
  v_add_u32_e64 v7, s69, 3
  s_cmp_lg_u32 s4, 7
  s_cbranch_scc1 MH_NOF7
  s_mov_b64 exec, 1
  buffer_store_dword v7, off, s[16:19], s25 sc1
  s_mov_b64 exec, -1
MH_NOF7:
  s_bfe_u32 s26, s60, 0x40018
  s_lshl_b32 s26, s26, 12
  s_add_u32 s26, s26, s61
  s_add_u32 m0, s38, 95232
  s_add_u32 s25, s26, 0
  buffer_load_dwordx4 v6, s[16:19], s25 offen sc1 lds
  s_add_u32 m0, s38, 73728
  s_add_u32 s25, s26, 114688
  buffer_load_dwordx4 v6, s[16:19], s25 offen sc1 lds
  s_add_u32 m0, s38, 103424
  s_add_u32 s25, s26, 1024
  buffer_load_dwordx4 v6, s[16:19], s25 offen sc1 lds
  s_add_u32 m0, s38, 25024
  s_add_u32 s25, s26, 115712
  buffer_load_dwordx4 v6, s[16:19], s25 offen sc1 lds
  s_bfe_u32 s26, s60, 0x40018
  s_lshl_b32 s26, s26, 12
  s_add_u32 s26, s26, s61
  s_add_u32 m0, s38, 20864
  s_add_u32 s25, s26, 2048
  buffer_load_dwordx4 v6, s[16:19], s25 offen sc1 lds
  s_add_u32 m0, s38, 55680
  s_add_u32 s25, s26, 116736
  buffer_load_dwordx4 v6, s[16:19], s25 offen sc1 lds
  s_add_u32 m0, s38, 148480
  s_add_u32 s25, s26, 3072
  buffer_load_dwordx4 v6, s[16:19], s25 offen sc1 lds
  s_add_u32 m0, s38, 99328
  s_add_u32 s25, s26, 117760
  buffer_load_dwordx4 v6, s[16:19], s25 offen sc1 lds
  s_mov_b32 s20, s62
  s_and_b32 s21, s63, 0xffff
  s_mov_b32 s22, 0x1c0000
  s_mov_b32 s23, 0x20000
  v_and_b32 v8, 0xf0, v6
  v_bfe_u32 v9, v2, 4, 1
  v_lshl_add_u32 v12, v9, 12, v8
  v_lshl_add_u32 v12, v3, 8, v12
  v_and_b32 v10, 0x70, v6
  v_lshl_add_u32 v10, v9, 7, v10
  v_bfe_u32 v9, v2, 3, 1
  v_lshl_add_u32 v9, v9, 2, v3
  v_lshl_add_u32 v11, v9, 1, v10
  v_mul_u32_u24 v14, 896, v9
  v_lshrrev_b32 v9, 1, v10
  v_add_u32 v14, v14, v9
  v_add_u32 v10, 160768, v10
  s_mul_i32 s41, s24, 28672
  s_lshl_b32 s25, s58, 7
  s_add_u32 s41, s41, s25
  s_lshr_b32 s25, s4, 1
  s_and_b32 s26, s4, 1
  s_lshl2_add_u32 s40, s25, s26
  s_mul_i32 s40, s40, 1792
  s_add_u32 s40, s40, s41
  s_add_u32 s40, s40, 917504
  v_lshlrev_b32 v16, 4, v8
  v_and_b32 v9, 0x30, v2
  v_add_u32 v16, v16, v9
  s_mul_i32 s42, s24, 28928
  s_lshl_b32 s46, s58, 12
  s_add_u32 s42, s42, s46
  s_lshl_b32 s46, s32, 6
  s_add_u32 s42, s42, s46
  s_add_u32 s42, s42, 147456
  s_lshl_b32 s46, s32, 10
  v_add_u32 v9, s46, v12
  s_lshl_b32 s46, s32, 8
  s_add_u32 s46, s46, 152576
  v_add_u32 v17, s46, v11
  s_mul_i32 s46, s32, 7168
  s_add_u32 s46, s46, s41
  s_add_u32 s47, s46, 1792
  s_lshl_b32 s25, s25, 8
  s_lshl2_add_u32 s25, s26, s25
  s_add_u32 s25, s25, 156672
  v_add_u32 v11, s25, v11
  s_lshl_b32 s25, s4, 9
  s_add_u32 s25, s25, 65536
  v_add_u32 v8, s25, v12
  s_bfe_u32 s25, s60, 0x40004
  s_lshl_b32 s25, s25, 12
  s_add_u32 s25, s25, s44
  buffer_load_dwordx4 v[96:99], v6, s[16:19], s25 offen offset:2048 sc1
  buffer_load_dwordx4 v[100:103], v6, s[16:19], s25 offen offset:3072 sc1
  s_bfe_u32 s25, s60, 0x40008
  s_lshl_b32 s25, s25, 12
  s_add_u32 s25, s25, s44
  buffer_load_dwordx4 v[104:107], v6, s[16:19], s25 offen offset:0 sc1
  buffer_load_dwordx4 v[108:111], v6, s[16:19], s25 offen offset:1024 sc1
  s_bfe_u32 s25, s60, 0x40008
  s_lshl_b32 s25, s25, 12
  s_add_u32 s25, s25, s44
  buffer_load_dwordx4 v[112:115], v6, s[16:19], s25 offen offset:2048 sc1
  buffer_load_dwordx4 v[116:119], v6, s[16:19], s25 offen offset:3072 sc1
  s_bfe_u32 s25, s60, 0x4000c
  s_lshl_b32 s25, s25, 12
  s_add_u32 s25, s25, s44
  buffer_load_dwordx4 v[120:123], v6, s[16:19], s25 offen offset:0 sc1
  buffer_load_dwordx4 v[124:127], v6, s[16:19], s25 offen offset:1024 sc1
  v_and_b32 v20, 0xf0, v6
  v_bfe_u32 v21, v2, 4, 1
  v_lshrrev_b32 v19, 2, v20
  v_lshl_add_u32 v19, v21, 8, v19
  s_lshl_b32 s48, s32, 6
  s_add_u32 s48, s48, 160768
  v_add_u32 v19, s48, v19
  v_cmp_eq_u32 s[28:29], 0, v21
  v_mov_b32 v21, 7168
  s_nop 0
  v_cndmask_b32_e64 v21, 0, v21, s[28:29]
  v_add_u32 v20, v20, v21
  s_lshl2_add_u32 s48, s58, s32
  s_lshl_b32 s48, s48, 8
  s_add_u32 s48, s48, 118784
  s_mov_b32 exec_hi, 0
  buffer_load_dwordx4 v[24:27], v20, s[16:19], s48 offen sc1
  s_mov_b64 exec, -1
  s_waitcnt vmcnt(9)
  s_waitcnt lgkmcnt(0)
  s_setprio 1
  s_barrier
  v_min_u32 v4, 6, v2
  v_lshlrev_b32 v4, 6, v4
  s_and_b32 s71, s24, 7
  s_lshl2_add_u32 s71, s71, s32
  s_mul_i32 s71, s71, 448
  s_add_u32 s71, s71, 16384
  buffer_load_dword v5, v4, s[16:19], s71 offen sc1
  v_max_u32 v60, v28, v32
  v_cmp_eq_u32 vcc, -1, v60
  s_cbranch_vccnz MH_SLOW17
MH_RET17:
  v_mfma_f32_32x32x16_bf16 v[64:79], v[28:31], a[0:3], 0
  v_mfma_f32_32x32x16_bf16 v[80:95], v[28:31], a[4:7], 0
  v_mfma_f32_32x32x16_bf16 v[64:79], v[32:35], a[8:11], v[64:79]
  v_mfma_f32_32x32x16_bf16 v[80:95], v[32:35], a[12:15], v[80:95]
  v_max_u32 v60, v36, v40
  v_cmp_eq_u32 vcc, -1, v60
  s_cbranch_vccnz MH_SLOW18
MH_RET18:
  v_mfma_f32_32x32x16_bf16 v[64:79], v[36:39], a[16:19], v[64:79]
  v_mfma_f32_32x32x16_bf16 v[80:95], v[36:39], a[20:23], v[80:95]
  v_mfma_f32_32x32x16_bf16 v[64:79], v[40:43], a[24:27], v[64:79]
  v_mfma_f32_32x32x16_bf16 v[80:95], v[40:43], a[28:31], v[80:95]
  v_max_u32 v60, v44, v48
  v_cmp_eq_u32 vcc, -1, v60
  s_cbranch_vccnz MH_SLOW19
MH_RET19:
  v_mfma_f32_32x32x16_bf16 v[64:79], v[44:47], a[32:35], v[64:79]
  v_mfma_f32_32x32x16_bf16 v[80:95], v[44:47], a[36:39], v[80:95]
  v_mfma_f32_32x32x16_bf16 v[64:79], v[48:51], a[40:43], v[64:79]
  v_mfma_f32_32x32x16_bf16 v[80:95], v[48:51], a[44:47], v[80:95]
  s_waitcnt vmcnt(8)
  v_max_u32 v60, v96, v100
  v_cmp_eq_u32 vcc, -1, v60
  s_cbranch_vccnz MH_SLOW20
MH_RET20:
  v_mfma_f32_32x32x16_bf16 v[64:79], v[96:99], a[48:51], v[64:79]
  v_mfma_f32_32x32x16_bf16 v[80:95], v[96:99], a[52:55], v[80:95]
  v_mfma_f32_32x32x16_bf16 v[64:79], v[100:103], a[56:59], v[64:79]
  v_mfma_f32_32x32x16_bf16 v[80:95], v[100:103], a[60:63], v[80:95]
  s_waitcnt vmcnt(6)
  v_max_u32 v60, v104, v108
  v_cmp_eq_u32 vcc, -1, v60
  s_cbranch_vccnz MH_SLOW21
MH_RET21:
  v_mfma_f32_32x32x16_bf16 v[64:79], v[104:107], a[64:67], v[64:79]
  v_mfma_f32_32x32x16_bf16 v[80:95], v[104:107], a[68:71], v[80:95]
  v_mfma_f32_32x32x16_bf16 v[64:79], v[108:111], a[72:75], v[64:79]
  v_mfma_f32_32x32x16_bf16 v[80:95], v[108:111], a[76:79], v[80:95]
  s_waitcnt vmcnt(4)
  v_max_u32 v60, v112, v116
  v_cmp_eq_u32 vcc, -1, v60
  s_cbranch_vccnz MH_SLOW22
MH_RET22:
  v_mfma_f32_32x32x16_bf16 v[64:79], v[112:115], a[80:83], v[64:79]
  v_mfma_f32_32x32x16_bf16 v[80:95], v[112:115], a[84:87], v[80:95]
  v_mfma_f32_32x32x16_bf16 v[64:79], v[116:119], a[88:91], v[64:79]
  v_mfma_f32_32x32x16_bf16 v[80:95], v[116:119], a[92:95], v[80:95]
  s_waitcnt vmcnt(1)
  s_mov_b32 exec_hi, 0
  v_subrev_u32 v25, s69, v25
  v_subrev_u32 v27, s69, v27
  v_max_u32 v25, v25, v27
  v_cmp_lt_u32 vcc, 16, v25
  s_cbranch_vccnz MH_SLOW23
MH_RET23:
  v_add_f32 v24, v24, v26
  v_cvt_pk_bf16_f32 v24, 0, v24
  v_add_f32 v25, 0x2b800000, v24
  v_rcp_f32 v25, v25
  s_nop 0
  v_cndmask_b32_e64 v24, v25, v24, s[28:29]
  ds_write_b32 v19, v24
  s_mov_b64 exec, -1
  v_max_u32 v60, v120, v124
  v_cmp_eq_u32 vcc, -1, v60
  s_cbranch_vccnz MH_SLOW24
MH_RET24:
  v_mfma_f32_32x32x16_bf16 v[64:79], v[120:123], a[96:99], v[64:79]
  v_mfma_f32_32x32x16_bf16 v[80:95], v[120:123], a[100:103], v[80:95]
  v_mfma_f32_32x32x16_bf16 v[64:79], v[124:127], a[104:107], v[64:79]
  v_mfma_f32_32x32x16_bf16 v[80:95], v[124:127], a[108:111], v[80:95]
  s_add_u32 m0, s38, 152576
  s_add_u32 s25, s42, 0
  buffer_load_dwordx4 v16, s[16:19], s25 offen sc1 lds
  s_waitcnt vmcnt(1)
  v_subrev_u32 v5, s69, v5
  v_cmp_lt_u32 vcc, 16, v5
  s_cbranch_vccnz MH_SLOW25
MH_RET25:
  s_bfe_u32 s25, s60, 0x40000
  s_lshl_b32 s25, s25, 12
  s_add_u32 s25, s25, s45
  buffer_load_dwordx4 v[52:55], v6, s[16:19], s25 offen offset:0 sc1
  buffer_load_dwordx4 v[56:59], v6, s[16:19], s25 offen offset:1024 sc1
  s_bfe_u32 s25, s60, 0x40000
  s_lshl_b32 s25, s25, 12
  s_add_u32 s25, s25, s45
  buffer_load_dwordx4 a[112:115], v6, s[16:19], s25 offen offset:2048 sc1
  buffer_load_dwordx4 a[116:119], v6, s[16:19], s25 offen offset:3072 sc1
  s_bfe_u32 s25, s60, 0x40004
  s_lshl_b32 s25, s25, 12
  s_add_u32 s25, s25, s45
  buffer_load_dwordx4 a[120:123], v6, s[16:19], s25 offen offset:0 sc1
  buffer_load_dwordx4 a[124:127], v6, s[16:19], s25 offen offset:1024 sc1
  s_bfe_u32 s25, s60, 0x40004
  s_lshl_b32 s25, s25, 12
  s_add_u32 s25, s25, s45
  buffer_load_dwordx4 v[28:31], v6, s[16:19], s25 offen offset:2048 sc1
  buffer_load_dwordx4 v[32:35], v6, s[16:19], s25 offen offset:3072 sc1
  s_bfe_u32 s25, s60, 0x40008
  s_lshl_b32 s25, s25, 12
  s_add_u32 s25, s25, s45
  buffer_load_dwordx4 v[36:39], v6, s[16:19], s25 offen offset:0 sc1
  buffer_load_dwordx4 v[40:43], v6, s[16:19], s25 offen offset:1024 sc1
  s_bfe_u32 s25, s60, 0x40008
  s_lshl_b32 s25, s25, 12
  s_add_u32 s25, s25, s45
  buffer_load_dwordx4 v[44:47], v6, s[16:19], s25 offen offset:2048 sc1
  buffer_load_dwordx4 v[48:51], v6, s[16:19], s25 offen offset:3072 sc1
  s_bfe_u32 s25, s60, 0x4000c
  s_lshl_b32 s25, s25, 12
  s_add_u32 s25, s25, s45
  buffer_load_dwordx4 v[20:23], v6, s[16:19], s25 offen offset:0 sc1
  buffer_load_dwordx4 v[24:27], v6, s[16:19], s25 offen offset:1024 sc1
  s_add_u32 m0, s38, 156672
  s_add_u32 s25, s42, 925696
  buffer_load_dwordx4 v16, s[16:19], s25 offen sc1 lds
  s_waitcnt vmcnt(15) lgkmcnt(0)
  s_barrier
  s_waitcnt vmcnt(13)
  v_max_u32 v60, v52, v56
  v_cmp_eq_u32 vcc, -1, v60
  s_cbranch_vccnz MH_SLOW26
MH_RET26:
  v_mfma_f32_32x32x16_bf16 v[96:111], v[52:55], a[0:3], 0
  s_lshl_b32 m0, s4, 13
  v_mfma_f32_32x32x16_bf16 v[112:127], v[52:55], a[4:7], 0
  ds_write_addtid_b32 v64 offset:0
  ds_write_addtid_b32 v65 offset:256
  v_mfma_f32_32x32x16_bf16 v[96:111], v[56:59], a[8:11], v[96:111]
  ds_write_addtid_b32 v66 offset:512
  ds_write_addtid_b32 v67 offset:768
  v_mfma_f32_32x32x16_bf16 v[112:127], v[56:59], a[12:15], v[112:127]
  ds_write_addtid_b32 v68 offset:1024
  ds_write_addtid_b32 v69 offset:1280
  s_waitcnt vmcnt(11)
  v_accvgpr_read_b32 v60, a112
  v_accvgpr_read_b32 v61, a116
  v_max_u32 v60, v60, v61
  v_cmp_eq_u32 vcc, -1, v60
  s_cbranch_vccnz MH_SLOW27
MH_RET27:
  v_mfma_f32_32x32x16_bf16 v[96:111], a[112:115], a[16:19], v[96:111]
  ds_write_addtid_b32 v70 offset:1536
  ds_write_addtid_b32 v71 offset:1792
  v_mfma_f32_32x32x16_bf16 v[112:127], a[112:115], a[20:23], v[112:127]
  ds_write_addtid_b32 v72 offset:2048
  ds_write_addtid_b32 v73 offset:2304
  v_mfma_f32_32x32x16_bf16 v[96:111], a[116:119], a[24:27], v[96:111]
  ds_write_addtid_b32 v74 offset:2560
  ds_write_addtid_b32 v75 offset:2816
  v_mfma_f32_32x32x16_bf16 v[112:127], a[116:119], a[28:31], v[112:127]
  ds_write_addtid_b32 v76 offset:3072
  ds_write_addtid_b32 v77 offset:3328
  s_waitcnt vmcnt(9)
  v_accvgpr_read_b32 v60, a120
  v_accvgpr_read_b32 v61, a124
  v_max_u32 v60, v60, v61
  v_cmp_eq_u32 vcc, -1, v60
  s_cbranch_vccnz MH_SLOW28
MH_RET28:
  v_mfma_f32_32x32x16_bf16 v[96:111], a[120:123], a[32:35], v[96:111]
  ds_write_addtid_b32 v78 offset:3584
  ds_write_addtid_b32 v79 offset:3840
  v_mfma_f32_32x32x16_bf16 v[112:127], a[120:123], a[36:39], v[112:127]
  ds_write_addtid_b32 v80 offset:4096
  ds_write_addtid_b32 v81 offset:4352
  v_mfma_f32_32x32x16_bf16 v[96:111], a[124:127], a[40:43], v[96:111]
  ds_write_addtid_b32 v82 offset:4608
  ds_write_addtid_b32 v83 offset:4864
  v_mfma_f32_32x32x16_bf16 v[112:127], a[124:127], a[44:47], v[112:127]
  ds_write_addtid_b32 v84 offset:5120
  ds_write_addtid_b32 v85 offset:5376
  s_waitcnt vmcnt(7)
  v_max_u32 v60, v28, v32
  v_cmp_eq_u32 vcc, -1, v60
  s_cbranch_vccnz MH_SLOW29
MH_RET29:
  v_mfma_f32_32x32x16_bf16 v[96:111], v[28:31], a[48:51], v[96:111]
  ds_write_addtid_b32 v86 offset:5632
  ds_write_addtid_b32 v87 offset:5888
  v_mfma_f32_32x32x16_bf16 v[112:127], v[28:31], a[52:55], v[112:127]
  ds_write_addtid_b32 v88 offset:6144
  ds_write_addtid_b32 v89 offset:6400
  v_mfma_f32_32x32x16_bf16 v[96:111], v[32:35], a[56:59], v[96:111]
  ds_write_addtid_b32 v90 offset:6656
  ds_write_addtid_b32 v91 offset:6912
  v_mfma_f32_32x32x16_bf16 v[112:127], v[32:35], a[60:63], v[112:127]
  ds_write_addtid_b32 v92 offset:7168
  ds_write_addtid_b32 v93 offset:7424
  s_waitcnt vmcnt(5)
  v_max_u32 v60, v36, v40
  v_cmp_eq_u32 vcc, -1, v60
  s_cbranch_vccnz MH_SLOW30
MH_RET30:
  v_mfma_f32_32x32x16_bf16 v[96:111], v[36:39], a[64:67], v[96:111]
  ds_write_addtid_b32 v94 offset:7680
  ds_write_addtid_b32 v95 offset:7936
  v_mfma_f32_32x32x16_bf16 v[112:127], v[36:39], a[68:71], v[112:127]
  ds_read_b128 v[28:31], v10
  ds_read_b128 v[32:35], v10 offset:256
  v_mfma_f32_32x32x16_bf16 v[96:111], v[40:43], a[72:75], v[96:111]
  ds_read_u16 v52, v17 offset:0
  ds_read_u16 v53, v17 offset:1024
  ds_read_u16 v54, v17 offset:2048
  ds_read_u16 v55, v17 offset:3072
  v_mfma_f32_32x32x16_bf16 v[112:127], v[40:43], a[76:79], v[112:127]
  ds_read_u16 v56, v17 offset:4
  ds_read_u16 v57, v17 offset:1028
  ds_read_u16 v58, v17 offset:2052
  ds_read_u16 v59, v17 offset:3076
  s_waitcnt vmcnt(3)
  v_max_u32 v60, v44, v48
  v_cmp_eq_u32 vcc, -1, v60
  s_cbranch_vccnz MH_SLOW31
MH_RET31:
  v_mfma_f32_32x32x16_bf16 v[96:111], v[44:47], a[80:83], v[96:111]
  v_mfma_f32_32x32x16_bf16 v[112:127], v[44:47], a[84:87], v[112:127]
  s_waitcnt lgkmcnt(0)
  v_lshlrev_b32 v52, 16, v52
  v_lshlrev_b32 v53, 16, v53
  v_lshlrev_b32 v54, 16, v54
  v_lshlrev_b32 v55, 16, v55
  v_mfma_f32_32x32x16_bf16 v[96:111], v[48:51], a[88:91], v[96:111]
  v_lshlrev_b32 v56, 16, v56
  v_lshlrev_b32 v57, 16, v57
  v_lshlrev_b32 v58, 16, v58
  v_lshlrev_b32 v59, 16, v59
  v_mfma_f32_32x32x16_bf16 v[112:127], v[48:51], a[92:95], v[112:127]
  v_mul_f32 v52, v52, v32
  v_mul_f32 v53, v53, v33
  v_mul_f32 v54, v54, v34
  v_mul_f32 v55, v55, v35
  s_waitcnt vmcnt(1)
  v_max_u32 v60, v20, v24
  v_cmp_eq_u32 vcc, -1, v60
  s_cbranch_vccnz MH_SLOW32
MH_RET32:
  v_mfma_f32_32x32x16_bf16 v[96:111], v[20:23], a[96:99], v[96:111]
  v_mul_f32 v56, v56, v32
  v_mul_f32 v57, v57, v33
  v_mul_f32 v58, v58, v34
  v_mul_f32 v59, v59, v35
  v_mfma_f32_32x32x16_bf16 v[96:111], v[24:27], a[104:107], v[96:111]
  v_mfma_f32_32x32x16_bf16 v[112:127], v[20:23], a[100:103], v[112:127]
  v_mfma_f32_32x32x16_bf16 v[112:127], v[24:27], a[108:111], v[112:127]
  s_lshl_b32 m0, s4, 13
  s_add_u32 m0, m0, 8064
  s_nop 7
  ds_write_addtid_b32 v96 offset:57472
  ds_write_addtid_b32 v97 offset:57728
  ds_write_addtid_b32 v98 offset:57984
  ds_write_addtid_b32 v99 offset:58240
  ds_write_addtid_b32 v100 offset:58496
  ds_write_addtid_b32 v101 offset:58752
  ds_write_addtid_b32 v102 offset:59008
  ds_write_addtid_b32 v103 offset:59264
  ds_write_addtid_b32 v104 offset:59520
  ds_write_addtid_b32 v105 offset:59776
  ds_write_addtid_b32 v106 offset:60032
  ds_write_addtid_b32 v107 offset:60288
  ds_write_addtid_b32 v108 offset:60544
  ds_write_addtid_b32 v109 offset:60800
  ds_write_addtid_b32 v110 offset:61056
  ds_write_addtid_b32 v111 offset:61312
  ds_write_addtid_b32 v112 offset:61568
  ds_write_addtid_b32 v113 offset:61824
  ds_write_addtid_b32 v114 offset:62080
  ds_write_addtid_b32 v115 offset:62336
  ds_write_addtid_b32 v116 offset:62592
  ds_write_addtid_b32 v117 offset:62848
  ds_write_addtid_b32 v118 offset:63104
  ds_write_addtid_b32 v119 offset:63360
  ds_write_addtid_b32 v120 offset:63616
  ds_write_addtid_b32 v121 offset:63872
  ds_write_addtid_b32 v122 offset:64128
  ds_write_addtid_b32 v123 offset:64384
  ds_write_addtid_b32 v124 offset:64640
  ds_write_addtid_b32 v125 offset:64896
  ds_write_addtid_b32 v126 offset:65152
  ds_write_addtid_b32 v127 offset:65408
  s_waitcnt vmcnt(0) lgkmcnt(0)
  s_barrier
  ds_read_b128 v[64:67], v9 offset:0
  ds_read_b128 v[68:71], v9 offset:8192
  ds_read_b128 v[72:75], v9 offset:16384
  ds_read_b128 v[76:79], v9 offset:24576
  ds_read_b128 v[80:83], v9 offset:32768
  ds_read_b128 v[84:87], v9 offset:40960
  ds_read_b128 v[88:91], v9 offset:49152
  ds_read_b128 v[92:95], v9 offset:57344
  ds_read_b128 v[96:99], v9 offset:512
  ds_read_b128 v[100:103], v9 offset:8704
  ds_read_b128 v[104:107], v9 offset:16896
  ds_read_b128 v[108:111], v9 offset:25088
  s_waitcnt lgkmcnt(10)
  v_add_f32 v64, v64, v68
  v_add_f32 v65, v65, v69
  v_add_f32 v66, v66, v70
  v_add_f32 v67, v67, v71
  ds_read_b128 v[112:115], v9 offset:33280
  ds_read_b128 v[116:119], v9 offset:41472
  s_waitcnt lgkmcnt(10)
  v_add_f32 v72, v72, v76
  v_add_f32 v73, v73, v77
  v_add_f32 v74, v74, v78
  v_add_f32 v75, v75, v79
  ds_read_b128 v[120:123], v9 offset:49664
  ds_read_b128 v[124:127], v9 offset:57856
  s_waitcnt lgkmcnt(10)
  v_add_f32 v80, v80, v84
  v_add_f32 v81, v81, v85
  v_add_f32 v82, v82, v86
  v_add_f32 v83, v83, v87
  ds_read_b128 v[36:39], v8 offset:32768
  ds_read_b128 v[40:43], v8 offset:40960
  s_waitcnt lgkmcnt(10)
  v_add_f32 v88, v88, v92
  v_add_f32 v89, v89, v93
  v_add_f32 v90, v90, v94
  v_add_f32 v91, v91, v95
  ds_read_b128 v[44:47], v8 offset:49152
  ds_read_b128 v[48:51], v8 offset:57344
  v_add_f32 v64, v64, v72
  v_add_f32 v65, v65, v73
  v_add_f32 v66, v66, v74
  v_add_f32 v67, v67, v75
  ds_read_u16 v20, v11 offset:0
  ds_read_u16 v21, v11 offset:1024
  v_add_f32 v80, v80, v88
  v_add_f32 v81, v81, v89
  v_add_f32 v82, v82, v90
  v_add_f32 v83, v83, v91
  ds_read_u16 v22, v11 offset:2048
  ds_read_u16 v23, v11 offset:3072
  v_add_f32 v64, v64, v80
  v_add_f32 v65, v65, v81
  v_add_f32 v66, v66, v82
  v_add_f32 v67, v67, v83
  v_fma_f32 v64, v64, v28, v52
  v_fma_f32 v65, v65, v29, v53
  v_fma_f32 v66, v66, v30, v54
  v_fma_f32 v67, v67, v31, v55
  v_cvt_pk_bf16_f32 v68, v64, v65
  v_cvt_pk_bf16_f32 v69, v66, v67
  buffer_store_dwordx2 v[68:69], v14, s[20:23], s46 offen sc1
  s_waitcnt lgkmcnt(14)
  v_add_f32 v96, v96, v100
  v_add_f32 v97, v97, v101
  v_add_f32 v98, v98, v102
  v_add_f32 v99, v99, v103
  s_waitcnt lgkmcnt(12)
  v_add_f32 v104, v104, v108
  v_add_f32 v105, v105, v109
  v_add_f32 v106, v106, v110
  v_add_f32 v107, v107, v111
  s_waitcnt lgkmcnt(10)
  v_add_f32 v112, v112, v116
  v_add_f32 v113, v113, v117
  v_add_f32 v114, v114, v118
  v_add_f32 v115, v115, v119
  s_waitcnt lgkmcnt(8)
  v_add_f32 v120, v120, v124
  v_add_f32 v121, v121, v125
  v_add_f32 v122, v122, v126
  v_add_f32 v123, v123, v127
  v_add_f32 v96, v96, v104
  v_add_f32 v97, v97, v105
  v_add_f32 v98, v98, v106
  v_add_f32 v99, v99, v107
  v_add_f32 v112, v112, v120
  v_add_f32 v113, v113, v121
  v_add_f32 v114, v114, v122
  v_add_f32 v115, v115, v123
  v_add_f32 v96, v96, v112
  v_add_f32 v97, v97, v113
  v_add_f32 v98, v98, v114
  v_add_f32 v99, v99, v115
  v_fma_f32 v96, v96, v28, v56
  v_fma_f32 v97, v97, v29, v57
  v_fma_f32 v98, v98, v30, v58
  v_fma_f32 v99, v99, v31, v59
  v_cvt_pk_bf16_f32 v100, v96, v97
  v_cvt_pk_bf16_f32 v101, v98, v99
  buffer_store_dwordx2 v[100:101], v14, s[20:23], s47 offen sc1
  s_waitcnt lgkmcnt(0)
  v_add_f32 v36, v36, v40
  v_add_f32 v37, v37, v41
  v_add_f32 v38, v38, v42
  v_add_f32 v39, v39, v43
  v_add_f32 v44, v44, v48
  v_add_f32 v45, v45, v49
  v_add_f32 v46, v46, v50
  v_add_f32 v47, v47, v51
  v_add_f32 v36, v36, v44
  v_add_f32 v37, v37, v45
  v_add_f32 v38, v38, v46
  v_add_f32 v39, v39, v47
  v_lshlrev_b32 v20, 16, v20
  v_lshlrev_b32 v21, 16, v21
  v_lshlrev_b32 v22, 16, v22
  v_lshlrev_b32 v23, 16, v23
  v_mul_f32 v20, v20, v32
  v_mul_f32 v21, v21, v33
  v_mul_f32 v22, v22, v34
  v_mul_f32 v23, v23, v35
  v_fma_f32 v20, v36, v28, v20
  v_fma_f32 v21, v37, v29, v21
  v_fma_f32 v22, v38, v30, v22
  v_fma_f32 v23, v39, v31, v23
  s_barrier
  ds_read_b128 v[80:83], v8 offset:0
  ds_read_b128 v[84:87], v8 offset:8192
  ds_read_b128 v[88:91], v8 offset:16384
  ds_read_b128 v[92:95], v8 offset:24576
  s_waitcnt lgkmcnt(2)
  v_add_f32 v80, v80, v84
  v_add_f32 v81, v81, v85
  v_add_f32 v82, v82, v86
  v_add_f32 v83, v83, v87
  s_waitcnt lgkmcnt(0)
  v_add_f32 v88, v88, v92
  v_add_f32 v89, v89, v93
  v_add_f32 v90, v90, v94
  v_add_f32 v91, v91, v95
  v_add_f32 v80, v80, v88
  v_add_f32 v81, v81, v89
  v_add_f32 v82, v82, v90
  v_add_f32 v83, v83, v91
  v_fma_f32 v80, v80, v28, v20
  v_fma_f32 v81, v81, v29, v21
  v_fma_f32 v82, v82, v30, v22
  v_fma_f32 v83, v83, v31, v23
  v_cvt_pk_bf16_f32 v84, v80, v81
  v_cvt_pk_bf16_f32 v85, v82, v83
  buffer_store_dwordx2 v[84:85], v14, s[20:23], s40 offen sc1
  s_endpgm
MC_GS:
  s_mov_b32 s43, 6
MC_GL:
  s_mov_b32 s8, 0
  s_cmp_eq_u32 s43, 0
  s_cbranch_scc1 MC_GT
  s_sub_u32 s43, s43, 1
  s_sleep 4
  v_lshrrev_b32 v80, 2, v6
  buffer_load_dword v80, v80, s[20:23], 0 offen offset:128 sc1
  s_waitcnt vmcnt(0)
  v_readlane_b32 s8, v80, 0
  v_readlane_b32 s9, v80, 1
  v_readlane_b32 s10, v80, 2
  v_readlane_b32 s11, v80, 3
  v_readlane_b32 s24, v80, 4
  v_readlane_b32 s25, v80, 5
  v_readlane_b32 s26, v80, 6
  v_readlane_b32 s27, v80, 7
  s_sub_u32 s8, s8, s42
  s_sub_u32 s9, s9, s42
  s_sub_u32 s10, s10, s42
  s_sub_u32 s11, s11, s42
  s_sub_u32 s24, s24, s42
  s_sub_u32 s25, s25, s42
  s_sub_u32 s26, s26, s42
  s_sub_u32 s27, s27, s42
  s_max_u32 s8, s8, s9
  s_max_u32 s10, s10, s11
  s_max_u32 s24, s24, s25
  s_max_u32 s26, s26, s27
  s_max_u32 s8, s8, s10
  s_max_u32 s24, s24, s26
  s_max_u32 s8, s8, s24
  s_cmp_gt_u32 s8, 3200
  s_cbranch_scc1 MC_GL
  s_branch MC_GT
MC_GW:
  s_memrealtime s[70:71]
  s_waitcnt lgkmcnt(0)
  s_lshl_b32 s70, s70, 1
  s_sub_u32 s70, s70, s8
  s_cmp_lt_i32 s70, 560
  s_cbranch_scc1 MC_GW
  s_branch MC_GR
MC_SLOW0:
  s_cmp_eq_u32 s31, 0
  s_cbranch_scc1 MC_RET0
  s_sub_u32 s31, s31, 1
  s_sleep 1
MC_RS:
  s_cmp_eq_u32 s31, 0
  s_cbranch_scc1 MC_RSX
  s_sub_u32 s31, s31, 1
  s_and_b32 s70, s31, 14
  s_cbranch_scc1 MC_WF0
  s_mov_b64 vcc, exec
  s_mov_b64 exec, 1
  global_load_dword v64, v6, s[64:65] offset:64 sc1
  s_not_b32 s70, s69
  s_waitcnt vmcnt(0)
  v_readfirstlane_b32 s69, v64
  s_nop 0
  s_cmp_ge_u32 s69, s70
  s_cbranch_scc1 MC_WF0B
  v_mov_b32 v64, s70
  global_atomic_umax v6, v64, s[64:65] offset:64 sc1
  s_mov_b32 s69, s70
MC_WF0B:
  s_not_b32 s69, s69
  s_mov_b64 exec, vcc
MC_WF0:
  s_memrealtime vcc
  buffer_load_dwordx4 v[88:91], v6, s[16:19], s47 offen offset:0 sc1
  buffer_load_dwordx4 v[92:95], v6, s[16:19], s47 offen offset:1024 sc1
  s_waitcnt vmcnt(0)
  s_waitcnt lgkmcnt(0)
  s_lshr_b64 vcc, vcc, 8
  s_sub_u32 s70, vcc_lo, s69
  s_add_u32 s70, s70, 1
  v_subrev_u32 v64, s69, v89
  v_subrev_u32 v65, s69, v91
  v_subrev_u32 v66, s69, v93
  v_subrev_u32 v67, s69, v95
  v_max3_u32 v64, v64, v65, v66
  v_max_u32 v64, v64, v67
  v_cmp_lt_u32 vcc, s70, v64
  s_cbranch_vccnz MC_RS
MC_RSX:
  buffer_load_dwordx4 v[80:83], v6, s[16:19], s34 offen offset:0 sc1
  buffer_load_dwordx4 v[84:87], v6, s[16:19], s34 offen offset:1024 sc1
  s_waitcnt vmcnt(0)
  v_subrev_u32 v64, s69, v81
  v_subrev_u32 v65, s69, v83
  v_subrev_u32 v66, s69, v85
  v_subrev_u32 v67, s69, v87
  v_subrev_u32 v68, s69, v89
  v_subrev_u32 v69, s69, v91
  v_subrev_u32 v70, s69, v93
  v_subrev_u32 v71, s69, v95
  v_max3_u32 v64, v64, v65, v66
  v_max3_u32 v67, v67, v68, v69
  v_max_u32 v70, v70, v71
  v_max3_u32 v64, v64, v67, v70
  v_cmp_lt_u32 vcc, s70, v64
  s_cbranch_vccnz MC_SLOW0
  s_branch MC_RET0
MC_SLOW1:
  s_cmp_eq_u32 s31, 0
  s_cbranch_scc1 MC_RET1
  s_sub_u32 s31, s31, 1
  s_sleep 4
  s_and_b32 s70, s31, 14
  s_cbranch_scc1 MC_WF1
  s_mov_b64 vcc, exec
  s_mov_b64 exec, 1
  global_load_dword v97, v6, s[64:65] offset:64 sc1
  s_not_b32 s70, s69
  s_waitcnt vmcnt(0)
  v_readfirstlane_b32 s69, v97
  s_nop 0
  s_cmp_ge_u32 s69, s70
  s_cbranch_scc1 MC_WF1B
  v_mov_b32 v97, s70
  global_atomic_umax v6, v97, s[64:65] offset:64 sc1
  s_mov_b32 s69, s70
MC_WF1B:
  s_not_b32 s69, s69
  s_mov_b64 exec, vcc
MC_WF1:
  s_memrealtime vcc
  buffer_load_dwordx4 v[96:99], v7, s[16:19], s39 offen sc1
  s_waitcnt vmcnt(0)
  s_waitcnt lgkmcnt(0)
  s_lshr_b64 vcc, vcc, 8
  s_sub_u32 s70, vcc_lo, s69
  s_add_u32 s70, s70, 1
  v_subrev_u32 v97, s69, v97
  v_subrev_u32 v99, s69, v99
  v_max_u32 v97, v97, v99
  v_cmp_lt_u32 vcc, s70, v97
  s_cbranch_vccnz MC_SLOW1
  s_branch MC_RET1
MC_SLOW2:
  s_cmp_eq_u32 s31, 0
  s_cbranch_scc1 MC_RET2
  s_sub_u32 s31, s31, 1
  s_sleep 2
  s_bfe_u32 s25, s60, 0x4000c
  s_lshl_b32 s25, s25, 12
  s_add_u32 s25, s25, s44
  buffer_load_dwordx4 v[80:83], v6, s[16:19], s25 offen offset:2048 sc1
  buffer_load_dwordx4 v[84:87], v6, s[16:19], s25 offen offset:3072 sc1
  s_waitcnt vmcnt(0)
  v_max_u32 v60, v80, v84
  v_cmp_eq_u32 vcc, -1, v60
  s_cbranch_vccnz MC_SLOW2
  s_branch MC_RET2
MC_SLOW3:
  s_cmp_eq_u32 s31, 0
  s_cbranch_scc1 MC_RET3
  s_sub_u32 s31, s31, 1
  s_sleep 2
  s_bfe_u32 s25, s60, 0x40010
  s_lshl_b32 s25, s25, 12
  s_add_u32 s25, s25, s44
  buffer_load_dwordx4 v[88:91], v6, s[16:19], s25 offen offset:0 sc1
  buffer_load_dwordx4 v[92:95], v6, s[16:19], s25 offen offset:1024 sc1
  s_waitcnt vmcnt(0)
  v_max_u32 v60, v88, v92
  v_cmp_eq_u32 vcc, -1, v60
  s_cbranch_vccnz MC_SLOW3
  s_branch MC_RET3
MC_SLOW4:
  s_cmp_eq_u32 s31, 0
  s_cbranch_scc1 MC_RET4
  s_sub_u32 s31, s31, 1
  s_sleep 2
  s_bfe_u32 s25, s60, 0x40010
  s_lshl_b32 s25, s25, 12
  s_add_u32 s25, s25, s44
  buffer_load_dwordx4 v[96:99], v6, s[16:19], s25 offen offset:2048 sc1
  buffer_load_dwordx4 v[100:103], v6, s[16:19], s25 offen offset:3072 sc1
  s_waitcnt vmcnt(0)
  v_max_u32 v60, v96, v100
  v_cmp_eq_u32 vcc, -1, v60
  s_cbranch_vccnz MC_SLOW4
  s_branch MC_RET4
MC_SLOW5:
  s_cmp_eq_u32 s31, 0
  s_cbranch_scc1 MC_RET5
  s_sub_u32 s31, s31, 1
  s_sleep 2
  s_bfe_u32 s25, s60, 0x40014
  s_lshl_b32 s25, s25, 12
  s_add_u32 s25, s25, s44
  buffer_load_dwordx4 v[104:107], v6, s[16:19], s25 offen offset:0 sc1
  buffer_load_dwordx4 v[108:111], v6, s[16:19], s25 offen offset:1024 sc1
  s_waitcnt vmcnt(0)
  v_max_u32 v60, v104, v108
  v_cmp_eq_u32 vcc, -1, v60
  s_cbranch_vccnz MC_SLOW5
  s_branch MC_RET5
MC_SLOW6:
  s_cmp_eq_u32 s31, 0
  s_cbranch_scc1 MC_RET6
  s_sub_u32 s31, s31, 1
  s_sleep 2
  s_bfe_u32 s25, s60, 0x40014
  s_lshl_b32 s25, s25, 12
  s_add_u32 s25, s25, s44
  buffer_load_dwordx4 a[112:115], v6, s[16:19], s25 offen offset:2048 sc1
  buffer_load_dwordx4 a[116:119], v6, s[16:19], s25 offen offset:3072 sc1
  s_waitcnt vmcnt(0)
  v_accvgpr_read_b32 v60, a112
  v_accvgpr_read_b32 v61, a116
  v_max_u32 v60, v60, v61
  v_cmp_eq_u32 vcc, -1, v60
  s_cbranch_vccnz MC_SLOW6
  s_branch MC_RET6
MC_SLOW7:
  s_cmp_eq_u32 s31, 0
  s_cbranch_scc1 MC_RET7
  s_sub_u32 s31, s31, 1
  s_sleep 2
  s_bfe_u32 s25, s60, 0x40018
  s_lshl_b32 s25, s25, 12
  s_add_u32 s25, s25, s44
  buffer_load_dwordx4 v[64:67], v6, s[16:19], s25 offen offset:0 sc1
  buffer_load_dwordx4 v[68:71], v6, s[16:19], s25 offen offset:1024 sc1
  s_waitcnt vmcnt(0)
  v_max_u32 v60, v64, v68
  v_cmp_eq_u32 vcc, -1, v60
  s_cbranch_vccnz MC_SLOW7
  s_branch MC_RET7
MC_SLOW8:
  s_cmp_eq_u32 s31, 0
  s_cbranch_scc1 MC_RET8
  s_sub_u32 s31, s31, 1
  s_sleep 2
  s_bfe_u32 s25, s60, 0x40018
  s_lshl_b32 s25, s25, 12
  s_add_u32 s25, s25, s44
  buffer_load_dwordx4 v[72:75], v6, s[16:19], s25 offen offset:2048 sc1
  buffer_load_dwordx4 v[76:79], v6, s[16:19], s25 offen offset:3072 sc1
  s_waitcnt vmcnt(0)
  v_max_u32 v60, v72, v76
  v_cmp_eq_u32 vcc, -1, v60
  s_cbranch_vccnz MC_SLOW8
  s_branch MC_RET8
MC_SLOW9:
  s_cmp_eq_u32 s31, 0
  s_cbranch_scc1 MC_RET9
  s_sub_u32 s31, s31, 1
  s_sleep 2
  s_bfe_u32 s25, s60, 0x4000c
  s_lshl_b32 s25, s25, 12
  s_add_u32 s25, s25, s45
  buffer_load_dwordx4 a[120:123], v6, s[16:19], s25 offen offset:2048 sc1
  buffer_load_dwordx4 a[124:127], v6, s[16:19], s25 offen offset:3072 sc1
  s_waitcnt vmcnt(0)
  v_accvgpr_read_b32 v60, a120
  v_accvgpr_read_b32 v61, a124
  v_max_u32 v60, v60, v61
  v_cmp_eq_u32 vcc, -1, v60
  s_cbranch_vccnz MC_SLOW9
  s_branch MC_RET9
MC_SLOW10:
  s_cmp_eq_u32 s31, 0
  s_cbranch_scc1 MC_RET10
  s_sub_u32 s31, s31, 1
  s_sleep 2
  s_bfe_u32 s25, s60, 0x40010
  s_lshl_b32 s25, s25, 12
  s_add_u32 s25, s25, s45
  buffer_load_dwordx4 v[20:23], v6, s[16:19], s25 offen offset:0 sc1
  buffer_load_dwordx4 v[24:27], v6, s[16:19], s25 offen offset:1024 sc1
  s_waitcnt vmcnt(0)
  v_max_u32 v60, v20, v24
  v_cmp_eq_u32 vcc, -1, v60
  s_cbranch_vccnz MC_SLOW10
  s_branch MC_RET10
MC_SLOW11:
  s_cmp_eq_u32 s31, 0
  s_cbranch_scc1 MC_RET11
  s_sub_u32 s31, s31, 1
  s_sleep 2
  s_bfe_u32 s25, s60, 0x40010
  s_lshl_b32 s25, s25, 12
  s_add_u32 s25, s25, s45
  buffer_load_dwordx4 v[80:83], v6, s[16:19], s25 offen offset:2048 sc1
  buffer_load_dwordx4 v[84:87], v6, s[16:19], s25 offen offset:3072 sc1
  s_waitcnt vmcnt(0)
  v_max_u32 v60, v80, v84
  v_cmp_eq_u32 vcc, -1, v60
  s_cbranch_vccnz MC_SLOW11
  s_branch MC_RET11
MC_SLOW12:
  s_cmp_eq_u32 s31, 0
  s_cbranch_scc1 MC_RET12
  s_sub_u32 s31, s31, 1
  s_sleep 2
  s_bfe_u32 s25, s60, 0x40014
  s_lshl_b32 s25, s25, 12
  s_add_u32 s25, s25, s45
  buffer_load_dwordx4 v[88:91], v6, s[16:19], s25 offen offset:0 sc1
  buffer_load_dwordx4 v[92:95], v6, s[16:19], s25 offen offset:1024 sc1
  s_waitcnt vmcnt(0)
  v_max_u32 v60, v88, v92
  v_cmp_eq_u32 vcc, -1, v60
  s_cbranch_vccnz MC_SLOW12
  s_branch MC_RET12
MC_SLOW13:
  s_cmp_eq_u32 s31, 0
  s_cbranch_scc1 MC_RET13
  s_sub_u32 s31, s31, 1
  s_sleep 2
  s_bfe_u32 s25, s60, 0x40014
  s_lshl_b32 s25, s25, 12
  s_add_u32 s25, s25, s45
  buffer_load_dwordx4 v[96:99], v6, s[16:19], s25 offen offset:2048 sc1
  buffer_load_dwordx4 v[100:103], v6, s[16:19], s25 offen offset:3072 sc1
  s_waitcnt vmcnt(0)
  v_max_u32 v60, v96, v100
  v_cmp_eq_u32 vcc, -1, v60
  s_cbranch_vccnz MC_SLOW13
  s_branch MC_RET13
MC_SLOW14:
  s_cmp_eq_u32 s31, 0
  s_cbranch_scc1 MC_RET14
  s_sub_u32 s31, s31, 1
  s_sleep 2
  s_bfe_u32 s25, s60, 0x40018
  s_lshl_b32 s25, s25, 12
  s_add_u32 s25, s25, s45
  buffer_load_dwordx4 v[104:107], v6, s[16:19], s25 offen offset:0 sc1
  buffer_load_dwordx4 v[108:111], v6, s[16:19], s25 offen offset:1024 sc1
  s_waitcnt vmcnt(0)
  v_max_u32 v60, v104, v108
  v_cmp_eq_u32 vcc, -1, v60
  s_cbranch_vccnz MC_SLOW14
  s_branch MC_RET14
MC_SLOW15:
  s_cmp_eq_u32 s31, 0
  s_cbranch_scc1 MC_RET15
  s_sub_u32 s31, s31, 1
  s_sleep 2
  s_bfe_u32 s25, s60, 0x40018
  s_lshl_b32 s25, s25, 12
  s_add_u32 s25, s25, s45
  buffer_load_dwordx4 a[112:115], v6, s[16:19], s25 offen offset:2048 sc1
  buffer_load_dwordx4 a[116:119], v6, s[16:19], s25 offen offset:3072 sc1
  s_waitcnt vmcnt(0)
  v_accvgpr_read_b32 v60, a112
  v_accvgpr_read_b32 v61, a116
  v_max_u32 v60, v60, v61
  v_cmp_eq_u32 vcc, -1, v60
  s_cbranch_vccnz MC_SLOW15
  s_branch MC_RET15
MH_GS:
  s_mov_b32 s43, 6
MH_GL:
  s_mov_b32 s8, 0
  s_cmp_eq_u32 s43, 0
  s_cbranch_scc1 MH_GT
  s_sub_u32 s43, s43, 1
  s_sleep 4
  v_lshrrev_b32 v80, 2, v6
  buffer_load_dword v80, v80, s[20:23], 0 offen offset:128 sc1
  s_waitcnt vmcnt(0)
  v_readlane_b32 s8, v80, 0
  v_readlane_b32 s9, v80, 1
  v_readlane_b32 s10, v80, 2
  v_readlane_b32 s11, v80, 3
  v_readlane_b32 s24, v80, 4
  v_readlane_b32 s25, v80, 5
  v_readlane_b32 s26, v80, 6
  v_readlane_b32 s27, v80, 7
  s_sub_u32 s8, s8, s42
  s_sub_u32 s9, s9, s42
  s_sub_u32 s10, s10, s42
  s_sub_u32 s11, s11, s42
  s_sub_u32 s24, s24, s42
  s_sub_u32 s25, s25, s42
  s_sub_u32 s26, s26, s42
  s_sub_u32 s27, s27, s42
  s_max_u32 s8, s8, s9
  s_max_u32 s10, s10, s11
  s_max_u32 s24, s24, s25
  s_max_u32 s26, s26, s27
  s_max_u32 s8, s8, s10
  s_max_u32 s24, s24, s26
  s_max_u32 s8, s8, s24
  s_cmp_gt_u32 s8, 3200
  s_cbranch_scc1 MH_GL
  s_branch MH_GT
MH_GW:
  s_memrealtime s[70:71]
  s_waitcnt lgkmcnt(0)
  s_lshl_b32 s70, s70, 1
  s_sub_u32 s70, s70, s8
  s_cmp_lt_i32 s70, 560
  s_cbranch_scc1 MH_GW
  s_branch MH_GR
MH_SLOW0:
  s_cmp_eq_u32 s31, 0
  s_cbranch_scc1 MH_RET0
  s_sub_u32 s31, s31, 1
  s_sleep 1
MH_RS:
  s_cmp_eq_u32 s31, 0
  s_cbranch_scc1 MH_RSX
  s_sub_u32 s31, s31, 1
  s_and_b32 s70, s31, 14
  s_cbranch_scc1 MH_WF0
  s_mov_b64 vcc, exec
  s_mov_b64 exec, 1
  global_load_dword v64, v6, s[64:65] offset:64 sc1
  s_not_b32 s70, s69
  s_waitcnt vmcnt(0)
  v_readfirstlane_b32 s69, v64
  s_nop 0
  s_cmp_ge_u32 s69, s70
  s_cbranch_scc1 MH_WF0B
  v_mov_b32 v64, s70
  global_atomic_umax v6, v64, s[64:65] offset:64 sc1
  s_mov_b32 s69, s70
MH_WF0B:
  s_not_b32 s69, s69
  s_mov_b64 exec, vcc
MH_WF0:
  s_memrealtime vcc
  buffer_load_dwordx4 v[88:91], v6, s[16:19], s47 offen offset:0 sc1
  buffer_load_dwordx4 v[92:95], v6, s[16:19], s47 offen offset:1024 sc1
  s_waitcnt vmcnt(0)
  s_waitcnt lgkmcnt(0)
  s_lshr_b64 vcc, vcc, 8
  s_sub_u32 s70, vcc_lo, s69
  s_add_u32 s70, s70, 1
  v_subrev_u32 v64, s69, v89
  v_subrev_u32 v65, s69, v91
  v_subrev_u32 v66, s69, v93
  v_subrev_u32 v67, s69, v95
  v_max3_u32 v64, v64, v65, v66
  v_max_u32 v64, v64, v67
  v_cmp_lt_u32 vcc, s70, v64
  s_cbranch_vccnz MH_RS
MH_RSX:
  buffer_load_dwordx4 v[80:83], v6, s[16:19], s34 offen offset:0 sc1
  buffer_load_dwordx4 v[84:87], v6, s[16:19], s34 offen offset:1024 sc1
  s_waitcnt vmcnt(0)
  v_subrev_u32 v64, s69, v81
  v_subrev_u32 v65, s69, v83
  v_subrev_u32 v66, s69, v85
  v_subrev_u32 v67, s69, v87
  v_subrev_u32 v68, s69, v89
  v_subrev_u32 v69, s69, v91
  v_subrev_u32 v70, s69, v93
  v_subrev_u32 v71, s69, v95
  v_max3_u32 v64, v64, v65, v66
  v_max3_u32 v67, v67, v68, v69
  v_max_u32 v70, v70, v71
  v_max3_u32 v64, v64, v67, v70
  v_cmp_lt_u32 vcc, s70, v64
  s_cbranch_vccnz MH_SLOW0
  s_branch MH_RET0
MH_SLOW1:
  s_cmp_eq_u32 s31, 0
  s_cbranch_scc1 MH_RET1
  s_sub_u32 s31, s31, 1
  s_sleep 4
  s_and_b32 s70, s31, 14
  s_cbranch_scc1 MH_WF1
  s_mov_b64 vcc, exec
  s_mov_b64 exec, 1
  global_load_dword v97, v6, s[64:65] offset:64 sc1
  s_not_b32 s70, s69
  s_waitcnt vmcnt(0)
  v_readfirstlane_b32 s69, v97
  s_nop 0
  s_cmp_ge_u32 s69, s70
  s_cbranch_scc1 MH_WF1B
  v_mov_b32 v97, s70
  global_atomic_umax v6, v97, s[64:65] offset:64 sc1
  s_mov_b32 s69, s70
MH_WF1B:
  s_not_b32 s69, s69
  s_mov_b64 exec, vcc
MH_WF1:
  s_memrealtime vcc
  buffer_load_dwordx4 v[96:99], v7, s[16:19], s39 offen sc1
  s_waitcnt vmcnt(0)
  s_waitcnt lgkmcnt(0)
  s_lshr_b64 vcc, vcc, 8
  s_sub_u32 s70, vcc_lo, s69
  s_add_u32 s70, s70, 1
  v_subrev_u32 v97, s69, v97
  v_subrev_u32 v99, s69, v99
  v_max_u32 v97, v97, v99
  v_cmp_lt_u32 vcc, s70, v97
  s_cbranch_vccnz MH_SLOW1
  s_branch MH_RET1
MH_SLOW2:
  s_cmp_eq_u32 s31, 0
  s_cbranch_scc1 MH_RET2
  s_sub_u32 s31, s31, 1
  s_sleep 2
  s_and_b32 s70, s31, 14
  s_cbranch_scc1 MH_WF2
  s_mov_b64 vcc, exec
  s_mov_b64 exec, 1
  global_load_dword v109, v6, s[64:65] offset:64 sc1
  s_not_b32 s70, s69
  s_waitcnt vmcnt(0)
  v_readfirstlane_b32 s69, v109
  s_nop 0
  s_cmp_ge_u32 s69, s70
  s_cbranch_scc1 MH_WF2B
  v_mov_b32 v109, s70
  global_atomic_umax v6, v109, s[64:65] offset:64 sc1
  s_mov_b32 s69, s70
MH_WF2B:
  s_not_b32 s69, s69
  s_mov_b64 exec, vcc
MH_WF2:
  s_memrealtime vcc
  buffer_load_dwordx4 v[108:111], v7, s[16:19], s39 offen sc1
  s_waitcnt vmcnt(0)
  s_waitcnt lgkmcnt(0)
  s_lshr_b64 vcc, vcc, 8
  s_sub_u32 s70, vcc_lo, s69
  s_add_u32 s70, s70, 1
  v_subrev_u32 v109, s69, v109
  v_subrev_u32 v111, s69, v111
  v_max_u32 v109, v109, v111
  v_cmp_lt_u32 vcc, s70, v109
  s_cbranch_vccnz MH_SLOW2
  s_branch MH_RET2
MH_SLOW3:
  s_cmp_eq_u32 s31, 0
  s_cbranch_scc1 MH_RET3
  s_sub_u32 s31, s31, 1
  s_sleep 1
  s_and_b32 s70, s31, 14
  s_cbranch_scc1 MH_WF3
  s_mov_b64 vcc, exec
  s_mov_b64 exec, 1
  global_load_dword v29, v6, s[64:65] offset:64 sc1
  s_not_b32 s70, s69
  s_waitcnt vmcnt(0)
  v_readfirstlane_b32 s69, v29
  s_nop 0
  s_cmp_ge_u32 s69, s70
  s_cbranch_scc1 MH_WF3B
  v_mov_b32 v29, s70
  global_atomic_umax v6, v29, s[64:65] offset:64 sc1
  s_mov_b32 s69, s70
MH_WF3B:
  s_not_b32 s69, s69
  s_mov_b64 exec, vcc
MH_WF3:
  s_memrealtime vcc
  buffer_load_dword v29, v28, s[16:19], 0 offen sc1
  s_waitcnt vmcnt(0)
  s_waitcnt lgkmcnt(0)
  s_lshr_b64 vcc, vcc, 8
  s_sub_u32 s70, vcc_lo, s69
  s_add_u32 s70, s70, 1
  v_subrev_u32 v29, s69, v29
  v_cmp_lt_u32 vcc, s70, v29
  s_cbranch_vccnz MH_SLOW3
  s_branch MH_RET3
MH_SLOW4:
  s_cmp_eq_u32 s31, 0
  s_cbranch_scc1 MH_RET4
  s_sub_u32 s31, s31, 1
  s_sleep 2
  s_and_b32 s70, s31, 14
  s_cbranch_scc1 MH_WF4
  s_mov_b64 vcc, exec
  s_mov_b64 exec, 1
  global_load_dword v41, v6, s[64:65] offset:64 sc1
  s_not_b32 s70, s69
  s_waitcnt vmcnt(0)
  v_readfirstlane_b32 s69, v41
  s_nop 0
  s_cmp_ge_u32 s69, s70
  s_cbranch_scc1 MH_WF4B
  v_mov_b32 v41, s70
  global_atomic_umax v6, v41, s[64:65] offset:64 sc1
  s_mov_b32 s69, s70
MH_WF4B:
  s_not_b32 s69, s69
  s_mov_b64 exec, vcc
MH_WF4:
  s_memrealtime vcc
  buffer_load_dwordx4 v[40:43], v36, s[16:19], s46 offen offset:0 sc1
  buffer_load_dwordx4 v[44:47], v36, s[16:19], s46 offen offset:16 sc1
  buffer_load_dwordx4 v[48:51], v36, s[16:19], s47 offen offset:0 sc1
  buffer_load_dwordx4 v[52:55], v36, s[16:19], s47 offen offset:16 sc1
  s_waitcnt vmcnt(0)
  s_waitcnt lgkmcnt(0)
  s_lshr_b64 vcc, vcc, 8
  s_sub_u32 s70, vcc_lo, s69
  s_add_u32 s70, s70, 1
  v_subrev_u32 v41, s69, v41
  v_subrev_u32 v43, s69, v43
  v_subrev_u32 v45, s69, v45
  v_subrev_u32 v47, s69, v47
  v_subrev_u32 v49, s69, v49
  v_subrev_u32 v51, s69, v51
  v_subrev_u32 v53, s69, v53
  v_subrev_u32 v55, s69, v55
  v_max3_u32 v41, v41, v43, v45
  v_max3_u32 v47, v47, v49, v51
  v_max_u32 v53, v53, v55
  v_max3_u32 v41, v41, v47, v53
  v_cmp_lt_u32 vcc, s70, v41
  s_cbranch_vccnz MH_SLOW4
  s_branch MH_RET4
MH_SLOW5:
  s_cmp_eq_u32 s31, 0
  s_cbranch_scc1 MH_RET5
  s_sub_u32 s31, s31, 1
  s_sleep 4
  s_mul_i32 s26, s50, 28928
  s_add_u32 s26, s26, s35
  s_add_u32 m0, s38, 87040
  s_add_u32 s25, s26, 0
  buffer_load_dwordx4 v6, s[16:19], s25 offen sc1 lds
  s_add_u32 m0, s38, 91136
  s_add_u32 s25, s26, 4096
  buffer_load_dwordx4 v6, s[16:19], s25 offen sc1 lds
  s_add_u32 m0, s38, 95232
  s_add_u32 s25, s26, 8192
  buffer_load_dwordx4 v6, s[16:19], s25 offen sc1 lds
  s_add_u32 m0, s38, 99328
  s_add_u32 s25, s26, 12288
  buffer_load_dwordx4 v6, s[16:19], s25 offen sc1 lds
  s_add_u32 m0, s38, 103424
  s_add_u32 s25, s26, 16384
  buffer_load_dwordx4 v6, s[16:19], s25 offen sc1 lds
  s_add_u32 m0, s38, 107520
  s_add_u32 s25, s26, 20480
  buffer_load_dwordx4 v6, s[16:19], s25 offen sc1 lds
  s_add_u32 m0, s38, 111616
  s_add_u32 s25, s26, 24576
  buffer_load_dwordx4 v6, s[16:19], s25 offen sc1 lds
  s_waitcnt vmcnt(0)
  ds_read_b32 v88, v17 offset:21504
  ds_read_b32 v89, v17 offset:25600
  ds_read_b32 v90, v17 offset:29696
  ds_read_b32 v91, v17 offset:33792
  ds_read_b32 v92, v17 offset:37888
  ds_read_b32 v93, v17 offset:41984
  ds_read_b32 v94, v17 offset:46080
  s_waitcnt lgkmcnt(0)
  v_max3_u32 v88, v88, v89, v90
  v_max3_u32 v91, v91, v92, v93
  v_max3_u32 v88, v88, v91, v94
  v_cmp_eq_u32 vcc, -1, v88
  s_cbranch_vccnz MH_SLOW5
  s_branch MH_RET5
MH_SLOW6:
  s_cmp_eq_u32 s31, 0
  s_cbranch_scc1 MH_RET6
  s_sub_u32 s31, s31, 1
  s_sleep 4
  s_and_b32 s70, s31, 14
  s_cbranch_scc1 MH_WF5
  s_mov_b64 vcc, exec
  s_mov_b64 exec, 1
  global_load_dword v23, v6, s[64:65] offset:64 sc1
  s_not_b32 s70, s69
  s_waitcnt vmcnt(0)
  v_readfirstlane_b32 s69, v23
  s_nop 0
  s_cmp_ge_u32 s69, s70
  s_cbranch_scc1 MH_WF5B
  v_mov_b32 v23, s70
  global_atomic_umax v6, v23, s[64:65] offset:64 sc1
  s_mov_b32 s69, s70
MH_WF5B:
  s_not_b32 s69, s69
  s_mov_b64 exec, vcc
MH_WF5:
  s_memrealtime vcc
  buffer_load_dword v23, v19, s[16:19], s42 offen sc1
  s_waitcnt vmcnt(0)
  s_waitcnt lgkmcnt(0)
  s_lshr_b64 vcc, vcc, 8
  s_sub_u32 s70, vcc_lo, s69
  s_add_u32 s70, s70, 1
  v_subrev_u32 v23, s69, v23
  v_cmp_lt_u32 vcc, s70, v23
  s_cbranch_vccnz MH_SLOW6
  s_branch MH_RET6
MH_SLOW7:
  s_cmp_eq_u32 s31, 0
  s_cbranch_scc1 MH_RET7
  s_sub_u32 s31, s31, 1
  s_sleep 4
  s_mul_i32 s26, s51, 28928
  s_add_u32 s26, s26, s35
  s_add_u32 m0, s38, 115712
  s_add_u32 s25, s26, 0
  buffer_load_dwordx4 v6, s[16:19], s25 offen sc1 lds
  s_add_u32 m0, s38, 119808
  s_add_u32 s25, s26, 4096
  buffer_load_dwordx4 v6, s[16:19], s25 offen sc1 lds
  s_add_u32 m0, s38, 123904
  s_add_u32 s25, s26, 8192
  buffer_load_dwordx4 v6, s[16:19], s25 offen sc1 lds
  s_add_u32 m0, s38, 128000
  s_add_u32 s25, s26, 12288
  buffer_load_dwordx4 v6, s[16:19], s25 offen sc1 lds
  s_add_u32 m0, s38, 132096
  s_add_u32 s25, s26, 16384
  buffer_load_dwordx4 v6, s[16:19], s25 offen sc1 lds
  s_add_u32 m0, s38, 136192
  s_add_u32 s25, s26, 20480
  buffer_load_dwordx4 v6, s[16:19], s25 offen sc1 lds
  s_add_u32 m0, s38, 140288
  s_add_u32 s25, s26, 24576
  buffer_load_dwordx4 v6, s[16:19], s25 offen sc1 lds
  s_waitcnt vmcnt(0)
  ds_read_b32 v88, v17 offset:50176
  ds_read_b32 v89, v17 offset:54272
  ds_read_b32 v90, v17 offset:58368
  ds_read_b32 v91, v17 offset:62464
  ds_read_b32 v92, v20 offset:1024
  ds_read_b32 v93, v20 offset:5120
  ds_read_b32 v94, v20 offset:9216
  s_waitcnt lgkmcnt(0)
  v_max3_u32 v88, v88, v89, v90
  v_max3_u32 v91, v91, v92, v93
  v_max3_u32 v88, v88, v91, v94
  v_cmp_eq_u32 vcc, -1, v88
  s_cbranch_vccnz MH_SLOW7
  s_branch MH_RET7
MH_SLOW8:
  s_cmp_eq_u32 s31, 0
  s_cbranch_scc1 MH_RET8
  s_sub_u32 s31, s31, 1
  s_sleep 4
  s_mul_i32 s26, s52, 28928
  s_add_u32 s26, s26, s35
  s_add_u32 m0, s38, 3328
  s_add_u32 s25, s26, 0
  buffer_load_dwordx4 v6, s[16:19], s25 offen sc1 lds
  s_add_u32 m0, s38, 69632
  s_add_u32 s25, s26, 4096
  buffer_load_dwordx4 v6, s[16:19], s25 offen sc1 lds
  s_add_u32 m0, s38, 152576
  s_add_u32 s25, s26, 8192
  buffer_load_dwordx4 v6, s[16:19], s25 offen sc1 lds
  s_add_u32 m0, s38, 55680
  s_add_u32 s25, s26, 12288
  buffer_load_dwordx4 v6, s[16:19], s25 offen sc1 lds
  s_add_u32 m0, s38, 12096
  s_add_u32 s25, s26, 16384
  buffer_load_dwordx4 v6, s[16:19], s25 offen sc1 lds
  s_add_u32 m0, s38, 73728
  s_add_u32 s25, s26, 20480
  buffer_load_dwordx4 v6, s[16:19], s25 offen sc1 lds
  s_add_u32 m0, s38, 59840
  s_add_u32 s25, s26, 24576
  buffer_load_dwordx4 v6, s[16:19], s25 offen sc1 lds
  s_waitcnt vmcnt(0)
  ds_read_b32 v88, v16 offset:3328
  ds_read_b32 v89, v17 offset:4096
  ds_read_b32 v90, v20 offset:21504
  ds_read_b32 v91, v16 offset:55680
  ds_read_b32 v92, v16 offset:12096
  ds_read_b32 v93, v17 offset:8192
  ds_read_b32 v94, v16 offset:59840
  s_waitcnt lgkmcnt(0)
  v_max3_u32 v88, v88, v89, v90
  v_max3_u32 v91, v91, v92, v93
  v_max3_u32 v88, v88, v91, v94
  v_cmp_eq_u32 vcc, -1, v88
  s_cbranch_vccnz MH_SLOW8
  s_branch MH_RET8
MH_SLOW9:
  s_cmp_eq_u32 s31, 0
  s_cbranch_scc1 MH_RET9
  s_sub_u32 s31, s31, 1
  s_sleep 4
  s_mul_i32 s26, s53, 28928
  s_add_u32 s26, s26, s35
  s_add_u32 m0, s38, 16256
  s_add_u32 s25, s26, 0
  buffer_load_dwordx4 v6, s[16:19], s25 offen sc1 lds
  s_add_u32 m0, s38, 81920
  s_add_u32 s25, s26, 4096
  buffer_load_dwordx4 v6, s[16:19], s25 offen sc1 lds
  s_add_u32 m0, s38, 46912
  s_add_u32 s25, s26, 8192
  buffer_load_dwordx4 v6, s[16:19], s25 offen sc1 lds
  s_add_u32 m0, s38, 144384
  s_add_u32 s25, s26, 12288
  buffer_load_dwordx4 v6, s[16:19], s25 offen sc1 lds
  s_add_u32 m0, s38, 99328
  s_add_u32 s25, s26, 16384
  buffer_load_dwordx4 v6, s[16:19], s25 offen sc1 lds
  s_add_u32 m0, s38, 51072
  s_add_u32 s25, s26, 20480
  buffer_load_dwordx4 v6, s[16:19], s25 offen sc1 lds
  s_add_u32 m0, s38, 87040
  s_add_u32 s25, s26, 24576
  buffer_load_dwordx4 v6, s[16:19], s25 offen sc1 lds
  s_waitcnt vmcnt(0)
  ds_read_b32 v88, v16 offset:16256
  ds_read_b32 v89, v17 offset:16384
  ds_read_b32 v90, v16 offset:46912
  ds_read_b32 v91, v20 offset:13312
  ds_read_b32 v92, v17 offset:33792
  ds_read_b32 v93, v16 offset:51072
  ds_read_b32 v94, v17 offset:21504
  s_waitcnt lgkmcnt(0)
  v_max3_u32 v88, v88, v89, v90
  v_max3_u32 v91, v91, v92, v93
  v_max3_u32 v88, v88, v91, v94
  v_cmp_eq_u32 vcc, -1, v88
  s_cbranch_vccnz MH_SLOW9
  s_branch MH_RET9
MH_SLOW10:
  s_cmp_eq_u32 s31, 0
  s_cbranch_scc1 MH_RET10
  s_sub_u32 s31, s31, 1
  s_sleep 2
  s_and_b32 s70, s31, 14
  s_cbranch_scc1 MH_WF6
  s_mov_b64 vcc, exec
  s_mov_b64 exec, 1
  global_load_dword v61, v6, s[64:65] offset:64 sc1
  s_not_b32 s70, s69
  s_waitcnt vmcnt(0)
  v_readfirstlane_b32 s69, v61
  s_nop 0
  s_cmp_ge_u32 s69, s70
  s_cbranch_scc1 MH_WF6B
  v_mov_b32 v61, s70
  global_atomic_umax v6, v61, s[64:65] offset:64 sc1
  s_mov_b32 s69, s70
MH_WF6B:
  s_not_b32 s69, s69
  s_mov_b64 exec, vcc
MH_WF6:
  s_memrealtime vcc
  s_lshl_b32 s25, s50, 8
  s_add_u32 s25, s25, 73728
  buffer_load_dwordx4 v[60:63], v26, s[16:19], s25 offen sc1
  s_waitcnt vmcnt(0)
  s_waitcnt lgkmcnt(0)
  s_lshr_b64 vcc, vcc, 8
  s_sub_u32 s70, vcc_lo, s69
  s_add_u32 s70, s70, 1
  v_subrev_u32 v61, s69, v61
  v_subrev_u32 v63, s69, v63
  v_max_u32 v61, v61, v63
  v_cmp_lt_u32 vcc, s70, v61
  s_cbranch_vccnz MH_SLOW10
  s_branch MH_RET10
MH_SLOW11:
  s_cmp_eq_u32 s31, 0
  s_cbranch_scc1 MH_RET11
  s_sub_u32 s31, s31, 1
  s_sleep 4
  s_mul_i32 s26, s54, 28928
  s_add_u32 s26, s26, s35
  s_add_u32 m0, s38, 156672
  s_add_u32 s25, s26, 0
  buffer_load_dwordx4 v6, s[16:19], s25 offen sc1 lds
  s_add_u32 m0, s38, 29632
  s_add_u32 s25, s26, 4096
  buffer_load_dwordx4 v6, s[16:19], s25 offen sc1 lds
  s_add_u32 m0, s38, 77824
  s_add_u32 s25, s26, 8192
  buffer_load_dwordx4 v6, s[16:19], s25 offen sc1 lds
  s_add_u32 m0, s38, 91136
  s_add_u32 s25, s26, 12288
  buffer_load_dwordx4 v6, s[16:19], s25 offen sc1 lds
  s_add_u32 m0, s38, 7488
  s_add_u32 s25, s26, 16384
  buffer_load_dwordx4 v6, s[16:19], s25 offen sc1 lds
  s_add_u32 m0, s38, 132096
  s_add_u32 s25, s26, 20480
  buffer_load_dwordx4 v6, s[16:19], s25 offen sc1 lds
  s_add_u32 m0, s38, 128000
  s_add_u32 s25, s26, 24576
  buffer_load_dwordx4 v6, s[16:19], s25 offen sc1 lds
  s_waitcnt vmcnt(0)
  ds_read_b32 v88, v20 offset:25600
  ds_read_b32 v89, v16 offset:29632
  ds_read_b32 v90, v17 offset:12288
  ds_read_b32 v91, v17 offset:25600
  ds_read_b32 v92, v16 offset:7488
  ds_read_b32 v93, v20 offset:1024
  ds_read_b32 v94, v17 offset:62464
  s_waitcnt lgkmcnt(0)
  v_max3_u32 v88, v88, v89, v90
  v_max3_u32 v91, v91, v92, v93
  v_max3_u32 v88, v88, v91, v94
  v_cmp_eq_u32 vcc, -1, v88
  s_cbranch_vccnz MH_SLOW11
  s_branch MH_RET11
MH_SLOW12:
  s_cmp_eq_u32 s31, 0
  s_cbranch_scc1 MH_RET12
  s_sub_u32 s31, s31, 1
  s_sleep 4
  s_mul_i32 s26, s55, 28928
  s_add_u32 s26, s26, s35
  s_add_u32 m0, s38, 33792
  s_add_u32 s25, s26, 0
  buffer_load_dwordx4 v6, s[16:19], s25 offen sc1 lds
  s_add_u32 m0, s38, 111616
  s_add_u32 s25, s26, 4096
  buffer_load_dwordx4 v6, s[16:19], s25 offen sc1 lds
  s_add_u32 m0, s38, 3328
  s_add_u32 s25, s26, 8192
  buffer_load_dwordx4 v6, s[16:19], s25 offen sc1 lds
  s_add_u32 m0, s38, 95232
  s_add_u32 s25, s26, 12288
  buffer_load_dwordx4 v6, s[16:19], s25 offen sc1 lds
  s_add_u32 m0, s38, 103424
  s_add_u32 s25, s26, 16384
  buffer_load_dwordx4 v6, s[16:19], s25 offen sc1 lds
  s_add_u32 m0, s38, 107520
  s_add_u32 s25, s26, 20480
  buffer_load_dwordx4 v6, s[16:19], s25 offen sc1 lds
  s_add_u32 m0, s38, 115712
  s_add_u32 s25, s26, 24576
  buffer_load_dwordx4 v6, s[16:19], s25 offen sc1 lds
  s_waitcnt vmcnt(0)
  ds_read_b32 v88, v16 offset:33792
  ds_read_b32 v89, v17 offset:46080
  ds_read_b32 v90, v16 offset:3328
  ds_read_b32 v91, v17 offset:29696
  ds_read_b32 v92, v17 offset:37888
  ds_read_b32 v93, v17 offset:41984
  ds_read_b32 v94, v17 offset:50176
  s_waitcnt lgkmcnt(0)
  v_max3_u32 v88, v88, v89, v90
  v_max3_u32 v91, v91, v92, v93
  v_max3_u32 v88, v88, v91, v94
  v_cmp_eq_u32 vcc, -1, v88
  s_cbranch_vccnz MH_SLOW12
  s_branch MH_RET12
MH_SLOW13:
  s_cmp_eq_u32 s31, 0
  s_cbranch_scc1 MH_RET13
  s_sub_u32 s31, s31, 1
  s_sleep 2
  s_and_b32 s70, s31, 14
  s_cbranch_scc1 MH_WF7
  s_mov_b64 vcc, exec
  s_mov_b64 exec, 1
  global_load_dword v61, v6, s[64:65] offset:64 sc1
  s_not_b32 s70, s69
  s_waitcnt vmcnt(0)
  v_readfirstlane_b32 s69, v61
  s_nop 0
  s_cmp_ge_u32 s69, s70
  s_cbranch_scc1 MH_WF7B
  v_mov_b32 v61, s70
  global_atomic_umax v6, v61, s[64:65] offset:64 sc1
  s_mov_b32 s69, s70
MH_WF7B:
  s_not_b32 s69, s69
  s_mov_b64 exec, vcc
MH_WF7:
  s_memrealtime vcc
  s_mov_b32 s25, 73728
  buffer_load_dwordx4 v[60:63], v26, s[16:19], s25 offen sc1
  s_waitcnt vmcnt(0)
  s_waitcnt lgkmcnt(0)
  s_lshr_b64 vcc, vcc, 8
  s_sub_u32 s70, vcc_lo, s69
  s_add_u32 s70, s70, 1
  v_subrev_u32 v61, s69, v61
  v_subrev_u32 v63, s69, v63
  v_max_u32 v61, v61, v63
  v_cmp_lt_u32 vcc, s70, v61
  s_cbranch_vccnz MH_SLOW13
  s_branch MH_RET13
MH_SLOW14:
  s_cmp_eq_u32 s31, 0
  s_cbranch_scc1 MH_RET14
  s_sub_u32 s31, s31, 1
  s_sleep 4
  s_mul_i32 s26, s56, 28928
  s_add_u32 s26, s26, s35
  s_add_u32 m0, s38, 55680
  s_add_u32 s25, s26, 0
  buffer_load_dwordx4 v6, s[16:19], s25 offen sc1 lds
  s_add_u32 m0, s38, 148480
  s_add_u32 s25, s26, 4096
  buffer_load_dwordx4 v6, s[16:19], s25 offen sc1 lds
  s_add_u32 m0, s38, 25024
  s_add_u32 s25, s26, 8192
  buffer_load_dwordx4 v6, s[16:19], s25 offen sc1 lds
  s_add_u32 m0, s38, 99328
  s_add_u32 s25, s26, 12288
  buffer_load_dwordx4 v6, s[16:19], s25 offen sc1 lds
  s_add_u32 m0, s38, 73728
  s_add_u32 s25, s26, 16384
  buffer_load_dwordx4 v6, s[16:19], s25 offen sc1 lds
  s_add_u32 m0, s38, 20864
  s_add_u32 s25, s26, 20480
  buffer_load_dwordx4 v6, s[16:19], s25 offen sc1 lds
  s_add_u32 m0, s38, 69632
  s_add_u32 s25, s26, 24576
  buffer_load_dwordx4 v6, s[16:19], s25 offen sc1 lds
  s_waitcnt vmcnt(0)
  ds_read_b32 v88, v16 offset:55680
  ds_read_b32 v89, v20 offset:17408
  ds_read_b32 v90, v16 offset:25024
  ds_read_b32 v91, v17 offset:33792
  ds_read_b32 v92, v17 offset:8192
  ds_read_b32 v93, v16 offset:20864
  ds_read_b32 v94, v17 offset:4096
  s_waitcnt lgkmcnt(0)
  v_max3_u32 v88, v88, v89, v90
  v_max3_u32 v91, v91, v92, v93
  v_max3_u32 v88, v88, v91, v94
  v_cmp_eq_u32 vcc, -1, v88
  s_cbranch_vccnz MH_SLOW14
  s_branch MH_RET14
MH_SLOW15:
  s_cmp_eq_u32 s31, 0
  s_cbranch_scc1 MH_RET15
  s_sub_u32 s31, s31, 1
  s_sleep 4
  s_mul_i32 s26, s57, 28928
  s_add_u32 s26, s26, s35
  s_add_u32 m0, s38, 152576
  s_add_u32 s25, s26, 0
  buffer_load_dwordx4 v6, s[16:19], s25 offen sc1 lds
  s_add_u32 m0, s38, 156672
  s_add_u32 s25, s26, 4096
  buffer_load_dwordx4 v6, s[16:19], s25 offen sc1 lds
  s_add_u32 m0, s38, 77824
  s_add_u32 s25, s26, 8192
  buffer_load_dwordx4 v6, s[16:19], s25 offen sc1 lds
  s_add_u32 m0, s38, 132096
  s_add_u32 s25, s26, 12288
  buffer_load_dwordx4 v6, s[16:19], s25 offen sc1 lds
  s_add_u32 m0, s38, 87040
  s_add_u32 s25, s26, 16384
  buffer_load_dwordx4 v6, s[16:19], s25 offen sc1 lds
  s_add_u32 m0, s38, 46912
  s_add_u32 s25, s26, 20480
  buffer_load_dwordx4 v6, s[16:19], s25 offen sc1 lds
  s_add_u32 m0, s38, 42304
  s_add_u32 s25, s26, 24576
  buffer_load_dwordx4 v6, s[16:19], s25 offen sc1 lds
  s_waitcnt vmcnt(0)
  ds_read_b32 v88, v20 offset:21504
  ds_read_b32 v89, v20 offset:25600
  ds_read_b32 v90, v17 offset:12288
  ds_read_b32 v91, v20 offset:1024
  ds_read_b32 v92, v17 offset:21504
  ds_read_b32 v93, v16 offset:46912
  ds_read_b32 v94, v16 offset:42304
  s_waitcnt lgkmcnt(0)
  v_max3_u32 v88, v88, v89, v90
  v_max3_u32 v91, v91, v92, v93
  v_max3_u32 v88, v88, v91, v94
  v_cmp_eq_u32 vcc, -1, v88
  s_cbranch_vccnz MH_SLOW15
  s_branch MH_RET15
MH_SLOW16:
  s_cmp_eq_u32 s31, 0
  s_cbranch_scc1 MH_RET16
  s_sub_u32 s31, s31, 1
  s_sleep 2
  s_and_b32 s70, s31, 14
  s_cbranch_scc1 MH_WF8
  s_mov_b64 vcc, exec
  s_mov_b64 exec, 1
  global_load_dword v23, v6, s[64:65] offset:64 sc1
  s_not_b32 s70, s69
  s_waitcnt vmcnt(0)
  v_readfirstlane_b32 s69, v23
  s_nop 0
  s_cmp_ge_u32 s69, s70
  s_cbranch_scc1 MH_WF8B
  v_mov_b32 v23, s70
  global_atomic_umax v6, v23, s[64:65] offset:64 sc1
  s_mov_b32 s69, s70
MH_WF8B:
  s_not_b32 s69, s69
  s_mov_b64 exec, vcc
MH_WF8:
  s_memrealtime vcc
  buffer_load_dword v23, v19, s[16:19], s36 offen sc1
  s_waitcnt vmcnt(0)
  s_waitcnt lgkmcnt(0)
  s_lshr_b64 vcc, vcc, 8
  s_sub_u32 s70, vcc_lo, s69
  s_add_u32 s70, s70, 1
  v_subrev_u32 v23, s69, v23
  v_cmp_lt_u32 vcc, s70, v23
  s_cbranch_vccnz MH_SLOW16
  s_branch MH_RET16
MH_SLOW17:
  s_cmp_eq_u32 s31, 0
  s_cbranch_scc1 MH_RET17
  s_sub_u32 s31, s31, 1
  s_sleep 2
  s_bfe_u32 s25, s60, 0x40000
  s_lshl_b32 s25, s25, 12
  s_add_u32 s25, s25, s44
  buffer_load_dwordx4 v[28:31], v6, s[16:19], s25 offen offset:0 sc1
  buffer_load_dwordx4 v[32:35], v6, s[16:19], s25 offen offset:1024 sc1
  s_waitcnt vmcnt(0)
  v_max_u32 v60, v28, v32
  v_cmp_eq_u32 vcc, -1, v60
  s_cbranch_vccnz MH_SLOW17
  s_branch MH_RET17
MH_SLOW18:
  s_cmp_eq_u32 s31, 0
  s_cbranch_scc1 MH_RET18
  s_sub_u32 s31, s31, 1
  s_sleep 2
  s_bfe_u32 s25, s60, 0x40000
  s_lshl_b32 s25, s25, 12
  s_add_u32 s25, s25, s44
  buffer_load_dwordx4 v[36:39], v6, s[16:19], s25 offen offset:2048 sc1
  buffer_load_dwordx4 v[40:43], v6, s[16:19], s25 offen offset:3072 sc1
  s_waitcnt vmcnt(0)
  v_max_u32 v60, v36, v40
  v_cmp_eq_u32 vcc, -1, v60
  s_cbranch_vccnz MH_SLOW18
  s_branch MH_RET18
MH_SLOW19:
  s_cmp_eq_u32 s31, 0
  s_cbranch_scc1 MH_RET19
  s_sub_u32 s31, s31, 1
  s_sleep 2
  s_bfe_u32 s25, s60, 0x40004
  s_lshl_b32 s25, s25, 12
  s_add_u32 s25, s25, s44
  buffer_load_dwordx4 v[44:47], v6, s[16:19], s25 offen offset:0 sc1
  buffer_load_dwordx4 v[48:51], v6, s[16:19], s25 offen offset:1024 sc1
  s_waitcnt vmcnt(0)
  v_max_u32 v60, v44, v48
  v_cmp_eq_u32 vcc, -1, v60
  s_cbranch_vccnz MH_SLOW19
  s_branch MH_RET19
MH_SLOW20:
  s_cmp_eq_u32 s31, 0
  s_cbranch_scc1 MH_RET20
  s_sub_u32 s31, s31, 1
  s_sleep 2
  s_bfe_u32 s25, s60, 0x40004
  s_lshl_b32 s25, s25, 12
  s_add_u32 s25, s25, s44
  buffer_load_dwordx4 v[96:99], v6, s[16:19], s25 offen offset:2048 sc1
  buffer_load_dwordx4 v[100:103], v6, s[16:19], s25 offen offset:3072 sc1
  s_waitcnt vmcnt(0)
  v_max_u32 v60, v96, v100
  v_cmp_eq_u32 vcc, -1, v60
  s_cbranch_vccnz MH_SLOW20
  s_branch MH_RET20
MH_SLOW21:
  s_cmp_eq_u32 s31, 0
  s_cbranch_scc1 MH_RET21
  s_sub_u32 s31, s31, 1
  s_sleep 2
  s_bfe_u32 s25, s60, 0x40008
  s_lshl_b32 s25, s25, 12
  s_add_u32 s25, s25, s44
  buffer_load_dwordx4 v[104:107], v6, s[16:19], s25 offen offset:0 sc1
  buffer_load_dwordx4 v[108:111], v6, s[16:19], s25 offen offset:1024 sc1
  s_waitcnt vmcnt(0)
  v_max_u32 v60, v104, v108
  v_cmp_eq_u32 vcc, -1, v60
  s_cbranch_vccnz MH_SLOW21
  s_branch MH_RET21
MH_SLOW22:
  s_cmp_eq_u32 s31, 0
  s_cbranch_scc1 MH_RET22
  s_sub_u32 s31, s31, 1
  s_sleep 2
  s_bfe_u32 s25, s60, 0x40008
  s_lshl_b32 s25, s25, 12
  s_add_u32 s25, s25, s44
  buffer_load_dwordx4 v[112:115], v6, s[16:19], s25 offen offset:2048 sc1
  buffer_load_dwordx4 v[116:119], v6, s[16:19], s25 offen offset:3072 sc1
  s_waitcnt vmcnt(0)
  v_max_u32 v60, v112, v116
  v_cmp_eq_u32 vcc, -1, v60
  s_cbranch_vccnz MH_SLOW22
  s_branch MH_RET22
MH_SLOW23:
  s_cmp_eq_u32 s31, 0
  s_cbranch_scc1 MH_RET23
  s_sub_u32 s31, s31, 1
  s_sleep 2
  s_and_b32 s70, s31, 14
  s_cbranch_scc1 MH_WF9
  s_mov_b64 vcc, exec
  s_mov_b64 exec, 1
  global_load_dword v25, v6, s[64:65] offset:64 sc1
  s_not_b32 s70, s69
  s_waitcnt vmcnt(0)
  v_readfirstlane_b32 s69, v25
  s_nop 0
  s_cmp_ge_u32 s69, s70
  s_cbranch_scc1 MH_WF9B
  v_mov_b32 v25, s70
  global_atomic_umax v6, v25, s[64:65] offset:64 sc1
  s_mov_b32 s69, s70
MH_WF9B:
  s_not_b32 s69, s69
  s_mov_b64 exec, vcc
MH_WF9:
  s_memrealtime vcc
  buffer_load_dwordx4 v[24:27], v20, s[16:19], s48 offen sc1
  s_waitcnt vmcnt(0)
  s_waitcnt lgkmcnt(0)
  s_lshr_b64 vcc, vcc, 8
  s_sub_u32 s70, vcc_lo, s69
  s_add_u32 s70, s70, 1
  v_subrev_u32 v25, s69, v25
  v_subrev_u32 v27, s69, v27
  v_max_u32 v25, v25, v27
  v_cmp_lt_u32 vcc, s70, v25
  s_cbranch_vccnz MH_SLOW23
  s_branch MH_RET23
MH_SLOW24:
  s_cmp_eq_u32 s31, 0
  s_cbranch_scc1 MH_RET24
  s_sub_u32 s31, s31, 1
  s_sleep 2
  s_bfe_u32 s25, s60, 0x4000c
  s_lshl_b32 s25, s25, 12
  s_add_u32 s25, s25, s44
  buffer_load_dwordx4 v[120:123], v6, s[16:19], s25 offen offset:0 sc1
  buffer_load_dwordx4 v[124:127], v6, s[16:19], s25 offen offset:1024 sc1
  s_waitcnt vmcnt(0)
  v_max_u32 v60, v120, v124
  v_cmp_eq_u32 vcc, -1, v60
  s_cbranch_vccnz MH_SLOW24
  s_branch MH_RET24
MH_SLOW25:
  s_cmp_eq_u32 s31, 0
  s_cbranch_scc1 MH_RET25
  s_sub_u32 s31, s31, 1
  s_sleep 2
  s_and_b32 s70, s31, 14
  s_cbranch_scc1 MH_WF10
  s_mov_b64 vcc, exec
  s_mov_b64 exec, 1
  global_load_dword v5, v6, s[64:65] offset:64 sc1
  s_not_b32 s70, s69
  s_waitcnt vmcnt(0)
  v_readfirstlane_b32 s69, v5
  s_nop 0
  s_cmp_ge_u32 s69, s70
  s_cbranch_scc1 MH_WF10B
  v_mov_b32 v5, s70
  global_atomic_umax v6, v5, s[64:65] offset:64 sc1
  s_mov_b32 s69, s70
MH_WF10B:
  s_not_b32 s69, s69
  s_mov_b64 exec, vcc
MH_WF10:
  s_memrealtime vcc
  buffer_load_dword v5, v4, s[16:19], s71 offen sc1
  s_waitcnt vmcnt(0)
  s_waitcnt lgkmcnt(0)
  s_lshr_b64 vcc, vcc, 8
  s_sub_u32 s70, vcc_lo, s69
  s_add_u32 s70, s70, 1
  v_subrev_u32 v5, s69, v5
  v_cmp_lt_u32 vcc, s70, v5
  s_cbranch_vccnz MH_SLOW25
  s_branch MH_RET25
MH_SLOW26:
  s_cmp_eq_u32 s31, 0
  s_cbranch_scc1 MH_RET26
  s_sub_u32 s31, s31, 1
  s_sleep 2
  s_bfe_u32 s25, s60, 0x40000
  s_lshl_b32 s25, s25, 12
  s_add_u32 s25, s25, s45
  buffer_load_dwordx4 v[52:55], v6, s[16:19], s25 offen offset:0 sc1
  buffer_load_dwordx4 v[56:59], v6, s[16:19], s25 offen offset:1024 sc1
  s_waitcnt vmcnt(0)
  v_max_u32 v60, v52, v56
  v_cmp_eq_u32 vcc, -1, v60
  s_cbranch_vccnz MH_SLOW26
  s_branch MH_RET26
MH_SLOW27:
  s_cmp_eq_u32 s31, 0
  s_cbranch_scc1 MH_RET27
  s_sub_u32 s31, s31, 1
  s_sleep 2
  s_bfe_u32 s25, s60, 0x40000
  s_lshl_b32 s25, s25, 12
  s_add_u32 s25, s25, s45
  buffer_load_dwordx4 a[112:115], v6, s[16:19], s25 offen offset:2048 sc1
  buffer_load_dwordx4 a[116:119], v6, s[16:19], s25 offen offset:3072 sc1
  s_waitcnt vmcnt(0)
  v_accvgpr_read_b32 v60, a112
  v_accvgpr_read_b32 v61, a116
  v_max_u32 v60, v60, v61
  v_cmp_eq_u32 vcc, -1, v60
  s_cbranch_vccnz MH_SLOW27
  s_branch MH_RET27
MH_SLOW28:
  s_cmp_eq_u32 s31, 0
  s_cbranch_scc1 MH_RET28
  s_sub_u32 s31, s31, 1
  s_sleep 2
  s_bfe_u32 s25, s60, 0x40004
  s_lshl_b32 s25, s25, 12
  s_add_u32 s25, s25, s45
  buffer_load_dwordx4 a[120:123], v6, s[16:19], s25 offen offset:0 sc1
  buffer_load_dwordx4 a[124:127], v6, s[16:19], s25 offen offset:1024 sc1
  s_waitcnt vmcnt(0)
  v_accvgpr_read_b32 v60, a120
  v_accvgpr_read_b32 v61, a124
  v_max_u32 v60, v60, v61
  v_cmp_eq_u32 vcc, -1, v60
  s_cbranch_vccnz MH_SLOW28
  s_branch MH_RET28
MH_SLOW29:
  s_cmp_eq_u32 s31, 0
  s_cbranch_scc1 MH_RET29
  s_sub_u32 s31, s31, 1
  s_sleep 2
  s_bfe_u32 s25, s60, 0x40004
  s_lshl_b32 s25, s25, 12
  s_add_u32 s25, s25, s45
  buffer_load_dwordx4 v[28:31], v6, s[16:19], s25 offen offset:2048 sc1
  buffer_load_dwordx4 v[32:35], v6, s[16:19], s25 offen offset:3072 sc1
  s_waitcnt vmcnt(0)
  v_max_u32 v60, v28, v32
  v_cmp_eq_u32 vcc, -1, v60
  s_cbranch_vccnz MH_SLOW29
  s_branch MH_RET29
MH_SLOW30:
  s_cmp_eq_u32 s31, 0
  s_cbranch_scc1 MH_RET30
  s_sub_u32 s31, s31, 1
  s_sleep 2
  s_bfe_u32 s25, s60, 0x40008
  s_lshl_b32 s25, s25, 12
  s_add_u32 s25, s25, s45
  buffer_load_dwordx4 v[36:39], v6, s[16:19], s25 offen offset:0 sc1
  buffer_load_dwordx4 v[40:43], v6, s[16:19], s25 offen offset:1024 sc1
  s_waitcnt vmcnt(0)
  v_max_u32 v60, v36, v40
  v_cmp_eq_u32 vcc, -1, v60
  s_cbranch_vccnz MH_SLOW30
  s_branch MH_RET30
MH_SLOW31:
  s_cmp_eq_u32 s31, 0
  s_cbranch_scc1 MH_RET31
  s_sub_u32 s31, s31, 1
  s_sleep 2
  s_bfe_u32 s25, s60, 0x40008
  s_lshl_b32 s25, s25, 12
  s_add_u32 s25, s25, s45
  buffer_load_dwordx4 v[44:47], v6, s[16:19], s25 offen offset:2048 sc1
  buffer_load_dwordx4 v[48:51], v6, s[16:19], s25 offen offset:3072 sc1
  s_waitcnt vmcnt(0)
  v_max_u32 v60, v44, v48
  v_cmp_eq_u32 vcc, -1, v60
  s_cbranch_vccnz MH_SLOW31
  s_branch MH_RET31
MH_SLOW32:
  s_cmp_eq_u32 s31, 0
  s_cbranch_scc1 MH_RET32
  s_sub_u32 s31, s31, 1
  s_sleep 2
  s_bfe_u32 s25, s60, 0x4000c
  s_lshl_b32 s25, s25, 12
  s_add_u32 s25, s25, s45
  buffer_load_dwordx4 v[20:23], v6, s[16:19], s25 offen offset:0 sc1
  buffer_load_dwordx4 v[24:27], v6, s[16:19], s25 offen offset:1024 sc1
  s_waitcnt vmcnt(0)
  v_max_u32 v60, v20, v24
  v_cmp_eq_u32 vcc, -1, v60
  s_cbranch_vccnz MH_SLOW32
  s_branch MH_RET32
AX_CONT:
  v_lshlrev_b32 v6, 4, v2
  s_mov_b32 s31, 20000
  s_mov_b32 s40, s7
  s_cmp_ge_u32 s3, 7
  s_cselect_b32 s41, 896, 0
  s_add_u32 s41, s41, 1792
  s_cmp_ge_u32 s3, 14
  s_cselect_b32 s41, 128, s41
  s_add_u32 s41, s41, s7
  s_lshr_b32 s5, 0x05554000, s6
  s_and_b32 s5, s5, 1
  v_lshrrev_b32 v20, 4, v2
  s_lshl_b32 s25, s4, 2
  v_add_u32 v20, s25, v20
  v_lshlrev_b32 v20, 8, v20
  v_lshl_add_u32 v20, v17, 5, v20
  v_lshlrev_b32 v21, 2, v2
  v_lshlrev_b32 v22, 3, v2
  s_lshl_b32 s23, s23, 3
  v_add_u32 v23, s23, v6
  s_and_b32 s32, s4, 3
  s_mov_b32 s20, s64
  s_and_b32 s21, s65, 0xffff
  s_mov_b32 s22, 0x100
  s_mov_b32 s23, 0x20000
  s_lshr_b64 s[70:71], s[68:69], 8
  s_sub_u32 s69, s70, 3
  s_mov_b32 s16, s66
  s_and_b32 s17, s67, 0xffff
  s_mov_b32 s18, 0x1400000
  s_mov_b32 s19, 0x20000
  s_mov_b32 s44, s56
  s_and_b32 s45, s57, 0xffff
  s_mov_b32 s46, 0x188000
  s_mov_b32 s47, 0x20000
  s_mov_b32 s28, 0x00ff00ff
  s_mov_b32 s29, 0x00ff00ff
  s_sleep 12
  s_add_u32 s25, s41, 0
  buffer_load_dwordx4 v[112:115], v18, s[12:15], s25 offen nt
  s_add_u32 s25, s41, 5376
  buffer_load_dwordx4 v[116:119], v18, s[12:15], s25 offen nt
  s_add_u32 s25, s41, 10752
  buffer_load_dwordx4 v[120:123], v18, s[12:15], s25 offen nt
  s_add_u32 s25, s41, 16128
  buffer_load_dwordx4 v[124:127], v18, s[12:15], s25 offen nt
  s_waitcnt vmcnt(9)
  v_lshlrev_b32 v60, 16, v50
  v_and_b32 v61, 0xffff0000, v50
  v_lshlrev_b32 v62, 16, v51
  v_and_b32 v63, 0xffff0000, v51
  v_lshlrev_b32 v64, 16, v52
  v_and_b32 v65, 0xffff0000, v52
  v_lshlrev_b32 v66, 16, v53
  v_and_b32 v67, 0xffff0000, v53
  v_lshlrev_b32 v68, 16, v54
  v_and_b32 v69, 0xffff0000, v54
  v_lshlrev_b32 v70, 16, v55
  v_and_b32 v71, 0xffff0000, v55
  v_lshlrev_b32 v72, 16, v56
  v_and_b32 v73, 0xffff0000, v56
  v_pk_add_f32 v[74:75], v[60:61], v[62:63]
  v_pk_mul_f32 v[76:77], v[60:61], v[60:61]
  v_pk_mul_f32 v[78:79], v[62:63], v[62:63]
  v_pk_add_f32 v[74:75], v[74:75], v[64:65]
  v_pk_fma_f32 v[76:77], v[64:65], v[64:65], v[76:77]
  v_pk_add_f32 v[74:75], v[74:75], v[66:67]
  v_pk_fma_f32 v[78:79], v[66:67], v[66:67], v[78:79]
  v_pk_add_f32 v[74:75], v[74:75], v[68:69]
  v_pk_fma_f32 v[76:77], v[68:69], v[68:69], v[76:77]
  v_pk_add_f32 v[74:75], v[74:75], v[70:71]
  v_pk_fma_f32 v[78:79], v[70:71], v[70:71], v[78:79]
  v_pk_add_f32 v[74:75], v[74:75], v[72:73]
  v_pk_fma_f32 v[76:77], v[72:73], v[72:73], v[76:77]
  v_pk_add_f32 v[76:77], v[76:77], v[78:79]
  v_add_f32 v74, v74, v75
  v_add_f32 v76, v76, v77
  s_lshl_b32 s25, s4, 4
  v_add_f32_dpp v74, v74, v74 quad_perm:[1,0,3,2] row_mask:0xf bank_mask:0xf
  v_add_f32_dpp v76, v76, v76 quad_perm:[1,0,3,2] row_mask:0xf bank_mask:0xf
  s_add_u32 s25, s25, 162592
  v_add_f32_dpp v74, v74, v74 quad_perm:[2,3,0,1] row_mask:0xf bank_mask:0xf
  v_add_f32_dpp v76, v76, v76 quad_perm:[2,3,0,1] row_mask:0xf bank_mask:0xf
  v_lshl_add_u32 v60, v3, 3, s25
  v_add_f32_dpp v74, v74, v74 row_half_mirror row_mask:0xf bank_mask:0xf
  v_add_f32_dpp v76, v76, v76 row_half_mirror row_mask:0xf bank_mask:0xf
  v_add_u32 v61, 162592, v6
  v_add_f32_dpp v74, v74, v74 row_mirror row_mask:0xf bank_mask:0xf
  v_add_f32_dpp v76, v76, v76 row_mirror row_mask:0xf bank_mask:0xf
  s_lshl_b32 s24, s2, 6
  v_add_f32_dpp v74, v74, v74 row_bcast:15 row_mask:0xa bank_mask:0xf
  v_add_f32_dpp v76, v76, v76 row_bcast:15 row_mask:0xa bank_mask:0xf
  v_mul_f32 v74, 0x3b124925, v74
  v_mul_f32 v76, 0x3b124925, v76
  v_fma_f32 v76, -v74, v74, v76
  v_max_f32 v76, 0, v76
  v_cvt_pk_bf16_f32 v76, 0, v76
  v_add_f32 v76, 0x3727c5ac, v76
  v_cvt_pk_bf16_f32 v76, 0, v76
  v_sqrt_f32 v76, v76
  s_nop 0
  v_cvt_pk_bf16_f32 v76, v76, v74
  s_waitcnt vmcnt(8)
  v_lshlrev_b32 v32, 16, v40
  v_and_b32 v33, 0xffff0000, v40
  v_lshlrev_b32 v34, 16, v41
  v_and_b32 v35, 0xffff0000, v41
  v_mul_f32 v40, 0xbfb8aa3b, v32
  v_mul_f32 v41, 0xbfb8aa3b, v33
  v_mul_f32 v42, 0xbfb8aa3b, v34
  v_mul_f32 v43, 0xbfb8aa3b, v35
  v_exp_f32 v40, v40
  v_exp_f32 v41, v41
  v_exp_f32 v42, v42
  v_exp_f32 v43, v43
  v_add_f32 v40, 1.0, v40
  v_add_f32 v41, 1.0, v41
  v_add_f32 v42, 1.0, v42
  v_add_f32 v43, 1.0, v43
  v_rcp_f32 v40, v40
  v_rcp_f32 v41, v41
  v_rcp_f32 v42, v42
  v_rcp_f32 v43, v43
  v_mul_f32 v32, v32, v40
  v_mul_f32 v33, v33, v41
  v_mul_f32 v34, v34, v42
  v_mul_f32 v35, v35, v43
  v_cvt_pk_bf16_f32 v32, 0, v32
  v_cvt_pk_bf16_f32 v33, 0, v33
  v_cvt_pk_bf16_f32 v34, 0, v34
  v_cvt_pk_bf16_f32 v35, 0, v35
  s_waitcnt vmcnt(7)
  v_lshlrev_b32 v80, 16, v96
  v_and_b32 v81, 0xffff0000, v96
  v_lshlrev_b32 v82, 16, v97
  v_and_b32 v83, 0xffff0000, v97
  v_lshlrev_b32 v84, 16, v98
  v_and_b32 v85, 0xffff0000, v98
  v_lshlrev_b32 v86, 16, v99
  v_and_b32 v87, 0xffff0000, v99
  v_mul_f32 v40, v80, v32
  v_mul_f32 v41, v81, v32
  v_mul_f32 v42, v82, v32
  v_mul_f32 v43, v83, v32
  v_mul_f32 v44, v84, v32
  v_mul_f32 v45, v85, v32
  v_mul_f32 v46, v86, v32
  v_mul_f32 v47, v87, v32
  s_waitcnt vmcnt(6)
  v_lshlrev_b32 v88, 16, v100
  v_and_b32 v89, 0xffff0000, v100
  v_lshlrev_b32 v90, 16, v101
  v_and_b32 v91, 0xffff0000, v101
  v_lshlrev_b32 v92, 16, v102
  v_and_b32 v93, 0xffff0000, v102
  v_lshlrev_b32 v94, 16, v103
  v_and_b32 v95, 0xffff0000, v103
  v_fmac_f32 v40, v88, v33
  v_fmac_f32 v41, v89, v33
  v_fmac_f32 v42, v90, v33
  v_fmac_f32 v43, v91, v33
  v_fmac_f32 v44, v92, v33
  v_fmac_f32 v45, v93, v33
  v_fmac_f32 v46, v94, v33
  v_fmac_f32 v47, v95, v33
  s_waitcnt vmcnt(5)
  v_lshlrev_b32 v80, 16, v104
  v_and_b32 v81, 0xffff0000, v104
  v_lshlrev_b32 v82, 16, v105
  v_and_b32 v83, 0xffff0000, v105
  v_lshlrev_b32 v84, 16, v106
  v_and_b32 v85, 0xffff0000, v106
  v_lshlrev_b32 v86, 16, v107
  v_and_b32 v87, 0xffff0000, v107
  v_fmac_f32 v40, v80, v34
  v_fmac_f32 v41, v81, v34
  v_fmac_f32 v42, v82, v34
  v_fmac_f32 v43, v83, v34
  v_fmac_f32 v44, v84, v34
  v_fmac_f32 v45, v85, v34
  v_fmac_f32 v46, v86, v34
  v_fmac_f32 v47, v87, v34
  s_waitcnt vmcnt(4)
  v_lshlrev_b32 v88, 16, v108
  v_and_b32 v89, 0xffff0000, v108
  v_lshlrev_b32 v90, 16, v109
  v_and_b32 v91, 0xffff0000, v109
  v_lshlrev_b32 v92, 16, v110
  v_and_b32 v93, 0xffff0000, v110
  v_lshlrev_b32 v94, 16, v111
  v_and_b32 v95, 0xffff0000, v111
  v_fmac_f32 v40, v88, v35
  v_fmac_f32 v41, v89, v35
  v_fmac_f32 v42, v90, v35
  v_fmac_f32 v43, v91, v35
  v_fmac_f32 v44, v92, v35
  v_fmac_f32 v45, v93, v35
  v_fmac_f32 v46, v94, v35
  v_fmac_f32 v47, v95, v35
  v_add_f32_dpp v40, v40, v40 row_ror:8 row_mask:0xf bank_mask:0xf
  v_add_f32_dpp v41, v41, v41 row_ror:8 row_mask:0xf bank_mask:0xf
  v_add_f32_dpp v42, v42, v42 row_ror:8 row_mask:0xf bank_mask:0xf
  v_add_f32_dpp v43, v43, v43 row_ror:8 row_mask:0xf bank_mask:0xf
  v_add_f32_dpp v44, v44, v44 row_ror:8 row_mask:0xf bank_mask:0xf
  v_add_f32_dpp v45, v45, v45 row_ror:8 row_mask:0xf bank_mask:0xf
  v_add_f32_dpp v46, v46, v46 row_ror:8 row_mask:0xf bank_mask:0xf
  v_add_f32_dpp v47, v47, v47 row_ror:8 row_mask:0xf bank_mask:0xf
  s_mov_b64 exec, s[28:29]
  ds_write_b128 v20, v[40:43] offset:0
  ds_write_b128 v20, v[44:47] offset:16
  s_mov_b64 exec, -1
  s_waitcnt lgkmcnt(0)
  v_add_u32_e64 v30, s69, 3
  v_mov_b32 v77, v30
  s_mov_b32 exec_lo, 0x10000
  s_mov_b32 exec_hi, 0x10000
  ds_write_b64 v60, v[76:77]
  s_mov_b64 exec, 15
  ds_read_b128 v[64:67], v61
  s_waitcnt lgkmcnt(0)
  v_subrev_u32 v62, s69, v65
  v_subrev_u32 v63, s69, v67
  v_max_u32 v62, v62, v63
  v_cmp_lt_u32 vcc, 16, v62
  s_cbranch_vccnz AX_NOST
  buffer_store_dwordx4 v[64:67], v6, s[16:19], s24 offen offset:0 sc1
AX_NOST:
  s_mov_b64 exec, -1
  s_barrier
  s_cmp_lt_u32 s6, 4
  s_cbranch_scc1 AX_SB
  s_waitcnt vmcnt(3)
  v_lshlrev_b32 v80, 16, v112
  v_and_b32 v81, 0xffff0000, v112
  v_lshlrev_b32 v82, 16, v113
  v_and_b32 v83, 0xffff0000, v113
  v_lshlrev_b32 v84, 16, v114
  v_and_b32 v85, 0xffff0000, v114
  v_lshlrev_b32 v86, 16, v115
  v_and_b32 v87, 0xffff0000, v115
  v_mul_f32 v40, v80, v32
  v_mul_f32 v41, v81, v32
  v_mul_f32 v42, v82, v32
  v_mul_f32 v43, v83, v32
  v_mul_f32 v44, v84, v32
  v_mul_f32 v45, v85, v32
  v_mul_f32 v46, v86, v32
  v_mul_f32 v47, v87, v32
  s_waitcnt vmcnt(2)
  v_lshlrev_b32 v88, 16, v116
  v_and_b32 v89, 0xffff0000, v116
  v_lshlrev_b32 v90, 16, v117
  v_and_b32 v91, 0xffff0000, v117
  v_lshlrev_b32 v92, 16, v118
  v_and_b32 v93, 0xffff0000, v118
  v_lshlrev_b32 v94, 16, v119
  v_and_b32 v95, 0xffff0000, v119
  v_fmac_f32 v40, v88, v33
  v_fmac_f32 v41, v89, v33
  v_fmac_f32 v42, v90, v33
  v_fmac_f32 v43, v91, v33
  v_fmac_f32 v44, v92, v33
  v_fmac_f32 v45, v93, v33
  v_fmac_f32 v46, v94, v33
  v_fmac_f32 v47, v95, v33
  s_waitcnt vmcnt(1)
  v_lshlrev_b32 v80, 16, v120
  v_and_b32 v81, 0xffff0000, v120
  v_lshlrev_b32 v82, 16, v121
  v_and_b32 v83, 0xffff0000, v121
  v_lshlrev_b32 v84, 16, v122
  v_and_b32 v85, 0xffff0000, v122
  v_lshlrev_b32 v86, 16, v123
  v_and_b32 v87, 0xffff0000, v123
  v_fmac_f32 v40, v80, v34
  v_fmac_f32 v41, v81, v34
  v_fmac_f32 v42, v82, v34
  v_fmac_f32 v43, v83, v34
  v_fmac_f32 v44, v84, v34
  v_fmac_f32 v45, v85, v34
  v_fmac_f32 v46, v86, v34
  v_fmac_f32 v47, v87, v34
  s_waitcnt vmcnt(0)
  v_lshlrev_b32 v88, 16, v124
  v_and_b32 v89, 0xffff0000, v124
  v_lshlrev_b32 v90, 16, v125
  v_and_b32 v91, 0xffff0000, v125
  v_lshlrev_b32 v92, 16, v126
  v_and_b32 v93, 0xffff0000, v126
  v_lshlrev_b32 v94, 16, v127
  v_and_b32 v95, 0xffff0000, v127
  v_fmac_f32 v40, v88, v35
  v_fmac_f32 v41, v89, v35
  v_fmac_f32 v42, v90, v35
  v_fmac_f32 v43, v91, v35
  v_fmac_f32 v44, v92, v35
  v_fmac_f32 v45, v93, v35
  v_fmac_f32 v46, v94, v35
  v_fmac_f32 v47, v95, v35
  v_add_f32_dpp v40, v40, v40 row_ror:8 row_mask:0xf bank_mask:0xf
  v_add_f32_dpp v41, v41, v41 row_ror:8 row_mask:0xf bank_mask:0xf
  v_add_f32_dpp v42, v42, v42 row_ror:8 row_mask:0xf bank_mask:0xf
  v_add_f32_dpp v43, v43, v43 row_ror:8 row_mask:0xf bank_mask:0xf
  v_add_f32_dpp v44, v44, v44 row_ror:8 row_mask:0xf bank_mask:0xf
  v_add_f32_dpp v45, v45, v45 row_ror:8 row_mask:0xf bank_mask:0xf
  v_add_f32_dpp v46, v46, v46 row_ror:8 row_mask:0xf bank_mask:0xf
  v_add_f32_dpp v47, v47, v47 row_ror:8 row_mask:0xf bank_mask:0xf
  s_mov_b64 exec, s[28:29]
  ds_write_b128 v20, v[40:43] offset:8192
  ds_write_b128 v20, v[44:47] offset:8208
  s_mov_b64 exec, -1
  s_waitcnt lgkmcnt(0)
  s_barrier
  s_barrier
  s_branch AX_J
AX_SB:
  s_and_b32 s40, s6, 2
  s_lshl_b32 s40, s40, 6
  s_add_u32 s40, s40, 3200
  s_add_u32 s41, s40, 128
  s_add_u32 s25, s40, 0
  buffer_load_dwordx4 v[96:99], v18, s[12:15], s25 offen nt
  s_add_u32 s25, s40, 5376
  buffer_load_dwordx4 v[100:103], v18, s[12:15], s25 offen nt
  s_add_u32 s25, s40, 10752
  buffer_load_dwordx4 v[104:107], v18, s[12:15], s25 offen nt
  s_add_u32 s25, s40, 16128
  buffer_load_dwordx4 v[108:111], v18, s[12:15], s25 offen nt
  s_waitcnt vmcnt(7)
  v_lshlrev_b32 v80, 16, v112
  v_and_b32 v81, 0xffff0000, v112
  v_lshlrev_b32 v82, 16, v113
  v_and_b32 v83, 0xffff0000, v113
  v_lshlrev_b32 v84, 16, v114
  v_and_b32 v85, 0xffff0000, v114
  v_lshlrev_b32 v86, 16, v115
  v_and_b32 v87, 0xffff0000, v115
  v_mul_f32 v40, v80, v32
  v_mul_f32 v41, v81, v32
  v_mul_f32 v42, v82, v32
  v_mul_f32 v43, v83, v32
  v_mul_f32 v44, v84, v32
  v_mul_f32 v45, v85, v32
  v_mul_f32 v46, v86, v32
  v_mul_f32 v47, v87, v32
  s_waitcnt vmcnt(6)
  v_lshlrev_b32 v88, 16, v116
  v_and_b32 v89, 0xffff0000, v116
  v_lshlrev_b32 v90, 16, v117
  v_and_b32 v91, 0xffff0000, v117
  v_lshlrev_b32 v92, 16, v118
  v_and_b32 v93, 0xffff0000, v118
  v_lshlrev_b32 v94, 16, v119
  v_and_b32 v95, 0xffff0000, v119
  v_fmac_f32 v40, v88, v33
  v_fmac_f32 v41, v89, v33
  v_fmac_f32 v42, v90, v33
  v_fmac_f32 v43, v91, v33
  v_fmac_f32 v44, v92, v33
  v_fmac_f32 v45, v93, v33
  v_fmac_f32 v46, v94, v33
  v_fmac_f32 v47, v95, v33
  s_waitcnt vmcnt(5)
  v_lshlrev_b32 v80, 16, v120
  v_and_b32 v81, 0xffff0000, v120
  v_lshlrev_b32 v82, 16, v121
  v_and_b32 v83, 0xffff0000, v121
  v_lshlrev_b32 v84, 16, v122
  v_and_b32 v85, 0xffff0000, v122
  v_lshlrev_b32 v86, 16, v123
  v_and_b32 v87, 0xffff0000, v123
  v_fmac_f32 v40, v80, v34
  v_fmac_f32 v41, v81, v34
  v_fmac_f32 v42, v82, v34
  v_fmac_f32 v43, v83, v34
  v_fmac_f32 v44, v84, v34
  v_fmac_f32 v45, v85, v34
  v_fmac_f32 v46, v86, v34
  v_fmac_f32 v47, v87, v34
  s_waitcnt vmcnt(4)
  v_lshlrev_b32 v88, 16, v124
  v_and_b32 v89, 0xffff0000, v124
  v_lshlrev_b32 v90, 16, v125
  v_and_b32 v91, 0xffff0000, v125
  v_lshlrev_b32 v92, 16, v126
  v_and_b32 v93, 0xffff0000, v126
  v_lshlrev_b32 v94, 16, v127
  v_and_b32 v95, 0xffff0000, v127
  v_fmac_f32 v40, v88, v35
  v_fmac_f32 v41, v89, v35
  v_fmac_f32 v42, v90, v35
  v_fmac_f32 v43, v91, v35
  v_fmac_f32 v44, v92, v35
  v_fmac_f32 v45, v93, v35
  v_fmac_f32 v46, v94, v35
  v_fmac_f32 v47, v95, v35
  v_add_f32_dpp v40, v40, v40 row_ror:8 row_mask:0xf bank_mask:0xf
  v_add_f32_dpp v41, v41, v41 row_ror:8 row_mask:0xf bank_mask:0xf
  v_add_f32_dpp v42, v42, v42 row_ror:8 row_mask:0xf bank_mask:0xf
  v_add_f32_dpp v43, v43, v43 row_ror:8 row_mask:0xf bank_mask:0xf
  v_add_f32_dpp v44, v44, v44 row_ror:8 row_mask:0xf bank_mask:0xf
  v_add_f32_dpp v45, v45, v45 row_ror:8 row_mask:0xf bank_mask:0xf
  v_add_f32_dpp v46, v46, v46 row_ror:8 row_mask:0xf bank_mask:0xf
  v_add_f32_dpp v47, v47, v47 row_ror:8 row_mask:0xf bank_mask:0xf
  s_mov_b64 exec, s[28:29]
  ds_write_b128 v20, v[40:43] offset:8192
  ds_write_b128 v20, v[44:47] offset:8208
  s_mov_b64 exec, -1
  s_waitcnt lgkmcnt(0)
  s_add_u32 s25, s41, 0
  buffer_load_dwordx4 v[112:115], v18, s[12:15], s25 offen nt
  s_add_u32 s25, s41, 5376
  buffer_load_dwordx4 v[116:119], v18, s[12:15], s25 offen nt
  s_add_u32 s25, s41, 10752
  buffer_load_dwordx4 v[120:123], v18, s[12:15], s25 offen nt
  s_add_u32 s25, s41, 16128
  buffer_load_dwordx4 v[124:127], v18, s[12:15], s25 offen nt
  s_barrier
  s_barrier
  s_waitcnt vmcnt(7)
  v_lshlrev_b32 v80, 16, v96
  v_and_b32 v81, 0xffff0000, v96
  v_lshlrev_b32 v82, 16, v97
  v_and_b32 v83, 0xffff0000, v97
  v_lshlrev_b32 v84, 16, v98
  v_and_b32 v85, 0xffff0000, v98
  v_lshlrev_b32 v86, 16, v99
  v_and_b32 v87, 0xffff0000, v99
  v_mul_f32 v40, v80, v32
  v_mul_f32 v41, v81, v32
  v_mul_f32 v42, v82, v32
  v_mul_f32 v43, v83, v32
  v_mul_f32 v44, v84, v32
  v_mul_f32 v45, v85, v32
  v_mul_f32 v46, v86, v32
  v_mul_f32 v47, v87, v32
  s_waitcnt vmcnt(6)
  v_lshlrev_b32 v88, 16, v100
  v_and_b32 v89, 0xffff0000, v100
  v_lshlrev_b32 v90, 16, v101
  v_and_b32 v91, 0xffff0000, v101
  v_lshlrev_b32 v92, 16, v102
  v_and_b32 v93, 0xffff0000, v102
  v_lshlrev_b32 v94, 16, v103
  v_and_b32 v95, 0xffff0000, v103
  v_fmac_f32 v40, v88, v33
  v_fmac_f32 v41, v89, v33
  v_fmac_f32 v42, v90, v33
  v_fmac_f32 v43, v91, v33
  v_fmac_f32 v44, v92, v33
  v_fmac_f32 v45, v93, v33
  v_fmac_f32 v46, v94, v33
  v_fmac_f32 v47, v95, v33
  s_waitcnt vmcnt(5)
  v_lshlrev_b32 v80, 16, v104
  v_and_b32 v81, 0xffff0000, v104
  v_lshlrev_b32 v82, 16, v105
  v_and_b32 v83, 0xffff0000, v105
  v_lshlrev_b32 v84, 16, v106
  v_and_b32 v85, 0xffff0000, v106
  v_lshlrev_b32 v86, 16, v107
  v_and_b32 v87, 0xffff0000, v107
  v_fmac_f32 v40, v80, v34
  v_fmac_f32 v41, v81, v34
  v_fmac_f32 v42, v82, v34
  v_fmac_f32 v43, v83, v34
  v_fmac_f32 v44, v84, v34
  v_fmac_f32 v45, v85, v34
  v_fmac_f32 v46, v86, v34
  v_fmac_f32 v47, v87, v34
  s_waitcnt vmcnt(4)
  v_lshlrev_b32 v88, 16, v108
  v_and_b32 v89, 0xffff0000, v108
  v_lshlrev_b32 v90, 16, v109
  v_and_b32 v91, 0xffff0000, v109
  v_lshlrev_b32 v92, 16, v110
  v_and_b32 v93, 0xffff0000, v110
  v_lshlrev_b32 v94, 16, v111
  v_and_b32 v95, 0xffff0000, v111
  v_fmac_f32 v40, v88, v35
  v_fmac_f32 v41, v89, v35
  v_fmac_f32 v42, v90, v35
  v_fmac_f32 v43, v91, v35
  v_fmac_f32 v44, v92, v35
  v_fmac_f32 v45, v93, v35
  v_fmac_f32 v46, v94, v35
  v_fmac_f32 v47, v95, v35
  v_add_f32_dpp v40, v40, v40 row_ror:8 row_mask:0xf bank_mask:0xf
  v_add_f32_dpp v41, v41, v41 row_ror:8 row_mask:0xf bank_mask:0xf
  v_add_f32_dpp v42, v42, v42 row_ror:8 row_mask:0xf bank_mask:0xf
  v_add_f32_dpp v43, v43, v43 row_ror:8 row_mask:0xf bank_mask:0xf
  v_add_f32_dpp v44, v44, v44 row_ror:8 row_mask:0xf bank_mask:0xf
  v_add_f32_dpp v45, v45, v45 row_ror:8 row_mask:0xf bank_mask:0xf
  v_add_f32_dpp v46, v46, v46 row_ror:8 row_mask:0xf bank_mask:0xf
  v_add_f32_dpp v47, v47, v47 row_ror:8 row_mask:0xf bank_mask:0xf
  s_mov_b64 exec, s[28:29]
  ds_write_b128 v20, v[40:43] offset:0
  ds_write_b128 v20, v[44:47] offset:16
  s_mov_b64 exec, -1
  s_waitcnt lgkmcnt(0)
  s_waitcnt vmcnt(3)
  v_lshlrev_b32 v80, 16, v112
  v_and_b32 v81, 0xffff0000, v112
  v_lshlrev_b32 v82, 16, v113
  v_and_b32 v83, 0xffff0000, v113
  v_lshlrev_b32 v84, 16, v114
  v_and_b32 v85, 0xffff0000, v114
  v_lshlrev_b32 v86, 16, v115
  v_and_b32 v87, 0xffff0000, v115
  v_mul_f32 v40, v80, v32
  v_mul_f32 v41, v81, v32
  v_mul_f32 v42, v82, v32
  v_mul_f32 v43, v83, v32
  v_mul_f32 v44, v84, v32
  v_mul_f32 v45, v85, v32
  v_mul_f32 v46, v86, v32
  v_mul_f32 v47, v87, v32
  s_waitcnt vmcnt(2)
  v_lshlrev_b32 v88, 16, v116
  v_and_b32 v89, 0xffff0000, v116
  v_lshlrev_b32 v90, 16, v117
  v_and_b32 v91, 0xffff0000, v117
  v_lshlrev_b32 v92, 16, v118
  v_and_b32 v93, 0xffff0000, v118
  v_lshlrev_b32 v94, 16, v119
  v_and_b32 v95, 0xffff0000, v119
  v_fmac_f32 v40, v88, v33
  v_fmac_f32 v41, v89, v33
  v_fmac_f32 v42, v90, v33
  v_fmac_f32 v43, v91, v33
  v_fmac_f32 v44, v92, v33
  v_fmac_f32 v45, v93, v33
  v_fmac_f32 v46, v94, v33
  v_fmac_f32 v47, v95, v33
  s_waitcnt vmcnt(1)
  v_lshlrev_b32 v80, 16, v120
  v_and_b32 v81, 0xffff0000, v120
  v_lshlrev_b32 v82, 16, v121
  v_and_b32 v83, 0xffff0000, v121
  v_lshlrev_b32 v84, 16, v122
  v_and_b32 v85, 0xffff0000, v122
  v_lshlrev_b32 v86, 16, v123
  v_and_b32 v87, 0xffff0000, v123
  v_fmac_f32 v40, v80, v34
  v_fmac_f32 v41, v81, v34
  v_fmac_f32 v42, v82, v34
  v_fmac_f32 v43, v83, v34
  v_fmac_f32 v44, v84, v34
  v_fmac_f32 v45, v85, v34
  v_fmac_f32 v46, v86, v34
  v_fmac_f32 v47, v87, v34
  s_waitcnt vmcnt(0)
  v_lshlrev_b32 v88, 16, v124
  v_and_b32 v89, 0xffff0000, v124
  v_lshlrev_b32 v90, 16, v125
  v_and_b32 v91, 0xffff0000, v125
  v_lshlrev_b32 v92, 16, v126
  v_and_b32 v93, 0xffff0000, v126
  v_lshlrev_b32 v94, 16, v127
  v_and_b32 v95, 0xffff0000, v127
  v_fmac_f32 v40, v88, v35
  v_fmac_f32 v41, v89, v35
  v_fmac_f32 v42, v90, v35
  v_fmac_f32 v43, v91, v35
  v_fmac_f32 v44, v92, v35
  v_fmac_f32 v45, v93, v35
  v_fmac_f32 v46, v94, v35
  v_fmac_f32 v47, v95, v35
  v_add_f32_dpp v40, v40, v40 row_ror:8 row_mask:0xf bank_mask:0xf
  v_add_f32_dpp v41, v41, v41 row_ror:8 row_mask:0xf bank_mask:0xf
  v_add_f32_dpp v42, v42, v42 row_ror:8 row_mask:0xf bank_mask:0xf
  v_add_f32_dpp v43, v43, v43 row_ror:8 row_mask:0xf bank_mask:0xf
  v_add_f32_dpp v44, v44, v44 row_ror:8 row_mask:0xf bank_mask:0xf
  v_add_f32_dpp v45, v45, v45 row_ror:8 row_mask:0xf bank_mask:0xf
  v_add_f32_dpp v46, v46, v46 row_ror:8 row_mask:0xf bank_mask:0xf
  v_add_f32_dpp v47, v47, v47 row_ror:8 row_mask:0xf bank_mask:0xf
  s_mov_b64 exec, s[28:29]
  ds_write_b128 v20, v[40:43] offset:8192
  ds_write_b128 v20, v[44:47] offset:8208
  s_mov_b64 exec, -1
  s_waitcnt lgkmcnt(0)
  s_branch AX_SB_A
AUXH:
  v_lshlrev_b32 v6, 4, v2
  s_mov_b32 s31, 20000
  s_mov_b32 s40, s7
  s_cmp_ge_u32 s3, 7
  s_cselect_b32 s41, 896, 0
  s_add_u32 s41, s41, 1792
  s_cmp_ge_u32 s3, 14
  s_cselect_b32 s41, 128, s41
  s_add_u32 s41, s41, s7
  s_lshr_b32 s5, 0x05554000, s6
  s_and_b32 s5, s5, 1
  v_lshrrev_b32 v20, 4, v2
  s_lshl_b32 s25, s4, 2
  v_add_u32 v20, s25, v20
  v_lshlrev_b32 v20, 8, v20
  v_lshl_add_u32 v20, v17, 5, v20
  v_lshlrev_b32 v21, 2, v2
  v_lshlrev_b32 v22, 3, v2
  s_lshl_b32 s23, s23, 3
  v_add_u32 v23, s23, v6
  s_and_b32 s32, s4, 3
  s_mov_b32 s20, s64
  s_and_b32 s21, s65, 0xffff
  s_mov_b32 s22, 0x100
  s_mov_b32 s23, 0x20000
  s_lshr_b64 s[70:71], s[68:69], 8
  s_sub_u32 s69, s70, 3
  s_mov_b32 s16, s66
  s_and_b32 s17, s67, 0xffff
  s_mov_b32 s18, 0x1400000
  s_mov_b32 s19, 0x20000
  s_mov_b32 s44, s56
  s_and_b32 s45, s57, 0xffff
  s_mov_b32 s46, 0x188000
  s_mov_b32 s47, 0x20000
  s_mov_b32 s28, 0x00ff00ff
  s_mov_b32 s29, 0x00ff00ff
  s_sleep 12
  s_add_u32 s25, s41, 0
  buffer_load_dwordx4 v[112:115], v18, s[12:15], s25 offen nt
  s_add_u32 s25, s41, 5376
  buffer_load_dwordx4 v[116:119], v18, s[12:15], s25 offen nt
  s_add_u32 s25, s41, 10752
  buffer_load_dwordx4 v[120:123], v18, s[12:15], s25 offen nt
  s_add_u32 s25, s41, 16128
  buffer_load_dwordx4 v[124:127], v18, s[12:15], s25 offen nt
  s_waitcnt vmcnt(8)
  v_lshlrev_b32 v32, 16, v40
  v_and_b32 v33, 0xffff0000, v40
  v_lshlrev_b32 v34, 16, v41
  v_and_b32 v35, 0xffff0000, v41
  v_mul_f32 v40, 0xbfb8aa3b, v32
  v_mul_f32 v41, 0xbfb8aa3b, v33
  v_mul_f32 v42, 0xbfb8aa3b, v34
  v_mul_f32 v43, 0xbfb8aa3b, v35
  v_exp_f32 v40, v40
  v_exp_f32 v41, v41
  v_exp_f32 v42, v42
  v_exp_f32 v43, v43
  v_add_f32 v40, 1.0, v40
  v_add_f32 v41, 1.0, v41
  v_add_f32 v42, 1.0, v42
  v_add_f32 v43, 1.0, v43
  v_rcp_f32 v40, v40
  v_rcp_f32 v41, v41
  v_rcp_f32 v42, v42
  v_rcp_f32 v43, v43
  v_mul_f32 v32, v32, v40
  v_mul_f32 v33, v33, v41
  v_mul_f32 v34, v34, v42
  v_mul_f32 v35, v35, v43
  v_cvt_pk_bf16_f32 v32, 0, v32
  v_cvt_pk_bf16_f32 v33, 0, v33
  v_cvt_pk_bf16_f32 v34, 0, v34
  v_cvt_pk_bf16_f32 v35, 0, v35
  s_waitcnt vmcnt(7)
  v_lshlrev_b32 v80, 16, v96
  v_and_b32 v81, 0xffff0000, v96
  v_lshlrev_b32 v82, 16, v97
  v_and_b32 v83, 0xffff0000, v97
  v_lshlrev_b32 v84, 16, v98
  v_and_b32 v85, 0xffff0000, v98
  v_lshlrev_b32 v86, 16, v99
  v_and_b32 v87, 0xffff0000, v99
  v_mul_f32 v40, v80, v32
  v_mul_f32 v41, v81, v32
  v_mul_f32 v42, v82, v32
  v_mul_f32 v43, v83, v32
  v_mul_f32 v44, v84, v32
  v_mul_f32 v45, v85, v32
  v_mul_f32 v46, v86, v32
  v_mul_f32 v47, v87, v32
  s_waitcnt vmcnt(6)
  v_lshlrev_b32 v88, 16, v100
  v_and_b32 v89, 0xffff0000, v100
  v_lshlrev_b32 v90, 16, v101
  v_and_b32 v91, 0xffff0000, v101
  v_lshlrev_b32 v92, 16, v102
  v_and_b32 v93, 0xffff0000, v102
  v_lshlrev_b32 v94, 16, v103
  v_and_b32 v95, 0xffff0000, v103
  v_fmac_f32 v40, v88, v33
  v_fmac_f32 v41, v89, v33
  v_fmac_f32 v42, v90, v33
  v_fmac_f32 v43, v91, v33
  v_fmac_f32 v44, v92, v33
  v_fmac_f32 v45, v93, v33
  v_fmac_f32 v46, v94, v33
  v_fmac_f32 v47, v95, v33
  s_waitcnt vmcnt(5)
  v_lshlrev_b32 v80, 16, v104
  v_and_b32 v81, 0xffff0000, v104
  v_lshlrev_b32 v82, 16, v105
  v_and_b32 v83, 0xffff0000, v105
  v_lshlrev_b32 v84, 16, v106
  v_and_b32 v85, 0xffff0000, v106
  v_lshlrev_b32 v86, 16, v107
  v_and_b32 v87, 0xffff0000, v107
  v_fmac_f32 v40, v80, v34
  v_fmac_f32 v41, v81, v34
  v_fmac_f32 v42, v82, v34
  v_fmac_f32 v43, v83, v34
  v_fmac_f32 v44, v84, v34
  v_fmac_f32 v45, v85, v34
  v_fmac_f32 v46, v86, v34
  v_fmac_f32 v47, v87, v34
  s_waitcnt vmcnt(4)
  v_lshlrev_b32 v88, 16, v108
  v_and_b32 v89, 0xffff0000, v108
  v_lshlrev_b32 v90, 16, v109
  v_and_b32 v91, 0xffff0000, v109
  v_lshlrev_b32 v92, 16, v110
  v_and_b32 v93, 0xffff0000, v110
  v_lshlrev_b32 v94, 16, v111
  v_and_b32 v95, 0xffff0000, v111
  v_fmac_f32 v40, v88, v35
  v_fmac_f32 v41, v89, v35
  v_fmac_f32 v42, v90, v35
  v_fmac_f32 v43, v91, v35
  v_fmac_f32 v44, v92, v35
  v_fmac_f32 v45, v93, v35
  v_fmac_f32 v46, v94, v35
  v_fmac_f32 v47, v95, v35
  v_add_f32_dpp v40, v40, v40 row_ror:8 row_mask:0xf bank_mask:0xf
  v_add_f32_dpp v41, v41, v41 row_ror:8 row_mask:0xf bank_mask:0xf
  v_add_f32_dpp v42, v42, v42 row_ror:8 row_mask:0xf bank_mask:0xf
  v_add_f32_dpp v43, v43, v43 row_ror:8 row_mask:0xf bank_mask:0xf
  v_add_f32_dpp v44, v44, v44 row_ror:8 row_mask:0xf bank_mask:0xf
  v_add_f32_dpp v45, v45, v45 row_ror:8 row_mask:0xf bank_mask:0xf
  v_add_f32_dpp v46, v46, v46 row_ror:8 row_mask:0xf bank_mask:0xf
  v_add_f32_dpp v47, v47, v47 row_ror:8 row_mask:0xf bank_mask:0xf
  s_mov_b64 exec, s[28:29]
  ds_write_b128 v20, v[40:43] offset:0
  ds_write_b128 v20, v[44:47] offset:16
  s_mov_b64 exec, -1
  s_waitcnt lgkmcnt(0)
  s_barrier
  s_cmp_lt_u32 s6, 4
  s_cbranch_scc1 AH_SB
  s_waitcnt vmcnt(3)
  v_lshlrev_b32 v80, 16, v112
  v_and_b32 v81, 0xffff0000, v112
  v_lshlrev_b32 v82, 16, v113
  v_and_b32 v83, 0xffff0000, v113
  v_lshlrev_b32 v84, 16, v114
  v_and_b32 v85, 0xffff0000, v114
  v_lshlrev_b32 v86, 16, v115
  v_and_b32 v87, 0xffff0000, v115
  v_mul_f32 v40, v80, v32
  v_mul_f32 v41, v81, v32
  v_mul_f32 v42, v82, v32
  v_mul_f32 v43, v83, v32
  v_mul_f32 v44, v84, v32
  v_mul_f32 v45, v85, v32
  v_mul_f32 v46, v86, v32
  v_mul_f32 v47, v87, v32
  s_waitcnt vmcnt(2)
  v_lshlrev_b32 v88, 16, v116
  v_and_b32 v89, 0xffff0000, v116
  v_lshlrev_b32 v90, 16, v117
  v_and_b32 v91, 0xffff0000, v117
  v_lshlrev_b32 v92, 16, v118
  v_and_b32 v93, 0xffff0000, v118
  v_lshlrev_b32 v94, 16, v119
  v_and_b32 v95, 0xffff0000, v119
  v_fmac_f32 v40, v88, v33
  v_fmac_f32 v41, v89, v33
  v_fmac_f32 v42, v90, v33
  v_fmac_f32 v43, v91, v33
  v_fmac_f32 v44, v92, v33
  v_fmac_f32 v45, v93, v33
  v_fmac_f32 v46, v94, v33
  v_fmac_f32 v47, v95, v33
  s_waitcnt vmcnt(1)
  v_lshlrev_b32 v80, 16, v120
  v_and_b32 v81, 0xffff0000, v120
  v_lshlrev_b32 v82, 16, v121
  v_and_b32 v83, 0xffff0000, v121
  v_lshlrev_b32 v84, 16, v122
  v_and_b32 v85, 0xffff0000, v122
  v_lshlrev_b32 v86, 16, v123
  v_and_b32 v87, 0xffff0000, v123
  v_fmac_f32 v40, v80, v34
  v_fmac_f32 v41, v81, v34
  v_fmac_f32 v42, v82, v34
  v_fmac_f32 v43, v83, v34
  v_fmac_f32 v44, v84, v34
  v_fmac_f32 v45, v85, v34
  v_fmac_f32 v46, v86, v34
  v_fmac_f32 v47, v87, v34
  s_waitcnt vmcnt(0)
  v_lshlrev_b32 v88, 16, v124
  v_and_b32 v89, 0xffff0000, v124
  v_lshlrev_b32 v90, 16, v125
  v_and_b32 v91, 0xffff0000, v125
  v_lshlrev_b32 v92, 16, v126
  v_and_b32 v93, 0xffff0000, v126
  v_lshlrev_b32 v94, 16, v127
  v_and_b32 v95, 0xffff0000, v127
  v_fmac_f32 v40, v88, v35
  v_fmac_f32 v41, v89, v35
  v_fmac_f32 v42, v90, v35
  v_fmac_f32 v43, v91, v35
  v_fmac_f32 v44, v92, v35
  v_fmac_f32 v45, v93, v35
  v_fmac_f32 v46, v94, v35
  v_fmac_f32 v47, v95, v35
  v_add_f32_dpp v40, v40, v40 row_ror:8 row_mask:0xf bank_mask:0xf
  v_add_f32_dpp v41, v41, v41 row_ror:8 row_mask:0xf bank_mask:0xf
  v_add_f32_dpp v42, v42, v42 row_ror:8 row_mask:0xf bank_mask:0xf
  v_add_f32_dpp v43, v43, v43 row_ror:8 row_mask:0xf bank_mask:0xf
  v_add_f32_dpp v44, v44, v44 row_ror:8 row_mask:0xf bank_mask:0xf
  v_add_f32_dpp v45, v45, v45 row_ror:8 row_mask:0xf bank_mask:0xf
  v_add_f32_dpp v46, v46, v46 row_ror:8 row_mask:0xf bank_mask:0xf
  v_add_f32_dpp v47, v47, v47 row_ror:8 row_mask:0xf bank_mask:0xf
  s_mov_b64 exec, s[28:29]
  ds_write_b128 v20, v[40:43] offset:8192
  ds_write_b128 v20, v[44:47] offset:8208
  s_mov_b64 exec, -1
  s_waitcnt lgkmcnt(0)
  s_barrier
  s_barrier
  s_branch AX_J
AH_SB:
  s_and_b32 s40, s6, 2
  s_lshl_b32 s40, s40, 6
  s_add_u32 s40, s40, 3200
  s_add_u32 s41, s40, 128
  s_add_u32 s25, s40, 0
  buffer_load_dwordx4 v[96:99], v18, s[12:15], s25 offen nt
  s_add_u32 s25, s40, 5376
  buffer_load_dwordx4 v[100:103], v18, s[12:15], s25 offen nt
  s_add_u32 s25, s40, 10752
  buffer_load_dwordx4 v[104:107], v18, s[12:15], s25 offen nt
  s_add_u32 s25, s40, 16128
  buffer_load_dwordx4 v[108:111], v18, s[12:15], s25 offen nt
  s_waitcnt vmcnt(7)
  v_lshlrev_b32 v80, 16, v112
  v_and_b32 v81, 0xffff0000, v112
  v_lshlrev_b32 v82, 16, v113
  v_and_b32 v83, 0xffff0000, v113
  v_lshlrev_b32 v84, 16, v114
  v_and_b32 v85, 0xffff0000, v114
  v_lshlrev_b32 v86, 16, v115
  v_and_b32 v87, 0xffff0000, v115
  v_mul_f32 v40, v80, v32
  v_mul_f32 v41, v81, v32
  v_mul_f32 v42, v82, v32
  v_mul_f32 v43, v83, v32
  v_mul_f32 v44, v84, v32
  v_mul_f32 v45, v85, v32
  v_mul_f32 v46, v86, v32
  v_mul_f32 v47, v87, v32
  s_waitcnt vmcnt(6)
  v_lshlrev_b32 v88, 16, v116
  v_and_b32 v89, 0xffff0000, v116
  v_lshlrev_b32 v90, 16, v117
  v_and_b32 v91, 0xffff0000, v117
  v_lshlrev_b32 v92, 16, v118
  v_and_b32 v93, 0xffff0000, v118
  v_lshlrev_b32 v94, 16, v119
  v_and_b32 v95, 0xffff0000, v119
  v_fmac_f32 v40, v88, v33
  v_fmac_f32 v41, v89, v33
  v_fmac_f32 v42, v90, v33
  v_fmac_f32 v43, v91, v33
  v_fmac_f32 v44, v92, v33
  v_fmac_f32 v45, v93, v33
  v_fmac_f32 v46, v94, v33
  v_fmac_f32 v47, v95, v33
  s_waitcnt vmcnt(5)
  v_lshlrev_b32 v80, 16, v120
  v_and_b32 v81, 0xffff0000, v120
  v_lshlrev_b32 v82, 16, v121
  v_and_b32 v83, 0xffff0000, v121
  v_lshlrev_b32 v84, 16, v122
  v_and_b32 v85, 0xffff0000, v122
  v_lshlrev_b32 v86, 16, v123
  v_and_b32 v87, 0xffff0000, v123
  v_fmac_f32 v40, v80, v34
  v_fmac_f32 v41, v81, v34
  v_fmac_f32 v42, v82, v34
  v_fmac_f32 v43, v83, v34
  v_fmac_f32 v44, v84, v34
  v_fmac_f32 v45, v85, v34
  v_fmac_f32 v46, v86, v34
  v_fmac_f32 v47, v87, v34
  s_waitcnt vmcnt(4)
  v_lshlrev_b32 v88, 16, v124
  v_and_b32 v89, 0xffff0000, v124
  v_lshlrev_b32 v90, 16, v125
  v_and_b32 v91, 0xffff0000, v125
  v_lshlrev_b32 v92, 16, v126
  v_and_b32 v93, 0xffff0000, v126
  v_lshlrev_b32 v94, 16, v127
  v_and_b32 v95, 0xffff0000, v127
  v_fmac_f32 v40, v88, v35
  v_fmac_f32 v41, v89, v35
  v_fmac_f32 v42, v90, v35
  v_fmac_f32 v43, v91, v35
  v_fmac_f32 v44, v92, v35
  v_fmac_f32 v45, v93, v35
  v_fmac_f32 v46, v94, v35
  v_fmac_f32 v47, v95, v35
  v_add_f32_dpp v40, v40, v40 row_ror:8 row_mask:0xf bank_mask:0xf
  v_add_f32_dpp v41, v41, v41 row_ror:8 row_mask:0xf bank_mask:0xf
  v_add_f32_dpp v42, v42, v42 row_ror:8 row_mask:0xf bank_mask:0xf
  v_add_f32_dpp v43, v43, v43 row_ror:8 row_mask:0xf bank_mask:0xf
  v_add_f32_dpp v44, v44, v44 row_ror:8 row_mask:0xf bank_mask:0xf
  v_add_f32_dpp v45, v45, v45 row_ror:8 row_mask:0xf bank_mask:0xf
  v_add_f32_dpp v46, v46, v46 row_ror:8 row_mask:0xf bank_mask:0xf
  v_add_f32_dpp v47, v47, v47 row_ror:8 row_mask:0xf bank_mask:0xf
  s_mov_b64 exec, s[28:29]
  ds_write_b128 v20, v[40:43] offset:8192
  ds_write_b128 v20, v[44:47] offset:8208
  s_mov_b64 exec, -1
  s_waitcnt lgkmcnt(0)
  s_add_u32 s25, s41, 0
  buffer_load_dwordx4 v[112:115], v18, s[12:15], s25 offen nt
  s_add_u32 s25, s41, 5376
  buffer_load_dwordx4 v[116:119], v18, s[12:15], s25 offen nt
  s_add_u32 s25, s41, 10752
  buffer_load_dwordx4 v[120:123], v18, s[12:15], s25 offen nt
  s_add_u32 s25, s41, 16128
  buffer_load_dwordx4 v[124:127], v18, s[12:15], s25 offen nt
  s_barrier
  s_barrier
  s_waitcnt vmcnt(7)
  v_lshlrev_b32 v80, 16, v96
  v_and_b32 v81, 0xffff0000, v96
  v_lshlrev_b32 v82, 16, v97
  v_and_b32 v83, 0xffff0000, v97
  v_lshlrev_b32 v84, 16, v98
  v_and_b32 v85, 0xffff0000, v98
  v_lshlrev_b32 v86, 16, v99
  v_and_b32 v87, 0xffff0000, v99
  v_mul_f32 v40, v80, v32
  v_mul_f32 v41, v81, v32
  v_mul_f32 v42, v82, v32
  v_mul_f32 v43, v83, v32
  v_mul_f32 v44, v84, v32
  v_mul_f32 v45, v85, v32
  v_mul_f32 v46, v86, v32
  v_mul_f32 v47, v87, v32
  s_waitcnt vmcnt(6)
  v_lshlrev_b32 v88, 16, v100
  v_and_b32 v89, 0xffff0000, v100
  v_lshlrev_b32 v90, 16, v101
  v_and_b32 v91, 0xffff0000, v101
  v_lshlrev_b32 v92, 16, v102
  v_and_b32 v93, 0xffff0000, v102
  v_lshlrev_b32 v94, 16, v103
  v_and_b32 v95, 0xffff0000, v103
  v_fmac_f32 v40, v88, v33
  v_fmac_f32 v41, v89, v33
  v_fmac_f32 v42, v90, v33
  v_fmac_f32 v43, v91, v33
  v_fmac_f32 v44, v92, v33
  v_fmac_f32 v45, v93, v33
  v_fmac_f32 v46, v94, v33
  v_fmac_f32 v47, v95, v33
  s_waitcnt vmcnt(5)
  v_lshlrev_b32 v80, 16, v104
  v_and_b32 v81, 0xffff0000, v104
  v_lshlrev_b32 v82, 16, v105
  v_and_b32 v83, 0xffff0000, v105
  v_lshlrev_b32 v84, 16, v106
  v_and_b32 v85, 0xffff0000, v106
  v_lshlrev_b32 v86, 16, v107
  v_and_b32 v87, 0xffff0000, v107
  v_fmac_f32 v40, v80, v34
  v_fmac_f32 v41, v81, v34
  v_fmac_f32 v42, v82, v34
  v_fmac_f32 v43, v83, v34
  v_fmac_f32 v44, v84, v34
  v_fmac_f32 v45, v85, v34
  v_fmac_f32 v46, v86, v34
  v_fmac_f32 v47, v87, v34
  s_waitcnt vmcnt(4)
  v_lshlrev_b32 v88, 16, v108
  v_and_b32 v89, 0xffff0000, v108
  v_lshlrev_b32 v90, 16, v109
  v_and_b32 v91, 0xffff0000, v109
  v_lshlrev_b32 v92, 16, v110
  v_and_b32 v93, 0xffff0000, v110
  v_lshlrev_b32 v94, 16, v111
  v_and_b32 v95, 0xffff0000, v111
  v_fmac_f32 v40, v88, v35
  v_fmac_f32 v41, v89, v35
  v_fmac_f32 v42, v90, v35
  v_fmac_f32 v43, v91, v35
  v_fmac_f32 v44, v92, v35
  v_fmac_f32 v45, v93, v35
  v_fmac_f32 v46, v94, v35
  v_fmac_f32 v47, v95, v35
  v_add_f32_dpp v40, v40, v40 row_ror:8 row_mask:0xf bank_mask:0xf
  v_add_f32_dpp v41, v41, v41 row_ror:8 row_mask:0xf bank_mask:0xf
  v_add_f32_dpp v42, v42, v42 row_ror:8 row_mask:0xf bank_mask:0xf
  v_add_f32_dpp v43, v43, v43 row_ror:8 row_mask:0xf bank_mask:0xf
  v_add_f32_dpp v44, v44, v44 row_ror:8 row_mask:0xf bank_mask:0xf
  v_add_f32_dpp v45, v45, v45 row_ror:8 row_mask:0xf bank_mask:0xf
  v_add_f32_dpp v46, v46, v46 row_ror:8 row_mask:0xf bank_mask:0xf
  v_add_f32_dpp v47, v47, v47 row_ror:8 row_mask:0xf bank_mask:0xf
  s_mov_b64 exec, s[28:29]
  ds_write_b128 v20, v[40:43] offset:0
  ds_write_b128 v20, v[44:47] offset:16
  s_mov_b64 exec, -1
  s_waitcnt lgkmcnt(0)
  s_waitcnt vmcnt(3)
  v_lshlrev_b32 v80, 16, v112
  v_and_b32 v81, 0xffff0000, v112
  v_lshlrev_b32 v82, 16, v113
  v_and_b32 v83, 0xffff0000, v113
  v_lshlrev_b32 v84, 16, v114
  v_and_b32 v85, 0xffff0000, v114
  v_lshlrev_b32 v86, 16, v115
  v_and_b32 v87, 0xffff0000, v115
  v_mul_f32 v40, v80, v32
  v_mul_f32 v41, v81, v32
  v_mul_f32 v42, v82, v32
  v_mul_f32 v43, v83, v32
  v_mul_f32 v44, v84, v32
  v_mul_f32 v45, v85, v32
  v_mul_f32 v46, v86, v32
  v_mul_f32 v47, v87, v32
  s_waitcnt vmcnt(2)
  v_lshlrev_b32 v88, 16, v116
  v_and_b32 v89, 0xffff0000, v116
  v_lshlrev_b32 v90, 16, v117
  v_and_b32 v91, 0xffff0000, v117
  v_lshlrev_b32 v92, 16, v118
  v_and_b32 v93, 0xffff0000, v118
  v_lshlrev_b32 v94, 16, v119
  v_and_b32 v95, 0xffff0000, v119
  v_fmac_f32 v40, v88, v33
  v_fmac_f32 v41, v89, v33
  v_fmac_f32 v42, v90, v33
  v_fmac_f32 v43, v91, v33
  v_fmac_f32 v44, v92, v33
  v_fmac_f32 v45, v93, v33
  v_fmac_f32 v46, v94, v33
  v_fmac_f32 v47, v95, v33
  s_waitcnt vmcnt(1)
  v_lshlrev_b32 v80, 16, v120
  v_and_b32 v81, 0xffff0000, v120
  v_lshlrev_b32 v82, 16, v121
  v_and_b32 v83, 0xffff0000, v121
  v_lshlrev_b32 v84, 16, v122
  v_and_b32 v85, 0xffff0000, v122
  v_lshlrev_b32 v86, 16, v123
  v_and_b32 v87, 0xffff0000, v123
  v_fmac_f32 v40, v80, v34
  v_fmac_f32 v41, v81, v34
  v_fmac_f32 v42, v82, v34
  v_fmac_f32 v43, v83, v34
  v_fmac_f32 v44, v84, v34
  v_fmac_f32 v45, v85, v34
  v_fmac_f32 v46, v86, v34
  v_fmac_f32 v47, v87, v34
  s_waitcnt vmcnt(0)
  v_lshlrev_b32 v88, 16, v124
  v_and_b32 v89, 0xffff0000, v124
  v_lshlrev_b32 v90, 16, v125
  v_and_b32 v91, 0xffff0000, v125
  v_lshlrev_b32 v92, 16, v126
  v_and_b32 v93, 0xffff0000, v126
  v_lshlrev_b32 v94, 16, v127
  v_and_b32 v95, 0xffff0000, v127
  v_fmac_f32 v40, v88, v35
  v_fmac_f32 v41, v89, v35
  v_fmac_f32 v42, v90, v35
  v_fmac_f32 v43, v91, v35
  v_fmac_f32 v44, v92, v35
  v_fmac_f32 v45, v93, v35
  v_fmac_f32 v46, v94, v35
  v_fmac_f32 v47, v95, v35
  v_add_f32_dpp v40, v40, v40 row_ror:8 row_mask:0xf bank_mask:0xf
  v_add_f32_dpp v41, v41, v41 row_ror:8 row_mask:0xf bank_mask:0xf
  v_add_f32_dpp v42, v42, v42 row_ror:8 row_mask:0xf bank_mask:0xf
  v_add_f32_dpp v43, v43, v43 row_ror:8 row_mask:0xf bank_mask:0xf
  v_add_f32_dpp v44, v44, v44 row_ror:8 row_mask:0xf bank_mask:0xf
  v_add_f32_dpp v45, v45, v45 row_ror:8 row_mask:0xf bank_mask:0xf
  v_add_f32_dpp v46, v46, v46 row_ror:8 row_mask:0xf bank_mask:0xf
  v_add_f32_dpp v47, v47, v47 row_ror:8 row_mask:0xf bank_mask:0xf
  s_mov_b64 exec, s[28:29]
  ds_write_b128 v20, v[40:43] offset:8192
  ds_write_b128 v20, v[44:47] offset:8208
  s_mov_b64 exec, -1
  s_waitcnt lgkmcnt(0)
  s_branch AX_SB_A
AX_W7:
  v_lshlrev_b32 v6, 4, v2
  s_mov_b32 s31, 20000
  s_mov_b32 s40, s7
  s_cmp_ge_u32 s3, 7
  s_cselect_b32 s41, 896, 0
  s_add_u32 s41, s41, 1792
  s_cmp_ge_u32 s3, 14
  s_cselect_b32 s41, 128, s41
  s_add_u32 s41, s41, s7
  s_lshr_b32 s5, 0x05554000, s6
  s_and_b32 s5, s5, 1
  v_lshrrev_b32 v20, 4, v2
  s_lshl_b32 s25, s4, 2
  v_add_u32 v20, s25, v20
  v_lshlrev_b32 v20, 8, v20
  v_lshl_add_u32 v20, v17, 5, v20
  v_lshlrev_b32 v21, 2, v2
  v_lshlrev_b32 v22, 3, v2
  s_lshl_b32 s23, s23, 3
  v_add_u32 v23, s23, v6
  s_and_b32 s32, s4, 3
  s_mov_b32 s20, s64
  s_and_b32 s21, s65, 0xffff
  s_mov_b32 s22, 0x100
  s_mov_b32 s23, 0x20000
  s_mov_b32 s12, s60
  s_and_b32 s13, s61, 0xffff
  s_mov_b32 s14, 0x24c000
  s_mov_b32 s15, 0x20000
  s_cmp_ge_u32 s2, 8
  s_cbranch_scc1 NOSTAMP
  s_lshl_b32 s28, s68, 1
  s_lshl_b32 s29, s2, 2
  v_mov_b32 v8, s28
  s_mov_b64 exec, 1
  buffer_store_dword v8, off, s[20:23], s29 offset:128 sc1
  s_mov_b64 exec, -1
NOSTAMP:
  s_lshr_b64 s[70:71], s[68:69], 8
  s_sub_u32 s69, s70, 3
  s_mov_b32 s16, s66
  s_and_b32 s17, s67, 0xffff
  s_mov_b32 s18, 0x1400000
  s_mov_b32 s19, 0x20000
  s_mov_b32 s44, s56
  s_and_b32 s45, s57, 0xffff
  s_mov_b32 s46, 0x188000
  s_mov_b32 s47, 0x20000
  s_mov_b32 s28, 0x00ff00ff
  s_mov_b32 s29, 0x00ff00ff
  s_sleep 12
  s_not_b32 s25, s69
  v_mov_b32 v8, 0
  v_mov_b32 v9, s25
  s_mov_b64 exec, 1
  global_atomic_umax v8, v9, s[64:65] offset:64 sc1
  s_mov_b64 exec, -1
  s_barrier
  ds_read2st64_b32 v[60:61], v21 offset0:0 offset1:1
  ds_read2st64_b32 v[62:63], v21 offset0:2 offset1:3
  ds_read2st64_b32 v[64:65], v21 offset0:4 offset1:5
  ds_read2st64_b32 v[66:67], v21 offset0:6 offset1:7
  ds_read2st64_b32 v[68:69], v21 offset0:8 offset1:9
  ds_read2st64_b32 v[70:71], v21 offset0:10 offset1:11
  ds_read2st64_b32 v[72:73], v21 offset0:12 offset1:13
  ds_read2st64_b32 v[74:75], v21 offset0:14 offset1:15
  ds_read2st64_b32 v[76:77], v21 offset0:16 offset1:17
  ds_read2st64_b32 v[78:79], v21 offset0:18 offset1:19
  ds_read2st64_b32 v[80:81], v21 offset0:20 offset1:21
  ds_read2st64_b32 v[82:83], v21 offset0:22 offset1:23
  ds_read2st64_b32 v[84:85], v21 offset0:24 offset1:25
  ds_read2st64_b32 v[86:87], v21 offset0:26 offset1:27
  s_lshl_b32 s25, s40, 3
  s_add_u32 s25, s25, 90112
  s_cmp_lg_u32 s5, 0
  s_cselect_b32 s26, 1.0, 0
  s_waitcnt lgkmcnt(0)
  v_pk_add_f32 v[60:61], v[60:61], v[74:75]
  v_pk_add_f32 v[62:63], v[62:63], v[76:77]
  v_pk_add_f32 v[64:65], v[64:65], v[78:79]
  v_pk_add_f32 v[66:67], v[66:67], v[80:81]
  v_pk_add_f32 v[68:69], v[68:69], v[82:83]
  v_pk_add_f32 v[70:71], v[70:71], v[84:85]
  v_pk_add_f32 v[72:73], v[72:73], v[86:87]
  v_pk_add_f32 v[60:61], v[60:61], v[68:69]
  v_pk_add_f32 v[62:63], v[62:63], v[70:71]
  v_pk_add_f32 v[64:65], v[64:65], v[72:73]
  v_pk_add_f32 v[60:61], v[60:61], v[64:65]
  v_pk_add_f32 v[62:63], v[62:63], v[66:67]
  v_pk_add_f32 v[60:61], v[60:61], v[62:63]
  v_add_f32 v60, v60, v61
  v_add_u32_e64 v61, s69, 3
  v_add_f32 v60, s26, v60
  buffer_store_dwordx2 v[60:61], v23, s[16:19], s25 offen sc1
  s_cmp_lt_u32 s6, 4
  s_cbranch_scc1 AX_W7B
  s_sub_u32 s25, s6, 4
  s_mul_i32 s25, s25, 57344
  s_add_u32 s25, s25, 3584
  s_mov_b32 s26, 20224
  s_mov_b32 s24, 8
  s_mov_b32 exec_hi, 0x00ffffff
AX_W7L:
  s_add_u32 m0, s26, 0
  s_nop 0
  buffer_load_dwordx4 v6, s[44:47], s25 offen offset:0 nt lds
  s_add_u32 m0, s26, 64
  s_nop 0
  buffer_load_dwordx4 v6, s[44:47], s25 offen offset:896 nt lds
  s_add_u32 m0, s26, 128
  s_nop 0
  buffer_load_dwordx4 v6, s[44:47], s25 offen offset:1792 nt lds
  s_add_u32 m0, s26, 192
  s_nop 0
  buffer_load_dwordx4 v6, s[44:47], s25 offen offset:2688 nt lds
  s_add_u32 s26, s26, 7680
  s_add_u32 s25, s25, 7168
  s_sub_u32 s24, s24, 1
  s_cmp_lg_u32 s24, 0
  s_cbranch_scc1 AX_W7L
  s_mov_b64 exec, -1
AX_W7B:
  s_barrier
  ds_read2st64_b32 v[92:93], v21 offset0:32 offset1:33
  ds_read2st64_b32 v[94:95], v21 offset0:34 offset1:35
  ds_read2st64_b32 v[96:97], v21 offset0:36 offset1:37
  ds_read2st64_b32 v[98:99], v21 offset0:38 offset1:39
  ds_read2st64_b32 v[100:101], v21 offset0:40 offset1:41
  ds_read2st64_b32 v[102:103], v21 offset0:42 offset1:43
  ds_read2st64_b32 v[104:105], v21 offset0:44 offset1:45
  ds_read2st64_b32 v[106:107], v21 offset0:46 offset1:47
  ds_read2st64_b32 v[108:109], v21 offset0:48 offset1:49
  ds_read2st64_b32 v[110:111], v21 offset0:50 offset1:51
  ds_read2st64_b32 v[112:113], v21 offset0:52 offset1:53
  ds_read2st64_b32 v[114:115], v21 offset0:54 offset1:55
  ds_read2st64_b32 v[116:117], v21 offset0:56 offset1:57
  ds_read2st64_b32 v[118:119], v21 offset0:58 offset1:59
  s_lshl_b32 s25, s41, 3
  s_add_u32 s25, s25, 90112
  s_cmp_lg_u32 s5, 0
  s_cselect_b32 s26, 1.0, 0
  s_waitcnt lgkmcnt(0)
  v_pk_add_f32 v[92:93], v[92:93], v[106:107]
  v_pk_add_f32 v[94:95], v[94:95], v[108:109]
  v_pk_add_f32 v[96:97], v[96:97], v[110:111]
  v_pk_add_f32 v[98:99], v[98:99], v[112:113]
  v_pk_add_f32 v[100:101], v[100:101], v[114:115]
  v_pk_add_f32 v[102:103], v[102:103], v[116:117]
  v_pk_add_f32 v[104:105], v[104:105], v[118:119]
  v_pk_add_f32 v[92:93], v[92:93], v[100:101]
  v_pk_add_f32 v[94:95], v[94:95], v[102:103]
  v_pk_add_f32 v[96:97], v[96:97], v[104:105]
  v_pk_add_f32 v[92:93], v[92:93], v[96:97]
  v_pk_add_f32 v[94:95], v[94:95], v[98:99]
  v_pk_add_f32 v[92:93], v[92:93], v[94:95]
  v_add_f32 v92, v92, v93
  v_add_u32_e64 v93, s69, 3
  v_add_f32 v92, s26, v92
  buffer_store_dwordx2 v[92:93], v23, s[16:19], s25 offen sc1
  s_barrier
AX_J:
  s_cmp_lt_u32 s6, 4
  s_cbranch_scc0 AX_WD
  s_and_b32 s40, s6, 2
  s_lshl_b32 s40, s40, 6
  s_add_u32 s40, s40, 3200
  s_add_u32 s41, s40, 128
AX_SB_A:
  s_barrier
  s_cmp_lg_u32 s4, 7
  s_cbranch_scc1 AX_SB_B
  ds_read2st64_b32 v[60:61], v21 offset0:0 offset1:1
  ds_read2st64_b32 v[62:63], v21 offset0:2 offset1:3
  ds_read2st64_b32 v[64:65], v21 offset0:4 offset1:5
  ds_read2st64_b32 v[66:67], v21 offset0:6 offset1:7
  ds_read2st64_b32 v[68:69], v21 offset0:8 offset1:9
  ds_read2st64_b32 v[70:71], v21 offset0:10 offset1:11
  ds_read2st64_b32 v[72:73], v21 offset0:12 offset1:13
  ds_read2st64_b32 v[74:75], v21 offset0:14 offset1:15
  ds_read2st64_b32 v[76:77], v21 offset0:16 offset1:17
  ds_read2st64_b32 v[78:79], v21 offset0:18 offset1:19
  ds_read2st64_b32 v[80:81], v21 offset0:20 offset1:21
  ds_read2st64_b32 v[82:83], v21 offset0:22 offset1:23
  ds_read2st64_b32 v[84:85], v21 offset0:24 offset1:25
  ds_read2st64_b32 v[86:87], v21 offset0:26 offset1:27
  s_lshl_b32 s25, s40, 3
  s_add_u32 s25, s25, 90112
  s_cmp_lg_u32 s5, 0
  s_cselect_b32 s26, 0, 0
  s_waitcnt lgkmcnt(0)
  v_pk_add_f32 v[60:61], v[60:61], v[74:75]
  v_pk_add_f32 v[62:63], v[62:63], v[76:77]
  v_pk_add_f32 v[64:65], v[64:65], v[78:79]
  v_pk_add_f32 v[66:67], v[66:67], v[80:81]
  v_pk_add_f32 v[68:69], v[68:69], v[82:83]
  v_pk_add_f32 v[70:71], v[70:71], v[84:85]
  v_pk_add_f32 v[72:73], v[72:73], v[86:87]
  v_pk_add_f32 v[60:61], v[60:61], v[68:69]
  v_pk_add_f32 v[62:63], v[62:63], v[70:71]
  v_pk_add_f32 v[64:65], v[64:65], v[72:73]
  v_pk_add_f32 v[60:61], v[60:61], v[64:65]
  v_pk_add_f32 v[62:63], v[62:63], v[66:67]
  v_pk_add_f32 v[60:61], v[60:61], v[62:63]
  v_add_f32 v60, v60, v61
  v_add_u32_e64 v61, s69, 3
  v_add_f32 v60, s26, v60
  buffer_store_dwordx2 v[60:61], v23, s[16:19], s25 offen sc1
  ds_read2st64_b32 v[92:93], v21 offset0:32 offset1:33
  ds_read2st64_b32 v[94:95], v21 offset0:34 offset1:35
  ds_read2st64_b32 v[96:97], v21 offset0:36 offset1:37
  ds_read2st64_b32 v[98:99], v21 offset0:38 offset1:39
  ds_read2st64_b32 v[100:101], v21 offset0:40 offset1:41
  ds_read2st64_b32 v[102:103], v21 offset0:42 offset1:43
  ds_read2st64_b32 v[104:105], v21 offset0:44 offset1:45
  ds_read2st64_b32 v[106:107], v21 offset0:46 offset1:47
  ds_read2st64_b32 v[108:109], v21 offset0:48 offset1:49
  ds_read2st64_b32 v[110:111], v21 offset0:50 offset1:51
  ds_read2st64_b32 v[112:113], v21 offset0:52 offset1:53
  ds_read2st64_b32 v[114:115], v21 offset0:54 offset1:55
  ds_read2st64_b32 v[116:117], v21 offset0:56 offset1:57
  ds_read2st64_b32 v[118:119], v21 offset0:58 offset1:59
  s_lshl_b32 s25, s41, 3
  s_add_u32 s25, s25, 90112
  s_cmp_lg_u32 s5, 0
  s_cselect_b32 s26, 0, 0
  s_waitcnt lgkmcnt(0)
  v_pk_add_f32 v[92:93], v[92:93], v[106:107]
  v_pk_add_f32 v[94:95], v[94:95], v[108:109]
  v_pk_add_f32 v[96:97], v[96:97], v[110:111]
  v_pk_add_f32 v[98:99], v[98:99], v[112:113]
  v_pk_add_f32 v[100:101], v[100:101], v[114:115]
  v_pk_add_f32 v[102:103], v[102:103], v[116:117]
  v_pk_add_f32 v[104:105], v[104:105], v[118:119]
  v_pk_add_f32 v[92:93], v[92:93], v[100:101]
  v_pk_add_f32 v[94:95], v[94:95], v[102:103]
  v_pk_add_f32 v[96:97], v[96:97], v[104:105]
  v_pk_add_f32 v[92:93], v[92:93], v[96:97]
  v_pk_add_f32 v[94:95], v[94:95], v[98:99]
  v_pk_add_f32 v[92:93], v[92:93], v[94:95]
  v_add_f32 v92, v92, v93
  v_add_u32_e64 v93, s69, 3
  v_add_f32 v92, s26, v92
  buffer_store_dwordx2 v[92:93], v23, s[16:19], s25 offen sc1
AX_SB_B:
  s_branch AX_NOWD
AX_WD:
  s_sub_u32 s7, s6, 4
  s_lshl_b32 s25, s7, 6
  s_lshl_b32 s26, s4, 3
  s_add_u32 s25, s25, s26
  s_mul_i32 s25, s25, 896
  s_mul_i32 s26, s4, 7680
  s_mov_b32 exec_hi, 0x00ffffff
  s_add_u32 m0, s26, 16384
  s_nop 0
  buffer_load_dwordx4 v6, s[44:47], s25 offen offset:0 nt lds
  s_add_u32 m0, s26, 16448
  s_nop 0
  buffer_load_dwordx4 v6, s[44:47], s25 offen offset:896 nt lds
  s_add_u32 m0, s26, 16512
  s_nop 0
  buffer_load_dwordx4 v6, s[44:47], s25 offen offset:1792 nt lds
  s_add_u32 m0, s26, 16576
  s_nop 0
  buffer_load_dwordx4 v6, s[44:47], s25 offen offset:2688 nt lds
  s_mov_b64 exec, -1
AX_NOWD:
  s_min_u32 s25, s4, 6
  v_and_b32 v8, 31, v2
  v_lshlrev_b32 v8, 6, v8
  s_lshl_b32 s42, s25, 11
  s_add_u32 s42, s42, 40960
  s_lshl_b32 s25, s25, 12
  s_mul_i32 s40, s2, 28928
  s_add_u32 s40, s40, s25
  s_add_u32 s40, s40, 147456
  s_lshr_b32 s46, s25, 2
  s_add_u32 s46, s46, 118784
  v_lshrrev_b32 v12, 2, v2
  v_lshlrev_b32 v12, 4, v12
  buffer_load_dwordx4 v[40:43], v12, s[16:19], s46 offen offset:0 sc1
  buffer_load_dwordx4 v[44:47], v12, s[16:19], s46 offen offset:256 sc1
  buffer_load_dwordx4 v[48:51], v12, s[16:19], s46 offen offset:512 sc1
  buffer_load_dwordx4 v[52:55], v12, s[16:19], s46 offen offset:768 sc1
  s_lshl_b32 s43, s2, 8
  s_add_u32 s43, s43, 73728
  v_and_b32 v7, 3, v2
  v_lshrrev_b32 v9, 4, v2
  s_lshl_b32 s25, s4, 2
  v_add_u32 v9, s25, v9
  v_lshlrev_b32 v9, 8, v9
  v_lshl_add_u32 v9, v7, 5, v9
  v_add_u32 v9, 81920, v9
  v_add_u32 v10, 81920, v21
  s_mov_b32 s28, 0x000f000f
  s_mov_b32 s29, 0x000f000f
  v_bfe_u32 v5, v2, 4, 1
  v_bfe_u32 v7, v2, 2, 2
  v_lshl_add_u32 v4, v3, 2, v7
  v_mul_u32_u24 v4, 960, v4
  v_lshl_add_u32 v4, v5, 5, v4
  v_and_b32 v7, 3, v2
  v_lshl_add_u32 v4, v7, 3, v4
  s_lshr_b32 s24, s4, 1
  s_and_b32 s27, s4, 1
  s_mul_i32 s25, s24, 15360
  s_mul_i32 s26, s27, 448
  s_add_u32 s25, s25, s26
  v_add_u32 v4, s25, v4
  s_lshl_b32 s25, s7, 2
  s_add_u32 s25, s25, s24
  s_lshl_b32 s25, s25, 10
  s_mul_i32 s26, s27, 802816
  s_add_u32 s25, s25, s26
  s_add_u32 s25, s25, 5898240
  s_mov_b32 s24, s25
  s_waitcnt vmcnt(0)
  s_barrier
  v_subrev_u32 v41, s69, v41
  v_subrev_u32 v43, s69, v43
  v_subrev_u32 v45, s69, v45
  v_subrev_u32 v47, s69, v47
  v_subrev_u32 v49, s69, v49
  v_subrev_u32 v51, s69, v51
  v_subrev_u32 v53, s69, v53
  v_subrev_u32 v55, s69, v55
  v_max3_u32 v41, v41, v43, v45
  v_max3_u32 v47, v47, v49, v51
  v_max_u32 v53, v53, v55
  v_max3_u32 v41, v41, v47, v53
  v_cmp_lt_u32 vcc, 16, v41
  s_cbranch_vccnz AJ_SLOW0
AJ_RET0:
  v_add_f32 v40, v40, v42
  v_add_f32 v41, v44, v46
  v_add_f32 v42, v48, v50
  v_add_f32 v43, v52, v54
  v_cvt_pk_bf16_f32 v40, 0, v40
  v_cvt_pk_bf16_f32 v41, 0, v41
  v_cvt_pk_bf16_f32 v42, 0, v42
  v_cvt_pk_bf16_f32 v43, 0, v43
  v_add_f32 v40, 0x2b800000, v40
  v_add_f32 v41, 0x2b800000, v41
  v_add_f32 v42, 0x2b800000, v42
  v_add_f32 v43, 0x2b800000, v43
  v_rcp_f32 v40, v40
  v_rcp_f32 v41, v41
  v_rcp_f32 v42, v42
  v_rcp_f32 v43, v43
  s_cmp_lt_u32 s6, 4
  s_cbranch_scc0 AX_ST
  s_waitcnt vmcnt(0)
  s_sleep 24
  s_branch AX_NOST2
AX_ST:
  ds_read_b64_tr_b16 v[100:101], v4 offset:16384
  ds_read_b64_tr_b16 v[102:103], v4 offset:24064
  ds_read_b64_tr_b16 v[104:105], v4 offset:16448
  ds_read_b64_tr_b16 v[106:107], v4 offset:24128
  ds_read_b64_tr_b16 v[108:109], v4 offset:16512
  ds_read_b64_tr_b16 v[110:111], v4 offset:24192
  ds_read_b64_tr_b16 v[112:113], v4 offset:16576
  ds_read_b64_tr_b16 v[114:115], v4 offset:24256
  ds_read_b64_tr_b16 v[116:117], v4 offset:16640
  ds_read_b64_tr_b16 v[118:119], v4 offset:24320
  ds_read_b64_tr_b16 v[120:121], v4 offset:16704
  ds_read_b64_tr_b16 v[122:123], v4 offset:24384
  ds_read_b64_tr_b16 v[124:125], v4 offset:16768
  ds_read_b64_tr_b16 v[126:127], v4 offset:24448
  s_waitcnt lgkmcnt(12)
  buffer_store_dwordx4 v[100:103], v6, s[16:19], s24 offen sc1
  s_add_u32 s24, s24, 114688
  s_waitcnt lgkmcnt(10)
  buffer_store_dwordx4 v[104:107], v6, s[16:19], s24 offen sc1
  s_add_u32 s24, s24, 114688
  s_waitcnt lgkmcnt(8)
  buffer_store_dwordx4 v[108:111], v6, s[16:19], s24 offen sc1
  s_add_u32 s24, s24, 114688
  s_waitcnt lgkmcnt(6)
  buffer_store_dwordx4 v[112:115], v6, s[16:19], s24 offen sc1
  s_add_u32 s24, s24, 114688
  s_waitcnt lgkmcnt(4)
  buffer_store_dwordx4 v[116:119], v6, s[16:19], s24 offen sc1
  s_add_u32 s24, s24, 114688
  s_waitcnt lgkmcnt(2)
  buffer_store_dwordx4 v[120:123], v6, s[16:19], s24 offen sc1
  s_add_u32 s24, s24, 114688
  s_waitcnt lgkmcnt(0)
  buffer_store_dwordx4 v[124:127], v6, s[16:19], s24 offen sc1
AX_NOST2:
  s_load_dwordx8 s[48:55], s[64:65], 128
  s_lshl_b32 s8, s68, 1
  s_sub_u32 s8, s8, 1600
  s_waitcnt lgkmcnt(0)
  s_sub_u32 s48, s48, s8
  s_cmp_gt_u32 s48, 3200
  s_cselect_b32 s48, 0, s48
  s_sub_u32 s49, s49, s8
  s_cmp_gt_u32 s49, 3200
  s_cselect_b32 s49, 0, s49
  s_sub_u32 s50, s50, s8
  s_cmp_gt_u32 s50, 3200
  s_cselect_b32 s50, 0, s50
  s_sub_u32 s51, s51, s8
  s_cmp_gt_u32 s51, 3200
  s_cselect_b32 s51, 0, s51
  s_sub_u32 s52, s52, s8
  s_cmp_gt_u32 s52, 3200
  s_cselect_b32 s52, 0, s52
  s_sub_u32 s53, s53, s8
  s_cmp_gt_u32 s53, 3200
  s_cselect_b32 s53, 0, s53
  s_sub_u32 s54, s54, s8
  s_cmp_gt_u32 s54, 3200
  s_cselect_b32 s54, 0, s54
  s_sub_u32 s55, s55, s8
  s_cmp_gt_u32 s55, 3200
  s_cselect_b32 s55, 0, s55
  s_max_u32 s48, s48, s49
  s_max_u32 s48, s48, s50
  s_max_u32 s48, s48, s51
  s_max_u32 s48, s48, s52
  s_max_u32 s48, s48, s53
  s_max_u32 s48, s48, s54
  s_max_u32 s48, s48, s55
  s_add_u32 s48, s48, s8
  s_cmp_lt_u32 s2, 16
  s_cselect_b32 s49, 880, 0
  s_cselect_b32 s50, 0, 880
  s_add_u32 s49, s49, s50
AX_U:
  s_memrealtime s[70:71]
  s_waitcnt lgkmcnt(0)
  s_lshl_b32 s70, s70, 1
  s_sub_u32 s70, s70, s48
  s_cmp_lt_i32 s70, s49
  s_cbranch_scc1 AX_U
  buffer_load_dword v11, v8, s[16:19], s42 offen sc1
  s_waitcnt vmcnt(1)
  s_barrier
  s_cmp_lg_u32 s4, 7
  s_cbranch_scc1 AX_F0
  s_cmp_lt_u32 s6, 4
  s_cbranch_scc1 AX_K0
  s_lshl_b32 s25, s7, 6
  s_add_u32 s25, s25, 55296
  v_add_u32_e64 v30, s69, 3
  s_mov_b64 exec, 1
  buffer_store_dword v30, off, s[16:19], s25 sc1
  s_mov_b64 exec, -1
  s_branch AX_K0
AX_F0:
  s_waitcnt vmcnt(0)
  v_subrev_u32 v11, s69, v11
  v_cmp_lt_u32 vcc, 16, v11
  s_cbranch_vccnz AJ_SLOW1
AJ_RET1:
  s_cmp_lt_u32 s2, 16
  s_cselect_b32 s49, 1200, 0
  s_cselect_b32 s50, 0, 1320
  s_add_u32 s49, s49, s50
AX_U0:
  s_memrealtime s[70:71]
  s_waitcnt lgkmcnt(0)
  s_lshl_b32 s70, s70, 1
  s_sub_u32 s70, s70, s48
  s_cmp_lt_i32 s70, s49
  s_cbranch_scc1 AX_U0
  buffer_load_dwordx4 v[64:67], v6, s[16:19], s40 offen offset:0 sc1
  buffer_load_dwordx4 v[68:71], v6, s[16:19], s40 offen offset:1024 sc1
  buffer_load_dwordx4 v[72:75], v6, s[16:19], s40 offen offset:2048 sc1
  buffer_load_dwordx4 v[76:79], v6, s[16:19], s40 offen offset:3072 sc1
  s_waitcnt vmcnt(0)
  v_max3_u32 v96, v64, v65, v66
  v_max3_u32 v97, v67, v68, v69
  v_max3_u32 v98, v70, v71, v72
  v_max3_u32 v99, v73, v74, v75
  v_max3_u32 v100, v76, v77, v78
  v_max3_u32 v96, v96, v97, v98
  v_max3_u32 v99, v99, v100, v79
  v_max_u32 v96, v96, v99
  v_cmp_eq_u32 vcc, -1, v96
  s_cbranch_vccnz AJ_SLOW2
AJ_RET2:
  v_lshlrev_b32 v80, 16, v64
  v_and_b32 v81, 0xffff0000, v64
  v_lshlrev_b32 v82, 16, v65
  v_and_b32 v83, 0xffff0000, v65
  v_lshlrev_b32 v84, 16, v66
  v_and_b32 v85, 0xffff0000, v66
  v_lshlrev_b32 v86, 16, v67
  v_and_b32 v87, 0xffff0000, v67
  v_pk_mul_f32 v[80:81], v[80:81], v[40:41] op_sel:[0,0] op_sel_hi:[1,0]
  v_pk_mul_f32 v[82:83], v[82:83], v[40:41] op_sel:[0,0] op_sel_hi:[1,0]
  v_pk_mul_f32 v[84:85], v[84:85], v[40:41] op_sel:[0,0] op_sel_hi:[1,0]
  v_pk_mul_f32 v[86:87], v[86:87], v[40:41] op_sel:[0,0] op_sel_hi:[1,0]
  v_pk_mul_f32 v[88:89], v[80:81], v[80:81]
  v_pk_mul_f32 v[90:91], v[82:83], v[82:83]
  v_pk_mul_f32 v[92:93], v[84:85], v[84:85]
  v_pk_mul_f32 v[94:95], v[86:87], v[86:87]
  v_lshlrev_b32 v104, 16, v68
  v_and_b32 v105, 0xffff0000, v68
  v_lshlrev_b32 v106, 16, v69
  v_and_b32 v107, 0xffff0000, v69
  v_lshlrev_b32 v108, 16, v70
  v_and_b32 v109, 0xffff0000, v70
  v_lshlrev_b32 v110, 16, v71
  v_and_b32 v111, 0xffff0000, v71
  v_pk_mul_f32 v[104:105], v[104:105], v[40:41] op_sel:[0,1] op_sel_hi:[1,1]
  v_pk_mul_f32 v[106:107], v[106:107], v[40:41] op_sel:[0,1] op_sel_hi:[1,1]
  v_pk_mul_f32 v[108:109], v[108:109], v[40:41] op_sel:[0,1] op_sel_hi:[1,1]
  v_pk_mul_f32 v[110:111], v[110:111], v[40:41] op_sel:[0,1] op_sel_hi:[1,1]
  v_pk_add_f32 v[80:81], v[80:81], v[104:105]
  v_pk_fma_f32 v[88:89], v[104:105], v[104:105], v[88:89]
  v_pk_add_f32 v[82:83], v[82:83], v[106:107]
  v_pk_fma_f32 v[90:91], v[106:107], v[106:107], v[90:91]
  v_pk_add_f32 v[84:85], v[84:85], v[108:109]
  v_pk_fma_f32 v[92:93], v[108:109], v[108:109], v[92:93]
  v_pk_add_f32 v[86:87], v[86:87], v[110:111]
  v_pk_fma_f32 v[94:95], v[110:111], v[110:111], v[94:95]
  v_lshlrev_b32 v96, 16, v72
  v_and_b32 v97, 0xffff0000, v72
  v_lshlrev_b32 v98, 16, v73
  v_and_b32 v99, 0xffff0000, v73
  v_lshlrev_b32 v100, 16, v74
  v_and_b32 v101, 0xffff0000, v74
  v_lshlrev_b32 v102, 16, v75
  v_and_b32 v103, 0xffff0000, v75
  v_pk_mul_f32 v[96:97], v[96:97], v[42:43] op_sel:[0,0] op_sel_hi:[1,0]
  v_pk_mul_f32 v[98:99], v[98:99], v[42:43] op_sel:[0,0] op_sel_hi:[1,0]
  v_pk_mul_f32 v[100:101], v[100:101], v[42:43] op_sel:[0,0] op_sel_hi:[1,0]
  v_pk_mul_f32 v[102:103], v[102:103], v[42:43] op_sel:[0,0] op_sel_hi:[1,0]
  v_pk_add_f32 v[80:81], v[80:81], v[96:97]
  v_pk_fma_f32 v[88:89], v[96:97], v[96:97], v[88:89]
  v_pk_add_f32 v[82:83], v[82:83], v[98:99]
  v_pk_fma_f32 v[90:91], v[98:99], v[98:99], v[90:91]
  v_pk_add_f32 v[84:85], v[84:85], v[100:101]
  v_pk_fma_f32 v[92:93], v[100:101], v[100:101], v[92:93]
  v_pk_add_f32 v[86:87], v[86:87], v[102:103]
  v_pk_fma_f32 v[94:95], v[102:103], v[102:103], v[94:95]
  v_lshlrev_b32 v104, 16, v76
  v_and_b32 v105, 0xffff0000, v76
  v_lshlrev_b32 v106, 16, v77
  v_and_b32 v107, 0xffff0000, v77
  v_lshlrev_b32 v108, 16, v78
  v_and_b32 v109, 0xffff0000, v78
  v_lshlrev_b32 v110, 16, v79
  v_and_b32 v111, 0xffff0000, v79
  v_pk_mul_f32 v[104:105], v[104:105], v[42:43] op_sel:[0,1] op_sel_hi:[1,1]
  v_pk_mul_f32 v[106:107], v[106:107], v[42:43] op_sel:[0,1] op_sel_hi:[1,1]
  v_pk_mul_f32 v[108:109], v[108:109], v[42:43] op_sel:[0,1] op_sel_hi:[1,1]
  v_pk_mul_f32 v[110:111], v[110:111], v[42:43] op_sel:[0,1] op_sel_hi:[1,1]
  v_pk_add_f32 v[80:81], v[80:81], v[104:105]
  v_pk_fma_f32 v[88:89], v[104:105], v[104:105], v[88:89]
  v_pk_add_f32 v[82:83], v[82:83], v[106:107]
  v_pk_fma_f32 v[90:91], v[106:107], v[106:107], v[90:91]
  v_pk_add_f32 v[84:85], v[84:85], v[108:109]
  v_pk_fma_f32 v[92:93], v[108:109], v[108:109], v[92:93]
  v_pk_add_f32 v[86:87], v[86:87], v[110:111]
  v_pk_fma_f32 v[94:95], v[110:111], v[110:111], v[94:95]
  v_add_f32_dpp v80, v80, v80 row_ror:4 row_mask:0xf bank_mask:0xf
  v_add_f32_dpp v81, v81, v81 row_ror:4 row_mask:0xf bank_mask:0xf
  v_add_f32_dpp v82, v82, v82 row_ror:4 row_mask:0xf bank_mask:0xf
  v_add_f32_dpp v83, v83, v83 row_ror:4 row_mask:0xf bank_mask:0xf
  v_add_f32_dpp v84, v84, v84 row_ror:4 row_mask:0xf bank_mask:0xf
  v_add_f32_dpp v85, v85, v85 row_ror:4 row_mask:0xf bank_mask:0xf
  v_add_f32_dpp v86, v86, v86 row_ror:4 row_mask:0xf bank_mask:0xf
  v_add_f32_dpp v87, v87, v87 row_ror:4 row_mask:0xf bank_mask:0xf
  v_add_f32_dpp v88, v88, v88 row_ror:4 row_mask:0xf bank_mask:0xf
  v_add_f32_dpp v89, v89, v89 row_ror:4 row_mask:0xf bank_mask:0xf
  v_add_f32_dpp v90, v90, v90 row_ror:4 row_mask:0xf bank_mask:0xf
  v_add_f32_dpp v91, v91, v91 row_ror:4 row_mask:0xf bank_mask:0xf
  v_add_f32_dpp v92, v92, v92 row_ror:4 row_mask:0xf bank_mask:0xf
  v_add_f32_dpp v93, v93, v93 row_ror:4 row_mask:0xf bank_mask:0xf
  v_add_f32_dpp v94, v94, v94 row_ror:4 row_mask:0xf bank_mask:0xf
  v_add_f32_dpp v95, v95, v95 row_ror:4 row_mask:0xf bank_mask:0xf
  v_add_f32_dpp v80, v80, v80 row_ror:8 row_mask:0xf bank_mask:0xf
  v_add_f32_dpp v81, v81, v81 row_ror:8 row_mask:0xf bank_mask:0xf
  v_add_f32_dpp v82, v82, v82 row_ror:8 row_mask:0xf bank_mask:0xf
  v_add_f32_dpp v83, v83, v83 row_ror:8 row_mask:0xf bank_mask:0xf
  v_add_f32_dpp v84, v84, v84 row_ror:8 row_mask:0xf bank_mask:0xf
  v_add_f32_dpp v85, v85, v85 row_ror:8 row_mask:0xf bank_mask:0xf
  v_add_f32_dpp v86, v86, v86 row_ror:8 row_mask:0xf bank_mask:0xf
  v_add_f32_dpp v87, v87, v87 row_ror:8 row_mask:0xf bank_mask:0xf
  v_add_f32_dpp v88, v88, v88 row_ror:8 row_mask:0xf bank_mask:0xf
  v_add_f32_dpp v89, v89, v89 row_ror:8 row_mask:0xf bank_mask:0xf
  v_add_f32_dpp v90, v90, v90 row_ror:8 row_mask:0xf bank_mask:0xf
  v_add_f32_dpp v91, v91, v91 row_ror:8 row_mask:0xf bank_mask:0xf
  v_add_f32_dpp v92, v92, v92 row_ror:8 row_mask:0xf bank_mask:0xf
  v_add_f32_dpp v93, v93, v93 row_ror:8 row_mask:0xf bank_mask:0xf
  v_add_f32_dpp v94, v94, v94 row_ror:8 row_mask:0xf bank_mask:0xf
  v_add_f32_dpp v95, v95, v95 row_ror:8 row_mask:0xf bank_mask:0xf
  s_mov_b64 exec, s[28:29]
  ds_write_b128 v9, v[80:83] offset:0
  ds_write_b128 v9, v[84:87] offset:16
  ds_write_b128 v9, v[88:91] offset:128
  ds_write_b128 v9, v[92:95] offset:144
  s_mov_b64 exec, -1
  s_add_u32 s40, s40, 925696
  s_waitcnt lgkmcnt(0)
AX_K0:
  s_barrier
  s_cmp_lg_u32 s4, 7
  s_cbranch_scc1 AX_L0
  ds_read2st64_b32 v[96:97], v10 offset0:0 offset1:1
  ds_read2st64_b32 v[98:99], v10 offset0:2 offset1:3
  ds_read2st64_b32 v[100:101], v10 offset0:4 offset1:5
  ds_read2st64_b32 v[102:103], v10 offset0:6 offset1:7
  ds_read2st64_b32 v[104:105], v10 offset0:8 offset1:9
  ds_read2st64_b32 v[106:107], v10 offset0:10 offset1:11
  ds_read2st64_b32 v[108:109], v10 offset0:12 offset1:13
  ds_read2st64_b32 v[110:111], v10 offset0:14 offset1:15
  ds_read2st64_b32 v[112:113], v10 offset0:16 offset1:17
  ds_read2st64_b32 v[114:115], v10 offset0:18 offset1:19
  ds_read2st64_b32 v[116:117], v10 offset0:20 offset1:21
  ds_read2st64_b32 v[118:119], v10 offset0:22 offset1:23
  ds_read2st64_b32 v[120:121], v10 offset0:24 offset1:25
  ds_read2st64_b32 v[122:123], v10 offset0:26 offset1:27
  s_waitcnt lgkmcnt(0)
  v_pk_add_f32 v[96:97], v[96:97], v[110:111]
  v_pk_add_f32 v[98:99], v[98:99], v[112:113]
  v_pk_add_f32 v[100:101], v[100:101], v[114:115]
  v_pk_add_f32 v[102:103], v[102:103], v[116:117]
  v_pk_add_f32 v[104:105], v[104:105], v[118:119]
  v_pk_add_f32 v[106:107], v[106:107], v[120:121]
  v_pk_add_f32 v[108:109], v[108:109], v[122:123]
  v_pk_add_f32 v[96:97], v[96:97], v[104:105]
  v_pk_add_f32 v[98:99], v[98:99], v[106:107]
  v_pk_add_f32 v[100:101], v[100:101], v[108:109]
  v_pk_add_f32 v[96:97], v[96:97], v[100:101]
  v_pk_add_f32 v[98:99], v[98:99], v[102:103]
  v_pk_add_f32 v[96:97], v[96:97], v[98:99]
  v_add_f32 v98, v96, v97
  v_mov_b32 v96, v98
  v_add_u32_e64 v97, s69, 3
  s_nop 0
  v_permlane32_swap_b32 v98, v96
  v_mul_f32 v98, 0x3b124925, v98
  v_mul_f32 v96, 0x3b124925, v96
  v_fma_f32 v96, -v98, v98, v96
  v_max_f32 v96, 0, v96
  v_cvt_pk_bf16_f32 v96, 0, v96
  v_add_f32 v96, 0x3727c5ac, v96
  v_cvt_pk_bf16_f32 v96, 0, v96
  v_sqrt_f32 v96, v96
  s_nop 0
  v_cvt_pk_bf16_f32 v96, v96, v98
  s_mov_b32 exec_hi, 0
  buffer_store_dwordx2 v[96:97], v22, s[16:19], s43 offen sc1
  s_mov_b64 exec, -1
AX_L0:
  s_add_u32 s43, s43, 8192
  s_cmp_eq_u32 s4, 7
  s_cbranch_scc1 AX_K1
  s_sleep 0
  s_cmp_lt_u32 s2, 16
  s_cselect_b32 s49, 1440, 0
  s_cselect_b32 s50, 0, 1620
  s_add_u32 s49, s49, s50
AX_U1:
  s_memrealtime s[70:71]
  s_waitcnt lgkmcnt(0)
  s_lshl_b32 s70, s70, 1
  s_sub_u32 s70, s70, s48
  s_cmp_lt_i32 s70, s49
  s_cbranch_scc1 AX_U1
  buffer_load_dwordx4 v[64:67], v6, s[16:19], s40 offen offset:0 sc1
  buffer_load_dwordx4 v[68:71], v6, s[16:19], s40 offen offset:1024 sc1
  buffer_load_dwordx4 v[72:75], v6, s[16:19], s40 offen offset:2048 sc1
  buffer_load_dwordx4 v[76:79], v6, s[16:19], s40 offen offset:3072 sc1
  s_waitcnt vmcnt(0)
  v_max3_u32 v96, v64, v65, v66
  v_max3_u32 v97, v67, v68, v69
  v_max3_u32 v98, v70, v71, v72
  v_max3_u32 v99, v73, v74, v75
  v_max3_u32 v100, v76, v77, v78
  v_max3_u32 v96, v96, v97, v98
  v_max3_u32 v99, v99, v100, v79
  v_max_u32 v96, v96, v99
  v_cmp_eq_u32 vcc, -1, v96
  s_cbranch_vccnz AJ_SLOW3
AJ_RET3:
  v_lshlrev_b32 v80, 16, v64
  v_and_b32 v81, 0xffff0000, v64
  v_lshlrev_b32 v82, 16, v65
  v_and_b32 v83, 0xffff0000, v65
  v_lshlrev_b32 v84, 16, v66
  v_and_b32 v85, 0xffff0000, v66
  v_lshlrev_b32 v86, 16, v67
  v_and_b32 v87, 0xffff0000, v67
  v_pk_mul_f32 v[80:81], v[80:81], v[40:41] op_sel:[0,0] op_sel_hi:[1,0]
  v_pk_mul_f32 v[82:83], v[82:83], v[40:41] op_sel:[0,0] op_sel_hi:[1,0]
  v_pk_mul_f32 v[84:85], v[84:85], v[40:41] op_sel:[0,0] op_sel_hi:[1,0]
  v_pk_mul_f32 v[86:87], v[86:87], v[40:41] op_sel:[0,0] op_sel_hi:[1,0]
  v_pk_mul_f32 v[88:89], v[80:81], v[80:81]
  v_pk_mul_f32 v[90:91], v[82:83], v[82:83]
  v_pk_mul_f32 v[92:93], v[84:85], v[84:85]
  v_pk_mul_f32 v[94:95], v[86:87], v[86:87]
  v_lshlrev_b32 v104, 16, v68
  v_and_b32 v105, 0xffff0000, v68
  v_lshlrev_b32 v106, 16, v69
  v_and_b32 v107, 0xffff0000, v69
  v_lshlrev_b32 v108, 16, v70
  v_and_b32 v109, 0xffff0000, v70
  v_lshlrev_b32 v110, 16, v71
  v_and_b32 v111, 0xffff0000, v71
  v_pk_mul_f32 v[104:105], v[104:105], v[40:41] op_sel:[0,1] op_sel_hi:[1,1]
  v_pk_mul_f32 v[106:107], v[106:107], v[40:41] op_sel:[0,1] op_sel_hi:[1,1]
  v_pk_mul_f32 v[108:109], v[108:109], v[40:41] op_sel:[0,1] op_sel_hi:[1,1]
  v_pk_mul_f32 v[110:111], v[110:111], v[40:41] op_sel:[0,1] op_sel_hi:[1,1]
  v_pk_add_f32 v[80:81], v[80:81], v[104:105]
  v_pk_fma_f32 v[88:89], v[104:105], v[104:105], v[88:89]
  v_pk_add_f32 v[82:83], v[82:83], v[106:107]
  v_pk_fma_f32 v[90:91], v[106:107], v[106:107], v[90:91]
  v_pk_add_f32 v[84:85], v[84:85], v[108:109]
  v_pk_fma_f32 v[92:93], v[108:109], v[108:109], v[92:93]
  v_pk_add_f32 v[86:87], v[86:87], v[110:111]
  v_pk_fma_f32 v[94:95], v[110:111], v[110:111], v[94:95]
  v_lshlrev_b32 v96, 16, v72
  v_and_b32 v97, 0xffff0000, v72
  v_lshlrev_b32 v98, 16, v73
  v_and_b32 v99, 0xffff0000, v73
  v_lshlrev_b32 v100, 16, v74
  v_and_b32 v101, 0xffff0000, v74
  v_lshlrev_b32 v102, 16, v75
  v_and_b32 v103, 0xffff0000, v75
  v_pk_mul_f32 v[96:97], v[96:97], v[42:43] op_sel:[0,0] op_sel_hi:[1,0]
  v_pk_mul_f32 v[98:99], v[98:99], v[42:43] op_sel:[0,0] op_sel_hi:[1,0]
  v_pk_mul_f32 v[100:101], v[100:101], v[42:43] op_sel:[0,0] op_sel_hi:[1,0]
  v_pk_mul_f32 v[102:103], v[102:103], v[42:43] op_sel:[0,0] op_sel_hi:[1,0]
  v_pk_add_f32 v[80:81], v[80:81], v[96:97]
  v_pk_fma_f32 v[88:89], v[96:97], v[96:97], v[88:89]
  v_pk_add_f32 v[82:83], v[82:83], v[98:99]
  v_pk_fma_f32 v[90:91], v[98:99], v[98:99], v[90:91]
  v_pk_add_f32 v[84:85], v[84:85], v[100:101]
  v_pk_fma_f32 v[92:93], v[100:101], v[100:101], v[92:93]
  v_pk_add_f32 v[86:87], v[86:87], v[102:103]
  v_pk_fma_f32 v[94:95], v[102:103], v[102:103], v[94:95]
  v_lshlrev_b32 v104, 16, v76
  v_and_b32 v105, 0xffff0000, v76
  v_lshlrev_b32 v106, 16, v77
  v_and_b32 v107, 0xffff0000, v77
  v_lshlrev_b32 v108, 16, v78
  v_and_b32 v109, 0xffff0000, v78
  v_lshlrev_b32 v110, 16, v79
  v_and_b32 v111, 0xffff0000, v79
  v_pk_mul_f32 v[104:105], v[104:105], v[42:43] op_sel:[0,1] op_sel_hi:[1,1]
  v_pk_mul_f32 v[106:107], v[106:107], v[42:43] op_sel:[0,1] op_sel_hi:[1,1]
  v_pk_mul_f32 v[108:109], v[108:109], v[42:43] op_sel:[0,1] op_sel_hi:[1,1]
  v_pk_mul_f32 v[110:111], v[110:111], v[42:43] op_sel:[0,1] op_sel_hi:[1,1]
  v_pk_add_f32 v[80:81], v[80:81], v[104:105]
  v_pk_fma_f32 v[88:89], v[104:105], v[104:105], v[88:89]
  v_pk_add_f32 v[82:83], v[82:83], v[106:107]
  v_pk_fma_f32 v[90:91], v[106:107], v[106:107], v[90:91]
  v_pk_add_f32 v[84:85], v[84:85], v[108:109]
  v_pk_fma_f32 v[92:93], v[108:109], v[108:109], v[92:93]
  v_pk_add_f32 v[86:87], v[86:87], v[110:111]
  v_pk_fma_f32 v[94:95], v[110:111], v[110:111], v[94:95]
  v_add_f32_dpp v80, v80, v80 row_ror:4 row_mask:0xf bank_mask:0xf
  v_add_f32_dpp v81, v81, v81 row_ror:4 row_mask:0xf bank_mask:0xf
  v_add_f32_dpp v82, v82, v82 row_ror:4 row_mask:0xf bank_mask:0xf
  v_add_f32_dpp v83, v83, v83 row_ror:4 row_mask:0xf bank_mask:0xf
  v_add_f32_dpp v84, v84, v84 row_ror:4 row_mask:0xf bank_mask:0xf
  v_add_f32_dpp v85, v85, v85 row_ror:4 row_mask:0xf bank_mask:0xf
  v_add_f32_dpp v86, v86, v86 row_ror:4 row_mask:0xf bank_mask:0xf
  v_add_f32_dpp v87, v87, v87 row_ror:4 row_mask:0xf bank_mask:0xf
  v_add_f32_dpp v88, v88, v88 row_ror:4 row_mask:0xf bank_mask:0xf
  v_add_f32_dpp v89, v89, v89 row_ror:4 row_mask:0xf bank_mask:0xf
  v_add_f32_dpp v90, v90, v90 row_ror:4 row_mask:0xf bank_mask:0xf
  v_add_f32_dpp v91, v91, v91 row_ror:4 row_mask:0xf bank_mask:0xf
  v_add_f32_dpp v92, v92, v92 row_ror:4 row_mask:0xf bank_mask:0xf
  v_add_f32_dpp v93, v93, v93 row_ror:4 row_mask:0xf bank_mask:0xf
  v_add_f32_dpp v94, v94, v94 row_ror:4 row_mask:0xf bank_mask:0xf
  v_add_f32_dpp v95, v95, v95 row_ror:4 row_mask:0xf bank_mask:0xf
  v_add_f32_dpp v80, v80, v80 row_ror:8 row_mask:0xf bank_mask:0xf
  v_add_f32_dpp v81, v81, v81 row_ror:8 row_mask:0xf bank_mask:0xf
  v_add_f32_dpp v82, v82, v82 row_ror:8 row_mask:0xf bank_mask:0xf
  v_add_f32_dpp v83, v83, v83 row_ror:8 row_mask:0xf bank_mask:0xf
  v_add_f32_dpp v84, v84, v84 row_ror:8 row_mask:0xf bank_mask:0xf
  v_add_f32_dpp v85, v85, v85 row_ror:8 row_mask:0xf bank_mask:0xf
  v_add_f32_dpp v86, v86, v86 row_ror:8 row_mask:0xf bank_mask:0xf
  v_add_f32_dpp v87, v87, v87 row_ror:8 row_mask:0xf bank_mask:0xf
  v_add_f32_dpp v88, v88, v88 row_ror:8 row_mask:0xf bank_mask:0xf
  v_add_f32_dpp v89, v89, v89 row_ror:8 row_mask:0xf bank_mask:0xf
  v_add_f32_dpp v90, v90, v90 row_ror:8 row_mask:0xf bank_mask:0xf
  v_add_f32_dpp v91, v91, v91 row_ror:8 row_mask:0xf bank_mask:0xf
  v_add_f32_dpp v92, v92, v92 row_ror:8 row_mask:0xf bank_mask:0xf
  v_add_f32_dpp v93, v93, v93 row_ror:8 row_mask:0xf bank_mask:0xf
  v_add_f32_dpp v94, v94, v94 row_ror:8 row_mask:0xf bank_mask:0xf
  v_add_f32_dpp v95, v95, v95 row_ror:8 row_mask:0xf bank_mask:0xf
  s_mov_b64 exec, s[28:29]
  ds_write_b128 v9, v[80:83] offset:8192
  ds_write_b128 v9, v[84:87] offset:8208
  ds_write_b128 v9, v[88:91] offset:8320
  ds_write_b128 v9, v[92:95] offset:8336
  s_mov_b64 exec, -1
  s_add_u32 s40, s40, 925696
  s_waitcnt lgkmcnt(0)
AX_K1:
  s_barrier
  s_cmp_lg_u32 s4, 7
  s_cbranch_scc1 AX_L1
  ds_read2st64_b32 v[96:97], v10 offset0:32 offset1:33
  ds_read2st64_b32 v[98:99], v10 offset0:34 offset1:35
  ds_read2st64_b32 v[100:101], v10 offset0:36 offset1:37
  ds_read2st64_b32 v[102:103], v10 offset0:38 offset1:39
  ds_read2st64_b32 v[104:105], v10 offset0:40 offset1:41
  ds_read2st64_b32 v[106:107], v10 offset0:42 offset1:43
  ds_read2st64_b32 v[108:109], v10 offset0:44 offset1:45
  ds_read2st64_b32 v[110:111], v10 offset0:46 offset1:47
  ds_read2st64_b32 v[112:113], v10 offset0:48 offset1:49
  ds_read2st64_b32 v[114:115], v10 offset0:50 offset1:51
  ds_read2st64_b32 v[116:117], v10 offset0:52 offset1:53
  ds_read2st64_b32 v[118:119], v10 offset0:54 offset1:55
  ds_read2st64_b32 v[120:121], v10 offset0:56 offset1:57
  ds_read2st64_b32 v[122:123], v10 offset0:58 offset1:59
  s_waitcnt lgkmcnt(0)
  v_pk_add_f32 v[96:97], v[96:97], v[110:111]
  v_pk_add_f32 v[98:99], v[98:99], v[112:113]
  v_pk_add_f32 v[100:101], v[100:101], v[114:115]
  v_pk_add_f32 v[102:103], v[102:103], v[116:117]
  v_pk_add_f32 v[104:105], v[104:105], v[118:119]
  v_pk_add_f32 v[106:107], v[106:107], v[120:121]
  v_pk_add_f32 v[108:109], v[108:109], v[122:123]
  v_pk_add_f32 v[96:97], v[96:97], v[104:105]
  v_pk_add_f32 v[98:99], v[98:99], v[106:107]
  v_pk_add_f32 v[100:101], v[100:101], v[108:109]
  v_pk_add_f32 v[96:97], v[96:97], v[100:101]
  v_pk_add_f32 v[98:99], v[98:99], v[102:103]
  v_pk_add_f32 v[96:97], v[96:97], v[98:99]
  v_add_f32 v98, v96, v97
  v_mov_b32 v96, v98
  v_add_u32_e64 v97, s69, 3
  s_nop 0
  v_permlane32_swap_b32 v98, v96
  v_mul_f32 v98, 0x3b124925, v98
  v_mul_f32 v96, 0x3b124925, v96
  v_fma_f32 v96, -v98, v98, v96
  v_max_f32 v96, 0, v96
  v_cvt_pk_bf16_f32 v96, 0, v96
  v_add_f32 v96, 0x3727c5ac, v96
  v_cvt_pk_bf16_f32 v96, 0, v96
  v_sqrt_f32 v96, v96
  s_nop 0
  v_cvt_pk_bf16_f32 v96, v96, v98
  s_mov_b32 exec_hi, 0
  buffer_store_dwordx2 v[96:97], v22, s[16:19], s43 offen sc1
  s_mov_b64 exec, -1
AX_L1:
  s_add_u32 s43, s43, 8192
  s_cmp_lt_u32 s6, 8
  s_cbranch_scc0 AX_GB_B
  s_and_b32 s40, s6, 6
  s_min_u32 s40, s40, 5
  s_lshl_b32 s40, s40, 7
  s_add_u32 s40, s40, 4480
  s_add_u32 s41, s40, 128
  s_mov_b32 s28, 0x00ff00ff
  s_mov_b32 s29, 0x00ff00ff
  s_cmp_eq_u32 s4, 7
  s_cbranch_scc1 AX_GB_A
  s_add_u32 s25, s40, 0
  buffer_load_dwordx4 v[96:99], v18, s[12:15], s25 offen nt
  s_add_u32 s25, s40, 5376
  buffer_load_dwordx4 v[100:103], v18, s[12:15], s25 offen nt
  s_add_u32 s25, s40, 10752
  buffer_load_dwordx4 v[104:107], v18, s[12:15], s25 offen nt
  s_add_u32 s25, s40, 16128
  buffer_load_dwordx4 v[108:111], v18, s[12:15], s25 offen nt
  s_add_u32 s25, s41, 0
  buffer_load_dwordx4 v[112:115], v18, s[12:15], s25 offen nt
  s_add_u32 s25, s41, 5376
  buffer_load_dwordx4 v[116:119], v18, s[12:15], s25 offen nt
  s_add_u32 s25, s41, 10752
  buffer_load_dwordx4 v[120:123], v18, s[12:15], s25 offen nt
  s_add_u32 s25, s41, 16128
  buffer_load_dwordx4 v[124:127], v18, s[12:15], s25 offen nt
  s_waitcnt vmcnt(7)
  v_lshlrev_b32 v80, 16, v96
  v_and_b32 v81, 0xffff0000, v96
  v_lshlrev_b32 v82, 16, v97
  v_and_b32 v83, 0xffff0000, v97
  v_lshlrev_b32 v84, 16, v98
  v_and_b32 v85, 0xffff0000, v98
  v_lshlrev_b32 v86, 16, v99
  v_and_b32 v87, 0xffff0000, v99
  v_mul_f32 v40, v80, v32
  v_mul_f32 v41, v81, v32
  v_mul_f32 v42, v82, v32
  v_mul_f32 v43, v83, v32
  v_mul_f32 v44, v84, v32
  v_mul_f32 v45, v85, v32
  v_mul_f32 v46, v86, v32
  v_mul_f32 v47, v87, v32
  s_waitcnt vmcnt(6)
  v_lshlrev_b32 v88, 16, v100
  v_and_b32 v89, 0xffff0000, v100
  v_lshlrev_b32 v90, 16, v101
  v_and_b32 v91, 0xffff0000, v101
  v_lshlrev_b32 v92, 16, v102
  v_and_b32 v93, 0xffff0000, v102
  v_lshlrev_b32 v94, 16, v103
  v_and_b32 v95, 0xffff0000, v103
  v_fmac_f32 v40, v88, v33
  v_fmac_f32 v41, v89, v33
  v_fmac_f32 v42, v90, v33
  v_fmac_f32 v43, v91, v33
  v_fmac_f32 v44, v92, v33
  v_fmac_f32 v45, v93, v33
  v_fmac_f32 v46, v94, v33
  v_fmac_f32 v47, v95, v33
  s_waitcnt vmcnt(5)
  v_lshlrev_b32 v80, 16, v104
  v_and_b32 v81, 0xffff0000, v104
  v_lshlrev_b32 v82, 16, v105
  v_and_b32 v83, 0xffff0000, v105
  v_lshlrev_b32 v84, 16, v106
  v_and_b32 v85, 0xffff0000, v106
  v_lshlrev_b32 v86, 16, v107
  v_and_b32 v87, 0xffff0000, v107
  v_fmac_f32 v40, v80, v34
  v_fmac_f32 v41, v81, v34
  v_fmac_f32 v42, v82, v34
  v_fmac_f32 v43, v83, v34
  v_fmac_f32 v44, v84, v34
  v_fmac_f32 v45, v85, v34
  v_fmac_f32 v46, v86, v34
  v_fmac_f32 v47, v87, v34
  s_waitcnt vmcnt(4)
  v_lshlrev_b32 v88, 16, v108
  v_and_b32 v89, 0xffff0000, v108
  v_lshlrev_b32 v90, 16, v109
  v_and_b32 v91, 0xffff0000, v109
  v_lshlrev_b32 v92, 16, v110
  v_and_b32 v93, 0xffff0000, v110
  v_lshlrev_b32 v94, 16, v111
  v_and_b32 v95, 0xffff0000, v111
  v_fmac_f32 v40, v88, v35
  v_fmac_f32 v41, v89, v35
  v_fmac_f32 v42, v90, v35
  v_fmac_f32 v43, v91, v35
  v_fmac_f32 v44, v92, v35
  v_fmac_f32 v45, v93, v35
  v_fmac_f32 v46, v94, v35
  v_fmac_f32 v47, v95, v35
  v_add_f32_dpp v40, v40, v40 row_ror:8 row_mask:0xf bank_mask:0xf
  v_add_f32_dpp v41, v41, v41 row_ror:8 row_mask:0xf bank_mask:0xf
  v_add_f32_dpp v42, v42, v42 row_ror:8 row_mask:0xf bank_mask:0xf
  v_add_f32_dpp v43, v43, v43 row_ror:8 row_mask:0xf bank_mask:0xf
  v_add_f32_dpp v44, v44, v44 row_ror:8 row_mask:0xf bank_mask:0xf
  v_add_f32_dpp v45, v45, v45 row_ror:8 row_mask:0xf bank_mask:0xf
  v_add_f32_dpp v46, v46, v46 row_ror:8 row_mask:0xf bank_mask:0xf
  v_add_f32_dpp v47, v47, v47 row_ror:8 row_mask:0xf bank_mask:0xf
  s_mov_b64 exec, s[28:29]
  ds_write_b128 v20, v[40:43] offset:0
  ds_write_b128 v20, v[44:47] offset:16
  s_mov_b64 exec, -1
  s_waitcnt lgkmcnt(0)
  s_waitcnt vmcnt(3)
  v_lshlrev_b32 v80, 16, v112
  v_and_b32 v81, 0xffff0000, v112
  v_lshlrev_b32 v82, 16, v113
  v_and_b32 v83, 0xffff0000, v113
  v_lshlrev_b32 v84, 16, v114
  v_and_b32 v85, 0xffff0000, v114
  v_lshlrev_b32 v86, 16, v115
  v_and_b32 v87, 0xffff0000, v115
  v_mul_f32 v40, v80, v32
  v_mul_f32 v41, v81, v32
  v_mul_f32 v42, v82, v32
  v_mul_f32 v43, v83, v32
  v_mul_f32 v44, v84, v32
  v_mul_f32 v45, v85, v32
  v_mul_f32 v46, v86, v32
  v_mul_f32 v47, v87, v32
  s_waitcnt vmcnt(2)
  v_lshlrev_b32 v88, 16, v116
  v_and_b32 v89, 0xffff0000, v116
  v_lshlrev_b32 v90, 16, v117
  v_and_b32 v91, 0xffff0000, v117
  v_lshlrev_b32 v92, 16, v118
  v_and_b32 v93, 0xffff0000, v118
  v_lshlrev_b32 v94, 16, v119
  v_and_b32 v95, 0xffff0000, v119
  v_fmac_f32 v40, v88, v33
  v_fmac_f32 v41, v89, v33
  v_fmac_f32 v42, v90, v33
  v_fmac_f32 v43, v91, v33
  v_fmac_f32 v44, v92, v33
  v_fmac_f32 v45, v93, v33
  v_fmac_f32 v46, v94, v33
  v_fmac_f32 v47, v95, v33
  s_waitcnt vmcnt(1)
  v_lshlrev_b32 v80, 16, v120
  v_and_b32 v81, 0xffff0000, v120
  v_lshlrev_b32 v82, 16, v121
  v_and_b32 v83, 0xffff0000, v121
  v_lshlrev_b32 v84, 16, v122
  v_and_b32 v85, 0xffff0000, v122
  v_lshlrev_b32 v86, 16, v123
  v_and_b32 v87, 0xffff0000, v123
  v_fmac_f32 v40, v80, v34
  v_fmac_f32 v41, v81, v34
  v_fmac_f32 v42, v82, v34
  v_fmac_f32 v43, v83, v34
  v_fmac_f32 v44, v84, v34
  v_fmac_f32 v45, v85, v34
  v_fmac_f32 v46, v86, v34
  v_fmac_f32 v47, v87, v34
  s_waitcnt vmcnt(0)
  v_lshlrev_b32 v88, 16, v124
  v_and_b32 v89, 0xffff0000, v124
  v_lshlrev_b32 v90, 16, v125
  v_and_b32 v91, 0xffff0000, v125
  v_lshlrev_b32 v92, 16, v126
  v_and_b32 v93, 0xffff0000, v126
  v_lshlrev_b32 v94, 16, v127
  v_and_b32 v95, 0xffff0000, v127
  v_fmac_f32 v40, v88, v35
  v_fmac_f32 v41, v89, v35
  v_fmac_f32 v42, v90, v35
  v_fmac_f32 v43, v91, v35
  v_fmac_f32 v44, v92, v35
  v_fmac_f32 v45, v93, v35
  v_fmac_f32 v46, v94, v35
  v_fmac_f32 v47, v95, v35
  v_add_f32_dpp v40, v40, v40 row_ror:8 row_mask:0xf bank_mask:0xf
  v_add_f32_dpp v41, v41, v41 row_ror:8 row_mask:0xf bank_mask:0xf
  v_add_f32_dpp v42, v42, v42 row_ror:8 row_mask:0xf bank_mask:0xf
  v_add_f32_dpp v43, v43, v43 row_ror:8 row_mask:0xf bank_mask:0xf
  v_add_f32_dpp v44, v44, v44 row_ror:8 row_mask:0xf bank_mask:0xf
  v_add_f32_dpp v45, v45, v45 row_ror:8 row_mask:0xf bank_mask:0xf
  v_add_f32_dpp v46, v46, v46 row_ror:8 row_mask:0xf bank_mask:0xf
  v_add_f32_dpp v47, v47, v47 row_ror:8 row_mask:0xf bank_mask:0xf
  s_mov_b64 exec, s[28:29]
  ds_write_b128 v20, v[40:43] offset:8192
  ds_write_b128 v20, v[44:47] offset:8208
  s_mov_b64 exec, -1
  s_waitcnt lgkmcnt(0)
AX_GB_A:
  s_barrier
  s_cmp_lg_u32 s4, 7
  s_cbranch_scc1 AX_GB_B
  ds_read2st64_b32 v[60:61], v21 offset0:0 offset1:1
  ds_read2st64_b32 v[62:63], v21 offset0:2 offset1:3
  ds_read2st64_b32 v[64:65], v21 offset0:4 offset1:5
  ds_read2st64_b32 v[66:67], v21 offset0:6 offset1:7
  ds_read2st64_b32 v[68:69], v21 offset0:8 offset1:9
  ds_read2st64_b32 v[70:71], v21 offset0:10 offset1:11
  ds_read2st64_b32 v[72:73], v21 offset0:12 offset1:13
  ds_read2st64_b32 v[74:75], v21 offset0:14 offset1:15
  ds_read2st64_b32 v[76:77], v21 offset0:16 offset1:17
  ds_read2st64_b32 v[78:79], v21 offset0:18 offset1:19
  ds_read2st64_b32 v[80:81], v21 offset0:20 offset1:21
  ds_read2st64_b32 v[82:83], v21 offset0:22 offset1:23
  ds_read2st64_b32 v[84:85], v21 offset0:24 offset1:25
  ds_read2st64_b32 v[86:87], v21 offset0:26 offset1:27
  s_lshl_b32 s25, s40, 3
  s_add_u32 s25, s25, 90112
  s_cmp_lg_u32 s5, 0
  s_cselect_b32 s26, 0, 0
  s_waitcnt lgkmcnt(0)
  v_pk_add_f32 v[60:61], v[60:61], v[74:75]
  v_pk_add_f32 v[62:63], v[62:63], v[76:77]
  v_pk_add_f32 v[64:65], v[64:65], v[78:79]
  v_pk_add_f32 v[66:67], v[66:67], v[80:81]
  v_pk_add_f32 v[68:69], v[68:69], v[82:83]
  v_pk_add_f32 v[70:71], v[70:71], v[84:85]
  v_pk_add_f32 v[72:73], v[72:73], v[86:87]
  v_pk_add_f32 v[60:61], v[60:61], v[68:69]
  v_pk_add_f32 v[62:63], v[62:63], v[70:71]
  v_pk_add_f32 v[64:65], v[64:65], v[72:73]
  v_pk_add_f32 v[60:61], v[60:61], v[64:65]
  v_pk_add_f32 v[62:63], v[62:63], v[66:67]
  v_pk_add_f32 v[60:61], v[60:61], v[62:63]
  v_add_f32 v60, v60, v61
  v_add_u32_e64 v61, s69, 3
  v_add_f32 v60, s26, v60
  buffer_store_dwordx2 v[60:61], v23, s[16:19], s25 offen sc1
  ds_read2st64_b32 v[92:93], v21 offset0:32 offset1:33
  ds_read2st64_b32 v[94:95], v21 offset0:34 offset1:35
  ds_read2st64_b32 v[96:97], v21 offset0:36 offset1:37
  ds_read2st64_b32 v[98:99], v21 offset0:38 offset1:39
  ds_read2st64_b32 v[100:101], v21 offset0:40 offset1:41
  ds_read2st64_b32 v[102:103], v21 offset0:42 offset1:43
  ds_read2st64_b32 v[104:105], v21 offset0:44 offset1:45
  ds_read2st64_b32 v[106:107], v21 offset0:46 offset1:47
  ds_read2st64_b32 v[108:109], v21 offset0:48 offset1:49
  ds_read2st64_b32 v[110:111], v21 offset0:50 offset1:51
  ds_read2st64_b32 v[112:113], v21 offset0:52 offset1:53
  ds_read2st64_b32 v[114:115], v21 offset0:54 offset1:55
  ds_read2st64_b32 v[116:117], v21 offset0:56 offset1:57
  ds_read2st64_b32 v[118:119], v21 offset0:58 offset1:59
  s_lshl_b32 s25, s41, 3
  s_add_u32 s25, s25, 90112
  s_cmp_lg_u32 s5, 0
  s_cselect_b32 s26, 0, 0
  s_waitcnt lgkmcnt(0)
  v_pk_add_f32 v[92:93], v[92:93], v[106:107]
  v_pk_add_f32 v[94:95], v[94:95], v[108:109]
  v_pk_add_f32 v[96:97], v[96:97], v[110:111]
  v_pk_add_f32 v[98:99], v[98:99], v[112:113]
  v_pk_add_f32 v[100:101], v[100:101], v[114:115]
  v_pk_add_f32 v[102:103], v[102:103], v[116:117]
  v_pk_add_f32 v[104:105], v[104:105], v[118:119]
  v_pk_add_f32 v[92:93], v[92:93], v[100:101]
  v_pk_add_f32 v[94:95], v[94:95], v[102:103]
  v_pk_add_f32 v[96:97], v[96:97], v[104:105]
  v_pk_add_f32 v[92:93], v[92:93], v[96:97]
  v_pk_add_f32 v[94:95], v[94:95], v[98:99]
  v_pk_add_f32 v[92:93], v[92:93], v[94:95]
  v_add_f32 v92, v92, v93
  v_add_u32_e64 v93, s69, 3
  v_add_f32 v92, s26, v92
  buffer_store_dwordx2 v[92:93], v23, s[16:19], s25 offen sc1
AX_GB_B:
  s_endpgm
AJ_SLOW0:
  s_cmp_eq_u32 s31, 0
  s_cbranch_scc1 AJ_RET0
  s_sub_u32 s31, s31, 1
  s_sleep 4
  s_and_b32 s70, s31, 14
  s_cbranch_scc1 AJ_WF0
  s_mov_b64 vcc, exec
  s_mov_b64 exec, 1
  global_load_dword v41, v6, s[64:65] offset:64 sc1
  s_not_b32 s70, s69
  s_waitcnt vmcnt(0)
  v_readfirstlane_b32 s69, v41
  s_nop 0
  s_cmp_ge_u32 s69, s70
  s_cbranch_scc1 AJ_WF0B
  v_mov_b32 v41, s70
  global_atomic_umax v6, v41, s[64:65] offset:64 sc1
  s_mov_b32 s69, s70
AJ_WF0B:
  s_not_b32 s69, s69
  s_mov_b64 exec, vcc
AJ_WF0:
  s_memrealtime vcc
  buffer_load_dwordx4 v[40:43], v12, s[16:19], s46 offen offset:0 sc1
  buffer_load_dwordx4 v[44:47], v12, s[16:19], s46 offen offset:256 sc1
  buffer_load_dwordx4 v[48:51], v12, s[16:19], s46 offen offset:512 sc1
  buffer_load_dwordx4 v[52:55], v12, s[16:19], s46 offen offset:768 sc1
  s_waitcnt vmcnt(0)
  s_waitcnt lgkmcnt(0)
  s_lshr_b64 vcc, vcc, 8
  s_sub_u32 s70, vcc_lo, s69
  s_add_u32 s70, s70, 1
  v_subrev_u32 v41, s69, v41
  v_subrev_u32 v43, s69, v43
  v_subrev_u32 v45, s69, v45
  v_subrev_u32 v47, s69, v47
  v_subrev_u32 v49, s69, v49
  v_subrev_u32 v51, s69, v51
  v_subrev_u32 v53, s69, v53
  v_subrev_u32 v55, s69, v55
  v_max3_u32 v41, v41, v43, v45
  v_max3_u32 v47, v47, v49, v51
  v_max_u32 v53, v53, v55
  v_max3_u32 v41, v41, v47, v53
  v_cmp_lt_u32 vcc, s70, v41
  s_cbranch_vccnz AJ_SLOW0
  s_branch AJ_RET0
AJ_SLOW1:
  s_cmp_eq_u32 s31, 0
  s_cbranch_scc1 AJ_RET1
  s_sub_u32 s31, s31, 1
  s_sleep 4
  s_and_b32 s70, s31, 14
  s_cbranch_scc1 AJ_WF1
  s_mov_b64 vcc, exec
  s_mov_b64 exec, 1
  global_load_dword v11, v6, s[64:65] offset:64 sc1
  s_not_b32 s70, s69
  s_waitcnt vmcnt(0)
  v_readfirstlane_b32 s69, v11
  s_nop 0
  s_cmp_ge_u32 s69, s70
  s_cbranch_scc1 AJ_WF1B
  v_mov_b32 v11, s70
  global_atomic_umax v6, v11, s[64:65] offset:64 sc1
  s_mov_b32 s69, s70
AJ_WF1B:
  s_not_b32 s69, s69
  s_mov_b64 exec, vcc
AJ_WF1:
  s_memrealtime vcc
  buffer_load_dword v11, v8, s[16:19], s42 offen sc1
  s_waitcnt vmcnt(0)
  s_waitcnt lgkmcnt(0)
  s_lshr_b64 vcc, vcc, 8
  s_sub_u32 s70, vcc_lo, s69
  s_add_u32 s70, s70, 1
  v_subrev_u32 v11, s69, v11
  v_cmp_lt_u32 vcc, s70, v11
  s_cbranch_vccnz AJ_SLOW1
  s_branch AJ_RET1
AJ_SLOW2:
  s_cmp_eq_u32 s31, 0
  s_cbranch_scc1 AJ_RET2
  s_sub_u32 s31, s31, 1
  s_sleep 6
  buffer_load_dwordx4 v[64:67], v6, s[16:19], s40 offen offset:0 sc1
  buffer_load_dwordx4 v[68:71], v6, s[16:19], s40 offen offset:1024 sc1
  buffer_load_dwordx4 v[72:75], v6, s[16:19], s40 offen offset:2048 sc1
  buffer_load_dwordx4 v[76:79], v6, s[16:19], s40 offen offset:3072 sc1
  s_waitcnt vmcnt(0)
  v_max3_u32 v96, v64, v65, v66
  v_max3_u32 v97, v67, v68, v69
  v_max3_u32 v98, v70, v71, v72
  v_max3_u32 v99, v73, v74, v75
  v_max3_u32 v100, v76, v77, v78
  v_max3_u32 v96, v96, v97, v98
  v_max3_u32 v99, v99, v100, v79
  v_max_u32 v96, v96, v99
  v_cmp_eq_u32 vcc, -1, v96
  s_cbranch_vccnz AJ_SLOW2
  s_branch AJ_RET2
AJ_SLOW3:
  s_cmp_eq_u32 s31, 0
  s_cbranch_scc1 AJ_RET3
  s_sub_u32 s31, s31, 1
  s_sleep 6
  buffer_load_dwordx4 v[64:67], v6, s[16:19], s40 offen offset:0 sc1
  buffer_load_dwordx4 v[68:71], v6, s[16:19], s40 offen offset:1024 sc1
  buffer_load_dwordx4 v[72:75], v6, s[16:19], s40 offen offset:2048 sc1
  buffer_load_dwordx4 v[76:79], v6, s[16:19], s40 offen offset:3072 sc1
  s_waitcnt vmcnt(0)
  v_max3_u32 v96, v64, v65, v66
  v_max3_u32 v97, v67, v68, v69
  v_max3_u32 v98, v70, v71, v72
  v_max3_u32 v99, v73, v74, v75
  v_max3_u32 v100, v76, v77, v78
  v_max3_u32 v96, v96, v97, v98
  v_max3_u32 v99, v99, v100, v79
  v_max_u32 v96, v96, v99
  v_cmp_eq_u32 vcc, -1, v96
  s_cbranch_vccnz AJ_SLOW3
  s_branch AJ_RET3
.p2align 4
GTAB:
.short 2720, 2720, 2720, 2720, 2712, 2712, 2712, 2712, 2712, 2712, 2712, 2708, 2708, 2708, 2708, 2708
.short 2708, 2708, 2708, 2708, 2704, 2704, 2704, 2704, 2704, 2704, 2704, 2700, 2700, 2700, 2700, 2700
.short 2700, 2700, 2700, 2700, 2696, 2696, 2696, 2696, 2696, 2696, 2696, 2692, 2692, 2692, 2692, 2692
.short 2692, 2692, 2692, 2692, 2688, 2688, 2688, 2688, 2688, 2688, 2688, 2684, 2684, 2684, 2684, 2684
.short 2684, 2684, 2684, 2684, 2680, 2680, 2680, 2680, 2680, 2680, 2680, 2676, 2676, 2676, 2676, 2676
.short 2676, 2676, 2676, 2676, 2672, 2672, 2672, 2672, 2672, 2672, 2672, 2668, 2668, 2668, 2668, 2668
.short 2668, 2668, 2668, 2668, 2664, 2664, 2664, 2664, 2664, 2664, 2664, 2660, 2660, 2660, 2660, 2660
.short 2660, 2660, 2660, 2660, 2656, 2656, 2656, 2656, 2656, 2656, 2656, 2652, 2652, 2652, 2652, 2652
.short 2652, 2652, 2652, 2652, 2644, 2644, 2644, 2644, 2644, 2644, 2644, 2640, 2640, 2640, 2640, 2640
.short 2640, 2640, 2640, 2640, 2636, 2636, 2636, 2636, 2636, 2636, 2636, 2632, 2632, 2632, 2632, 2632
.short 2632, 2632, 2632, 2632, 2628, 2628, 2628, 2628, 2628, 2628, 2628, 2624, 2624, 2624, 2624, 2624
.short 2624, 2624, 2624, 2624, 2620, 2620, 2620, 2620, 2620, 2620, 2620, 2616, 2616, 2616, 2616, 2616
.short 2616, 2616, 2616, 2616, 2612, 2612, 2612, 2612, 2612, 2612, 2612, 2608, 2608, 2608, 2608, 2608
.short 2608, 2608, 2608, 2608, 2604, 2604, 2604, 2604, 2604, 2604, 2604, 2600, 2600, 2600, 2600, 2600
.short 2600, 2600, 2600, 2600, 2596, 2596, 2596, 2596, 2596, 2596, 2596, 2592, 2592, 2592, 2592, 2592
.short 2592, 2592, 2592, 2592, 2588, 2588, 2588, 2588, 2588, 2588, 2588, 2584, 2584, 2584, 2584, 2584
.short 2584, 2584, 2584, 2584, 2576, 2576, 2576, 2576, 2576, 2576, 2576, 2572, 2572, 2572, 2572, 2572
.short 2572, 2572, 2572, 2572, 2568, 2568, 2568, 2568, 2568, 2568, 2568, 2564, 2564, 2564, 2564, 2564
.short 2564, 2564, 2564, 2564, 2560, 2560, 2560, 2560, 2560, 2560, 2560, 2556, 2556, 2556, 2556, 2556
.short 2556, 2556, 2556, 2556, 2552, 2552, 2552, 2552, 2552, 2552, 2552, 2548, 2548, 2548, 2548, 2548
.short 2548, 2548, 2548, 2548, 2544, 2544, 2544, 2544, 2544, 2544, 2544, 2540, 2540, 2540, 2540, 2540
.short 2540, 2540, 2540, 2540, 2536, 2536, 2536, 2536, 2536, 2536, 2536, 2532, 2532, 2532, 2532, 2532
.short 2532, 2532, 2532, 2532, 2528, 2528, 2528, 2528, 2528, 2528, 2528, 2524, 2524, 2524, 2524, 2524
.short 2524, 2524, 2524, 2524, 2520, 2520, 2520, 2520, 2520, 2520, 2520, 2516, 2516, 2516, 2516, 2516
.short 2516, 2516, 2516, 2516, 2508, 2508, 2508, 2508, 2508, 2508, 2508, 2504, 2504, 2504, 2504, 2504
.short 2504, 2504, 2504, 2504, 2500, 2500, 2500, 2500, 2500, 2500, 2500, 2496, 2496, 2496, 2496, 2496
.short 2496, 2496, 2496, 2496, 2492, 2492, 2492, 2492, 2492, 2492, 2492, 2488, 2488, 2488, 2488, 2488
.short 2488, 2488, 2488, 2488, 2484, 2484, 2484, 2484, 2484, 2484, 2484, 2480, 2480, 2480, 2480, 2480
.short 2480, 2480, 2480, 2480, 2476, 2476, 2476, 2476, 2476, 2476, 2476, 2472, 2472, 2472, 2472, 2472
.short 2472, 2472, 2472, 2472, 2468, 2468, 2468, 2468, 2468, 2468, 2468, 2464, 2464, 2464, 2464, 2464
.short 2464, 2464, 2464, 2464, 2460, 2460, 2460, 2460, 2460, 2460, 2460, 2456, 2456, 2456, 2456, 2456
.short 2456, 2456, 2456, 2456, 2452, 2452, 2452, 2452, 2452, 2452, 2452, 2448, 2448, 2448, 2448, 2448
.short 2448, 2448, 2448, 2448, 2440, 2440, 2440, 2440, 2440, 2440, 2440, 2436, 2436, 2436, 2436, 2436
.short 2436, 2436, 2436, 2436, 2432, 2432, 2432, 2432, 2432, 2432, 2432, 2428, 2428, 2428, 2428, 2428
.short 2428, 2428, 2428, 2428, 2424, 2424, 2424, 2424, 2424, 2424, 2424, 2420, 2420, 2420, 2420, 2420
.short 2420, 2420, 2420, 2420, 2416, 2416, 2416, 2416, 2416, 2416, 2416, 2412, 2412, 2412, 2412, 2412
.short 2412, 2412, 2412, 2412, 2408, 2408, 2408, 2408, 2408, 2408, 2408, 2404, 2404, 2404, 2404, 2404
.short 2404, 2404, 2404, 2404, 2400, 2400, 2400, 2400, 2400, 2400, 2400, 2396, 2396, 2396, 2396, 2396
.short 2396, 2396, 2396, 2396, 2392, 2392, 2392, 2392, 2392, 2392, 2392, 2388, 2388, 2388, 2388, 2388
.short 2388, 2388, 2388, 2388, 2384, 2384, 2384, 2384, 2384, 2384, 2384, 2380, 2380, 2380, 2380, 2380
.short 2380, 2380, 2380, 2380, 2372, 2372, 2372, 2372, 2372, 2372, 2372, 2368, 2368, 2368, 2368, 2368
.short 2368, 2368, 2368, 2368, 2364, 2364, 2364, 2364, 2364, 2364, 2364, 2360, 2360, 2360, 2360, 2360
.short 2360, 2360, 2360, 2360, 2356, 2356, 2356, 2356, 2356, 2356, 2356, 2352, 2352, 2352, 2352, 2352
.short 2352, 2352, 2352, 2352, 2348, 2348, 2348, 2348, 2348, 2348, 2348, 2344, 2344, 2344, 2344, 2344
.short 2344, 2344, 2344, 2344, 2340, 2340, 2340, 2340, 2340, 2340, 2340, 2336, 2336, 2336, 2336, 2336
.short 2336, 2336, 2336, 2336, 2332, 2332, 2332, 2332, 2332, 2332, 2332, 2328, 2328, 2328, 2328, 2328
.short 2328, 2328, 2328, 2328, 2324, 2324, 2324, 2324, 2324, 2324, 2324, 2320, 2320, 2320, 2320, 2320
.short 2320, 2320, 2320, 2320, 2316, 2316, 2316, 2316, 2316, 2316, 2316, 2312, 2312, 2312, 2312, 2312
.short 2312, 2312, 2312, 2312, 2304, 2304, 2304, 2304, 2304, 2304, 2304, 2300, 2300, 2300, 2300, 2300
.short 2300, 2300, 2300, 2300, 2296, 2296, 2296, 2296, 2296, 2296, 2296, 2292, 2292, 2292, 2292, 2292
.short 2292, 2292, 2292, 2292, 2288, 2288, 2288, 2288, 2288, 2288, 2288, 2284, 2284, 2284, 2284, 2284
.short 2284, 2284, 2284, 2284, 2280, 2280, 2280, 2280, 2280, 2280, 2280, 2276, 2276, 2276, 2276, 2276
.short 2276, 2276, 2276, 2276, 2272, 2272, 2272, 2272, 2272, 2272, 2272, 2268, 2268, 2268, 2268, 2268
.short 2268, 2268, 2268, 2268, 2264, 2264, 2264, 2264, 2264, 2264, 2264, 2260, 2260, 2260, 2260, 2260
.short 2260, 2260, 2260, 2260, 2256, 2256, 2256, 2256, 2256, 2256, 2256, 2252, 2252, 2252, 2252, 2252
.short 2252, 2252, 2252, 2252, 2248, 2248, 2248, 2248, 2248, 2248, 2248, 2244, 2244, 2244, 2244, 2244
.short 2244, 2244, 2244, 2244, 2236, 2236, 2236, 2236, 2236, 2236, 2236, 2232, 2232, 2232, 2232, 2232
.short 2232, 2232, 2232, 2232, 2228, 2228, 2228, 2228, 2228, 2228, 2228, 2224, 2224, 2224, 2224, 2224
.short 2224, 2224, 2224, 2224, 2220, 2220, 2220, 2220, 2220, 2220, 2220, 2216, 2216, 2216, 2216, 2216
.short 2216, 2216, 2216, 2216, 2212, 2212, 2212, 2212, 2212, 2212, 2212, 2208, 2208, 2208, 2208, 2208
.short 2208, 2208, 2208, 2208, 2204, 2204, 2204, 2204, 2204, 2204, 2204, 2200, 2200, 2200, 2200, 2200
.short 2200, 2200, 2200, 2200, 2196, 2196, 2196, 2196, 2196, 2196, 2196, 2192, 2192, 2192, 2192, 2192
.short 2192, 2192, 2192, 2192, 2188, 2188, 2188, 2188, 2188, 2188, 2188, 2184, 2184, 2184, 2184, 2184
.short 2184, 2184, 2184, 2184, 2180, 2180, 2180, 2180, 2180, 2180, 2180, 2176, 2176, 2176, 2176, 2176
.short 2176, 2176, 2168, 2168, 2168, 2164, 2164, 2164, 2164, 2164, 2160, 2160, 2160, 2156, 2156, 2156
.short 2156, 2156, 2152, 2152, 2152, 2148, 2148, 2148, 2148, 2148, 2144, 2144, 2144, 2140, 2140, 2140
.short 2140, 2140, 2136, 2136, 2136, 2132, 2132, 2132, 2132, 2132, 2128, 2128, 2128, 2124, 2124, 2124
.short 2124, 2124, 2120, 2120, 2120, 2116, 2116, 2116, 2116, 2116, 2112, 2112, 2112, 2108, 2108, 2108
.short 2108, 2108, 2100, 2100, 2100, 2096, 2096, 2096, 2096, 2096, 2092, 2092, 2092, 2088, 2088, 2088
.short 2088, 2088, 2084, 2084, 2084, 2080, 2080, 2080, 2080, 2080, 2076, 2076, 2076, 2072, 2072, 2072
.short 2072, 2072, 2068, 2068, 2068, 2064, 2064, 2064, 2064, 2064, 2060, 2060, 2060, 2056, 2056, 2056
.short 2056, 2056, 2052, 2052, 2052, 2048, 2048, 2048, 2048, 2048, 2044, 2044, 2044, 2040, 2040, 2040
.short 2040, 2040, 2032, 2032, 2032, 2028, 2028, 2028, 2028, 2028, 2024, 2024, 2024, 2020, 2020, 2020
.short 2020, 2020, 2016, 2016, 2016, 2012, 2012, 2012, 2012, 2012, 2008, 2008, 2008, 2004, 2004, 2004
.short 2004, 2004, 2000, 2000, 2000, 1996, 1996, 1996, 1996, 1996, 1992, 1992, 1992, 1988, 1988, 1988
.short 1988, 1988, 1984, 1984, 1984, 1980, 1980, 1980, 1980, 1980, 1976, 1976, 1976, 1972, 1972, 1972
.short 1972, 1972, 1964, 1964, 1964, 1960, 1960, 1960, 1960, 1960, 1956, 1956, 1956, 1952, 1952, 1952
.short 1952, 1952, 1948, 1948, 1948, 1944, 1944, 1944, 1944, 1944, 1940, 1940, 1940, 1936, 1936, 1936
.short 1936, 1936, 1932, 1932, 1932, 1928, 1928, 1928, 1928, 1928, 1924, 1924, 1924, 1920, 1920, 1920
.short 1920, 1920, 1916, 1916, 1916, 1912, 1912, 1912, 1912, 1912, 1908, 1908, 1908, 1904, 1904, 1904
.short 1904, 1904, 1896, 1896, 1896, 1892, 1892, 1892, 1892, 1892, 1888, 1888, 1888, 1884, 1884, 1884
.short 1884, 1884, 1880, 1880, 1880, 1876, 1876, 1876, 1876, 1876, 1872, 1872, 1872, 1868, 1868, 1868
.short 1868, 1868, 1864, 1864, 1864, 1860, 1860, 1860, 1860, 1860, 1856, 1856, 1856, 1852, 1852, 1852
.short 1852, 1852, 1848, 1848, 1848, 1844, 1844, 1844, 1844, 1844, 1840, 1840, 1840, 1836, 1836, 1836
.short 1836, 1836, 1828, 1828, 1828, 1824, 1824, 1824, 1824, 1824, 1820, 1820, 1820, 1816, 1816, 1816
.short 1816, 1816, 1812, 1812, 1812, 1808, 1808, 1808, 1808, 1808, 1804, 1804, 1804, 1800, 1800, 1800
.short 1800, 1800, 1796, 1796, 1796, 1792, 1792, 1792, 1792, 1792, 1788, 1788, 1788, 1784, 1784, 1784
.short 1784, 1784, 1780, 1780, 1780, 1776, 1776, 1776, 1776, 1776, 1772, 1772, 1772, 1768, 1768, 1768
.short 1768, 1768, 1760, 1760, 1760, 1756, 1756, 1756, 1756, 1756, 1752, 1752, 1752, 1748, 1748, 1748
.short 1748, 1748, 1744, 1744, 1744, 1740, 1740, 1740, 1740, 1740, 1736, 1736, 1736, 1732, 1732, 1732
.short 1732, 1732, 1728, 1728, 1728, 1724, 1724, 1724, 1724, 1724, 1720, 1720, 1720, 1716, 1716, 1716
.short 1716, 1716, 1712, 1712, 1712, 1708, 1708, 1708, 1708, 1708, 1704, 1704, 1704, 1700, 1700, 1700
.short 1700, 1700, 1692, 1692, 1692, 1688, 1688, 1688, 1688, 1688, 1684, 1684, 1684, 1680, 1680, 1680
.short 1680, 1680, 1676, 1676, 1676, 1672, 1672, 1672, 1672, 1672, 1668, 1668, 1668, 1664, 1664, 1664
.short 1664, 1664, 1660, 1660, 1660, 1656, 1656, 1656, 1656, 1656, 1652, 1652, 1652, 1648, 1648, 1648
.short 1648, 1648, 1644, 1644, 1644, 1640, 1640, 1640, 1640, 1640, 1636, 1636, 1636, 1632, 1632, 1632
.short 1632, 1624, 1620, 1620, 1620, 1616, 1612, 1612, 1612, 1608, 1604, 1604, 1604, 1600, 1596, 1596
.short 1596, 1592, 1588, 1588, 1588, 1584, 1580, 1580, 1580, 1576, 1572, 1572, 1572, 1568, 1564, 1564
.short 1564, 1556, 1552, 1552, 1552, 1548, 1544, 1544, 1544, 1540, 1536, 1536, 1536, 1532, 1528, 1528
.short 1528, 1524, 1520, 1520, 1520, 1516, 1512, 1512, 1512, 1508, 1504, 1504, 1504, 1500, 1496, 1496
.short 1496, 1488, 1484, 1484, 1484, 1480, 1476, 1476, 1476, 1472, 1468, 1468, 1468, 1464, 1460, 1460
.short 1460, 1456, 1452, 1452, 1452, 1448, 1444, 1444, 1444, 1440, 1436, 1436, 1436, 1432, 1428, 1428
.short 1428, 1420, 1416, 1416, 1416, 1412, 1408, 1408, 1408, 1404, 1400, 1400, 1400, 1396, 1392, 1392
.short 1392, 1388, 1384, 1384, 1384, 1380, 1376, 1376, 1376, 1372, 1368, 1368, 1368, 1364, 1360, 1360
.short 1360, 1352, 1348, 1348, 1348, 1344, 1340, 1340, 1340, 1336, 1332, 1332, 1332, 1328, 1324, 1324
.short 1324, 1320, 1316, 1316, 1316, 1312, 1308, 1308, 1308, 1304, 1300, 1300, 1300, 1296, 1292, 1292
.short 1292, 1284, 1280, 1280, 1280, 1276, 1272, 1272, 1272, 1268, 1264, 1264, 1264, 1260, 1256, 1256
.short 1256, 1252, 1248, 1248, 1248, 1244, 1240, 1240, 1240, 1236, 1232, 1232, 1232, 1228, 1224, 1224
.short 1224, 1216, 1212, 1212, 1212, 1208, 1204, 1204, 1204, 1200, 1196, 1196, 1196, 1192, 1188, 1188
.short 1188, 1184, 1180, 1180, 1180, 1176, 1172, 1172, 1172, 1168, 1164, 1164, 1164, 1160, 1156, 1156
.short 1156, 1148, 1144, 1144, 1144, 1140, 1136, 1136, 1136, 1132, 1128, 1128, 1128, 1124, 1120, 1120
.short 1120, 1116, 1112, 1112, 1112, 1108, 1104, 1104, 1104, 1100, 1096, 1096, 1096, 1092, 1088, 1088
.short 1080, 1076, 1072, 1068, 1064, 1060, 1056, 1052, 1048, 1044, 1040, 1036, 1032, 1028, 1024, 1020
.short 1012, 1008, 1004, 1000, 996, 992, 988, 984, 980, 976, 972, 968, 964, 960, 956, 952
.short 944, 940, 936, 932, 928, 924, 920, 916, 912, 908, 904, 900, 896, 892, 888, 884
.short 876, 872, 868, 864, 860, 856, 852, 848, 844, 840, 836, 832, 828, 824, 820, 816
.short 808, 804, 800, 796, 792, 788, 784, 780, 776, 772, 768, 764, 760, 756, 752, 748
.short 740, 736, 732, 728, 724, 720, 716, 712, 708, 704, 700, 696, 692, 688, 684, 680
.short 672, 668, 664, 660, 656, 652, 648, 644, 640, 636, 632, 628, 624, 620, 616, 612
.short 604, 600, 596, 592, 588, 584, 580, 576, 572, 568, 564, 560, 556, 552, 548, 544
.short 536, 532, 528, 524, 520, 516, 512, 508, 504, 500, 496, 492, 488, 484, 480, 476
.short 468, 464, 460, 456, 452, 448, 444, 440, 436, 432, 428, 424, 420, 416, 412, 408
.short 400, 396, 392, 388, 384, 380, 376, 372, 368, 364, 360, 356, 352, 348, 344, 340
.short 332, 328, 324, 320, 316, 312, 308, 304, 300, 296, 292, 288, 284, 280, 276, 272
.short 264, 260, 256, 252, 248, 244, 240, 236, 232, 228, 224, 220, 216, 212, 208, 204
.short 196, 192, 188, 184, 180, 176, 172, 168, 164, 160, 156, 152, 148, 144, 140, 136
.short 128, 124, 120, 116, 112, 108, 104, 100, 96, 92, 88, 84, 80, 76, 72, 68
.short 60, 56, 52, 48, 44, 40, 36, 32, 28, 24, 20, 16, 12, 8, 4, 0
.short 0, 0, 0, 0, 0, 0, 0, 0
.section .rodata,"a"
.p2align 6
.amdhsa_kernel adaLN_cond__ssm_conv_s4__glu_gated_glu__prompt_kernel
  .amdhsa_next_free_vgpr 256
  .amdhsa_next_free_sgpr 102
  .amdhsa_accum_offset 128
  .amdhsa_group_segment_fixed_size 0
  .amdhsa_kernarg_size 144
  .amdhsa_user_sgpr_count 2
  .amdhsa_user_sgpr_kernarg_segment_ptr 1
  .amdhsa_system_sgpr_workgroup_id_x 1
  .amdhsa_float_denorm_mode_32 3
.end_amdhsa_kernel
```
